```python
import torch

def _softmax(x, axis=-1):
    return torch.softmax(x, dim=axis)
def _gelu(x):
    return torch.nn.functional.gelu(x, approximate="tanh")
def _silu(x):
    return torch.nn.functional.silu(x)
def _sigmoid(x):
    return torch.sigmoid(x)
def _layernorm(x, axis=-1, eps=1e-5):
    m = x.mean(dim=axis, keepdim=True)
    v = x.var(dim=axis, keepdim=True, unbiased=False)
    return (x - m) / torch.sqrt(v + eps)
def _scatter_add(tgt, idx, src, axis=0):
    return tgt.clone().index_add_(axis, idx, src)
def _segment_sum(src, seg, n):
    out = torch.zeros((n,) + src.shape[1:], dtype=src.dtype)
    return out.index_add_(0, seg, src)
def _pad(x, pw):
    flat = tuple(v for pair in reversed(pw) for v in pair)
    return torch.nn.functional.pad(x, flat)

kernel_name = 'interleave_layers__softmax_full_mha__ssm_conv_h3__prompt'

def setup_inputs():

    _w = (lambda a: (lambda t: t.to(torch.bfloat16) if t.is_floating_point() else t)(torch.as_tensor(a)))
    def _A_setup():
        B, S, D = 1, 2048, 576
        return {
            "x": _w((lambda *s: torch.randn(*s, dtype=torch.bfloat16) * 0.05)(B, S, D)),
            "wqkv": _w((lambda *s: torch.randn(*s, dtype=torch.bfloat16) * 0.05)(D, 3 * D)),
            "wo": _w((lambda *s: torch.randn(*s, dtype=torch.bfloat16) * 0.05)(D, D)),
        }
    _A_in = _A_setup()

    def _B_setup():
        B, S, D = 1, 2048, 576
        ks = 4
        return {
            "q": _w((lambda *s: torch.randn(*s, dtype=torch.bfloat16) * 0.05)(B, S, D)),
            "k": _w((lambda *s: torch.randn(*s, dtype=torch.bfloat16) * 0.4)(B, S, D)),
            "v": _w((lambda *s: torch.randn(*s, dtype=torch.bfloat16) * 0.4)(B, S, D)),
            "shift_k": _w((lambda *s: torch.randn(*s, dtype=torch.bfloat16) * 0.4)(D, ks) * 0.5),
            "ssm_k": _w((lambda *s: torch.randn(*s, dtype=torch.bfloat16) * 0.8)(D, S) * (1.0 / S ** 0.5)),
            "ssm_D": _w((lambda *s: torch.randn(*s, dtype=torch.bfloat16) * 0.4)(D)),
        }
    _B_in = _B_setup()

    return {
        "A_x": _A_in["x"],
        "A_wqkv": _A_in["wqkv"],
        "A_wo": _A_in["wo"],
        "B_q": _B_in["q"],
        "B_k": _B_in["k"],
        "B_v": _B_in["v"],
        "B_shift_k": _B_in["shift_k"],
        "B_ssm_k": _B_in["ssm_k"],
        "B_ssm_D": _B_in["ssm_D"],
    }

def reference(A_x, A_wqkv, A_wo, B_q, B_k, B_v, B_shift_k, B_ssm_k, B_ssm_D):
    def _A_ref(x, wqkv, wo):
        B, S, D = x.shape
        H = 32; Dh = D // H
        qkv = (lambda x, *d: x.permute(*d))((x @ wqkv).reshape(B, S, 3, H, Dh), 2, 0, 3, 1, 4)
        q, k, v = qkv[0], qkv[1], qkv[2]
        scale = Dh ** -0.5
        scores = torch.einsum("bhqd,bhkd->bhqk", q, k) * scale
        p = _softmax(scores, axis=-1)
        o = torch.einsum("bhqk,bhkd->bhqd", p, v)
        return (lambda x, *d: x.permute(*d))(o, 0, 2, 1, 3).reshape(B, S, D) @ wo

    def _B_ref(q, k, v, shift_k, ssm_k, ssm_D):
        B, S, D = q.shape
        ks = shift_k.shape[-1]
        k_pad = _pad(k, ((0, 0), (ks - 1, 0), (0, 0)))
        k_shift = torch.zeros_like(k)
        for t in range(ks):
            k_shift = k_shift + k_pad[:, t:t + S, :] * shift_k[:, ks - 1 - t][None, None, :]
        kv = k_shift * v
        L = 2 * S
        kv_pad = _pad(kv, ((0, 0), (0, S), (0, 0)))
        kf_pad = _pad(ssm_k, ((0, 0), (0, S)))
        kv_f = (lambda x, axes=(-2,-1): torch.fft.rfft2(x.float(), dim=axes))(kv_pad[:, None, :, :], axes=(1, 2))
        kf_f = (lambda x, axes=(-2,-1): torch.fft.rfft2(x.float(), dim=axes))(kf_pad[:, None, :], axes=(1, 2))
        kf_f = (lambda x, *d: x.permute(*d))(kf_f, 1, 2, 0)
        y_f = kv_f * kf_f[None, :, :, :]
        y = (lambda x, s, axes=(-2,-1): torch.fft.irfft2(x, s=s, dim=axes).to(torch.bfloat16))(y_f, (1, L), axes=(1, 2))[:, 0, :S, :]
        y = y + kv * ssm_D[None, None, :]
        return q * y

    x = A_x
    x = x + _A_ref(_layernorm(x, axis=-1), A_wqkv, A_wo)
    x = x + _B_ref(_layernorm(x, axis=-1), B_k, B_v, B_shift_k, B_ssm_k, B_ssm_D)
    x = x + _A_ref(_layernorm(x, axis=-1), A_wqkv, A_wo)
    x = x + _B_ref(_layernorm(x, axis=-1), B_k, B_v, B_shift_k, B_ssm_k, B_ssm_D)
    return x
```

```asm
; @launch kernel=interleave_layers__softmax_full_mha__ssm_conv_h3__prompt_kernel grid=(309,1,1) block=(512,1,1) lds=44032
; @launch kernel=qkv1_conv_kernel grid=(512,1,1) block=(512,1,1) lds=81920
; @launch kernel=attn_proj1_qkv2_kernel grid=(256,1,1) block=(512,1,1) lds=155648
; @launch kernel=attn_proj2_kernel grid=(256,1,1) block=(512,1,1) lds=155648
.amdgcn_target "amdgcn-amd-amdhsa--gfx950"
.text
.globl interleave_layers__softmax_full_mha__ssm_conv_h3__prompt_kernel
.p2align 8
.type interleave_layers__softmax_full_mha__ssm_conv_h3__prompt_kernel,@function
interleave_layers__softmax_full_mha__ssm_conv_h3__prompt_kernel:
    s_cmp_ge_u32 s2, 309
    s_cbranch_scc1 L_interleave_layers__softmax_full_mha__ssm_conv_h3__prompt_kernel_exit2
    s_load_dwordx2 s[12:13], s[0:1], 88
    v_lshrrev_b32 v1, 6, v0
    v_and_b32 v2, 63, v0
    v_readfirstlane_b32 s10, v1
    s_mov_b32 s3, s2
    s_cmp_lt_u32 s2, 32
    s_cbranch_scc1 L_interleave_layers__softmax_full_mha__ssm_conv_h3__prompt_kernel_t1
    s_sub_u32 s3, s2, 32
    s_cmp_lt_u32 s2, 176
    s_cbranch_scc1 L_interleave_layers__softmax_full_mha__ssm_conv_h3__prompt_kernel_t4
    s_sub_u32 s3, s2, 176
    s_cmp_lt_u32 s2, 228
    s_cbranch_scc1 L_interleave_layers__softmax_full_mha__ssm_conv_h3__prompt_kernel_t2
    s_sub_u32 s3, s2, 228
L_interleave_layers__softmax_full_mha__ssm_conv_h3__prompt_kernel_t3:
    s_mov_b32 s60, -1
    s_mov_b32 s61, -1
    s_mov_b32 s62, 3
    s_load_dwordx2 s[14:15], s[0:1], 16
    s_mov_b32 s8, s3
    s_lshl_b32 s8, s8, 3
    s_add_u32 s8, s8, s10
    v_and_b32 v3, 15, v2
    v_lshrrev_b32 v4, 4, v2
    v_lshrrev_b32 v5, 1, v4
    v_mul_u32_u24 v5, 18, v5
    v_and_b32 v6, 1, v4
    v_lshl_add_u32 v5, v6, 2, v5
    v_mul_u32_u24 v5, 1152, v5
    v_lshl_add_u32 v5, v3, 1, v5
    v_mul_u32_u24 v6, 82944, v4
    v_lshl_add_u32 v6, v3, 1, v6
    v_lshlrev_b32 v7, 4, v2
    s_waitcnt lgkmcnt(0)
    s_mov_b32 s4, s12
    s_and_b32 s5, s13, 0xffff
    s_mov_b32 s6, 0x10000000
    s_mov_b32 s7, 0x00020000
    s_mov_b32 s20, s14
    s_and_b32 s21, s15, 0xffff
    s_mov_b32 s22, 0xa2000
    s_mov_b32 s23, 0x00020000
    s_add_u32 s24, s8, 0
    s_mul_i32 s25, s24, 607
    s_lshr_b32 s25, s25, 16
    s_mul_i32 s26, s25, 108
    s_sub_u32 s26, s24, s26
    s_mul_i32 s27, s26, 43
    s_lshr_b32 s27, s27, 8
    s_mul_i32 s28, s27, 6
    s_sub_u32 s28, s26, s28
    s_mul_i32 s29, s25, 192
    s_lshl_b32 s28, s28, 5
    s_add_u32 s29, s29, s28
    s_cmp_ge_u32 s27, 16
    s_cbranch_scc1 L_interleave_layers__softmax_full_mha__ssm_conv_h3__prompt_kernel_t3x0
    s_mul_i32 s30, s27, 41472
    s_add_u32 s30, s30, s29
    s_add_u32 s31, s30, 0
    buffer_load_ushort v8, v5, s[20:23], s31 offen
    s_add_u32 s31, s30, 1152
    buffer_load_ushort v9, v5, s[20:23], s31 offen
    s_add_u32 s31, s30, 2304
    buffer_load_ushort v10, v5, s[20:23], s31 offen
    s_add_u32 s31, s30, 3456
    buffer_load_ushort v11, v5, s[20:23], s31 offen
    s_add_u32 s31, s30, 9216
    buffer_load_ushort v12, v5, s[20:23], s31 offen
    s_add_u32 s31, s30, 10368
    buffer_load_ushort v13, v5, s[20:23], s31 offen
    s_add_u32 s31, s30, 11520
    buffer_load_ushort v14, v5, s[20:23], s31 offen
    s_add_u32 s31, s30, 12672
    buffer_load_ushort v15, v5, s[20:23], s31 offen
    s_branch L_interleave_layers__softmax_full_mha__ssm_conv_h3__prompt_kernel_t3j0
L_interleave_layers__softmax_full_mha__ssm_conv_h3__prompt_kernel_t3x0:
    s_sub_u32 s30, s27, 16
    s_mul_i32 s30, s30, 331776
    s_add_u32 s30, s30, s29
    s_add_u32 s31, s30, 18432
    buffer_load_ushort v8, v6, s[20:23], s31 offen
    s_add_u32 s31, s30, 19584
    buffer_load_ushort v9, v6, s[20:23], s31 offen
    s_add_u32 s31, s30, 39168
    buffer_load_ushort v10, v6, s[20:23], s31 offen
    s_add_u32 s31, s30, 40320
    buffer_load_ushort v11, v6, s[20:23], s31 offen
    s_add_u32 s31, s30, 59904
    buffer_load_ushort v12, v6, s[20:23], s31 offen
    s_add_u32 s31, s30, 61056
    buffer_load_ushort v13, v6, s[20:23], s31 offen
    s_add_u32 s31, s30, 80640
    buffer_load_ushort v14, v6, s[20:23], s31 offen
    s_add_u32 s31, s30, 81792
    buffer_load_ushort v15, v6, s[20:23], s31 offen
L_interleave_layers__softmax_full_mha__ssm_conv_h3__prompt_kernel_t3j0:
    s_lshl_b32 s30, s24, 10
    s_add_u32 s30, s30, 28311552
    s_waitcnt vmcnt(0)
    v_lshl_or_b32 v16, v9, 16, v8
    v_lshl_or_b32 v17, v11, 16, v10
    v_lshl_or_b32 v18, v13, 16, v12
    v_lshl_or_b32 v19, v15, 16, v14
    buffer_store_dwordx4 v[16:19], v7, s[4:7], s30 offen
    s_cmp_ge_u32 s8, 128
    s_cbranch_scc1 L_interleave_layers__softmax_full_mha__ssm_conv_h3__prompt_kernel_exit
    s_lshr_b32 s24, s8, 2
    s_and_b32 s25, s8, 3
    s_mul_i32 s24, s24, 151552
    s_mul_i32 s25, s25, 19456
    s_add_u32 s24, s24, s25
    s_add_u32 s24, s24, 74016
    v_lshrrev_b32 v8, 1, v2
    v_mul_u32_u24 v8, 608, v8
    v_and_b32 v9, 1, v2
    v_mul_u32_u24 v9, 304, v9
    v_add_u32 v8, v8, v9
    v_mov_b32 v20, 0x3f803f80
    v_mov_b32 v21, 0x3f803f80
    v_mov_b32 v22, 0x3f803f80
    v_mov_b32 v23, 0x3f803f80
    buffer_store_dwordx4 v[20:23], v8, s[4:7], s24 offen
    s_branch L_interleave_layers__softmax_full_mha__ssm_conv_h3__prompt_kernel_exit
L_interleave_layers__softmax_full_mha__ssm_conv_h3__prompt_kernel_t2:
    s_load_dwordx2 s[14:15], s[0:1], 8
    s_lshr_b32 s9, s3, 2
    s_and_b32 s8, s3, 3
    s_mov_b32 s60, -1
    s_mov_b32 s61, -1
    s_mov_b32 s62, 2
    s_cmp_ge_u32 s9, 8
    s_cselect_b32 s11, 1, 0
    s_cbranch_scc1 L_interleave_layers__softmax_full_mha__ssm_conv_h3__prompt_kernel_t2v
    s_lshr_b32 s16, s9, 2
    s_and_b32 s17, s9, 3
    s_mul_i32 s18, s17, 288
    s_mul_i32 s19, s16, 1152
    s_add_u32 s18, s18, s19
    s_mov_b32 s24, 40
    s_mov_b32 s25, 72
    s_branch L_interleave_layers__softmax_full_mha__ssm_conv_h3__prompt_kernel_t2j
L_interleave_layers__softmax_full_mha__ssm_conv_h3__prompt_kernel_t2v:
    s_sub_u32 s17, s9, 8
    s_lshl_b32 s18, s17, 8
    s_add_u32 s18, s18, 2304
    s_mov_b32 s24, 32
    s_mov_b32 s25, 64
L_interleave_layers__softmax_full_mha__ssm_conv_h3__prompt_kernel_t2j:
    s_mul_i32 s19, s8, 497664
    s_add_u32 s18, s18, s19
    s_waitcnt lgkmcnt(0)
    s_mov_b32 s4, s12
    s_and_b32 s5, s13, 0xffff
    s_mov_b32 s6, 0x10000000
    s_mov_b32 s7, 0x00020000
    s_mov_b32 s20, s14
    s_and_b32 s21, s15, 0xffff
    s_mov_b32 s22, 0x1e6000
    s_mov_b32 s23, 0x00020000
    s_lshl_b32 s26, s10, 6
    s_add_u32 s26, s26, 0
    v_add_u32 v3, s26, v2
    v_mul_u32_u24 v4, 3641, v3
    v_lshrrev_b32 v4, 16, v4
    v_mul_u32_u24 v5, 18, v4
    v_sub_u32 v5, v3, v5
    v_mul_u32_u24 v4, 3456, v4
    v_lshl_add_u32 v4, v5, 4, v4
    s_lshl_b32 m0, s26, 4
    s_nop 0
    buffer_load_dwordx4 v4, s[20:23], s18 offen lds
    s_lshl_b32 s26, s10, 6
    s_add_u32 s26, s26, 512
    v_add_u32 v3, s26, v2
    v_mul_u32_u24 v4, 3641, v3
    v_lshrrev_b32 v4, 16, v4
    v_mul_u32_u24 v5, 18, v4
    v_sub_u32 v5, v3, v5
    v_mul_u32_u24 v4, 3456, v4
    v_lshl_add_u32 v4, v5, 4, v4
    s_lshl_b32 m0, s26, 4
    s_nop 0
    buffer_load_dwordx4 v4, s[20:23], s18 offen lds
    s_lshl_b32 s26, s10, 6
    s_add_u32 s26, s26, 1024
    v_add_u32 v3, s26, v2
    v_mul_u32_u24 v4, 3641, v3
    v_lshrrev_b32 v4, 16, v4
    v_mul_u32_u24 v5, 18, v4
    v_sub_u32 v5, v3, v5
    v_mul_u32_u24 v4, 3456, v4
    v_lshl_add_u32 v4, v5, 4, v4
    s_lshl_b32 m0, s26, 4
    s_nop 0
    buffer_load_dwordx4 v4, s[20:23], s18 offen lds
    s_lshl_b32 s26, s10, 6
    s_add_u32 s26, s26, 1536
    v_add_u32 v3, s26, v2
    v_mul_u32_u24 v4, 3641, v3
    v_lshrrev_b32 v4, 16, v4
    v_mul_u32_u24 v5, 18, v4
    v_sub_u32 v5, v3, v5
    v_mul_u32_u24 v4, 3456, v4
    v_lshl_add_u32 v4, v5, 4, v4
    s_lshl_b32 m0, s26, 4
    s_nop 0
    buffer_load_dwordx4 v4, s[20:23], s18 offen lds
    s_lshl_b32 s26, s10, 6
    s_add_u32 s26, s26, 2048
    v_add_u32 v3, s26, v2
    v_mul_u32_u24 v4, 3641, v3
    v_lshrrev_b32 v4, 16, v4
    v_mul_u32_u24 v5, 18, v4
    v_sub_u32 v5, v3, v5
    v_mul_u32_u24 v4, 3456, v4
    v_lshl_add_u32 v4, v5, 4, v4
    s_lshl_b32 m0, s26, 4
    s_nop 0
    buffer_load_dwordx4 v4, s[20:23], s18 offen lds
    s_cmp_ge_u32 s10, 1
    s_cbranch_scc1 L_interleave_layers__softmax_full_mha__ssm_conv_h3__prompt_kernel_t2d
    s_lshl_b32 s26, s10, 6
    s_add_u32 s26, s26, 2560
    v_add_u32 v3, s26, v2
    v_mul_u32_u24 v4, 3641, v3
    v_lshrrev_b32 v4, 16, v4
    v_mul_u32_u24 v5, 18, v4
    v_sub_u32 v5, v3, v5
    v_mul_u32_u24 v4, 3456, v4
    v_lshl_add_u32 v4, v5, 4, v4
    s_lshl_b32 m0, s26, 4
    s_nop 0
    buffer_load_dwordx4 v4, s[20:23], s18 offen lds
L_interleave_layers__softmax_full_mha__ssm_conv_h3__prompt_kernel_t2d:
    s_and_b32 s26, s10, 3
    s_lshr_b32 s27, s10, 2
    v_lshrrev_b32 v3, 5, v2
    v_bfe_u32 v4, v2, 2, 2
    v_lshl_add_u32 v3, v3, 3, v4
    v_mul_u32_u24 v3, 288, v3
    s_mul_i32 s28, s26, s25
    s_mul_i32 s29, s27, 4608
    s_add_u32 s28, s28, s29
    v_add_u32 v3, s28, v3
    v_and_b32 v4, 3, v2
    v_lshl_add_u32 v5, v4, 3, v3
    v_bfe_u32 v4, v2, 4, 1
    v_mul_lo_u32 v4, v4, s24
    v_add_u32 v5, v5, v4
    v_add_u32 v6, 32, v3
    v_lshlrev_b32 v7, 4, v2
    s_mul_i32 s30, s8, 9
    s_add_u32 s30, s30, s27
    s_lshl_b32 s30, s30, 12
    s_mul_i32 s31, s9, 147456
    s_lshl_b32 s28, s26, 10
    s_add_u32 s31, s31, s28
    s_add_u32 s31, s31, s30
    s_add_u32 s31, s31, 25165824
    s_lshl_b32 s32, s17, 2
    s_add_u32 s32, s32, s26
    s_lshl_b32 s33, s16, 1
    s_lshr_b32 s28, s32, 3
    s_add_u32 s33, s33, s28
    s_and_b32 s32, s32, 7
    s_lshl_b32 s34, s33, 10
    s_lshl_b32 s28, s32, 6
    s_add_u32 s34, s34, s28
    s_add_u32 s34, s34, s30
    s_add_u32 s34, s34, 27082752
    v_mov_b32 v30, 0
    v_mov_b32 v31, 0
    s_waitcnt vmcnt(0)
    s_barrier
    ds_read_b64_tr_b16 v[32:33], v5 offset:0
    ds_read_b64_tr_b16 v[34:35], v5 offset:1152
    ds_read_b64_tr_b16 v[36:37], v6 offset:0
    ds_read_b64_tr_b16 v[38:39], v6 offset:1152
    ds_read_b64_tr_b16 v[40:41], v5 offset:9216
    ds_read_b64_tr_b16 v[42:43], v5 offset:10368
    ds_read_b64_tr_b16 v[44:45], v6 offset:9216
    ds_read_b64_tr_b16 v[46:47], v6 offset:10368
    ds_read_b64_tr_b16 v[48:49], v5 offset:18432
    ds_read_b64_tr_b16 v[50:51], v5 offset:19584
    ds_read_b64_tr_b16 v[52:53], v6 offset:18432
    ds_read_b64_tr_b16 v[54:55], v6 offset:19584
    ds_read_b64_tr_b16 v[56:57], v5 offset:27648
    ds_read_b64_tr_b16 v[58:59], v5 offset:28800
    ds_read_b64_tr_b16 v[60:61], v6 offset:27648
    ds_read_b64_tr_b16 v[62:63], v6 offset:28800
    s_cmp_ge_u32 s10, 4
    s_cbranch_scc1 L_interleave_layers__softmax_full_mha__ssm_conv_h3__prompt_kernel_t2r
    ds_read_b64_tr_b16 v[64:65], v5 offset:36864
    ds_read_b64_tr_b16 v[66:67], v5 offset:38016
    ds_read_b64_tr_b16 v[68:69], v6 offset:36864
    ds_read_b64_tr_b16 v[70:71], v6 offset:38016
L_interleave_layers__softmax_full_mha__ssm_conv_h3__prompt_kernel_t2r:
    s_waitcnt lgkmcnt(0)
    s_add_u32 s28, s31, 0
    buffer_store_dwordx4 v[32:35], v7, s[4:7], s28 offen
    s_cmp_eq_u32 s11, 0
    s_cbranch_scc0 L_interleave_layers__softmax_full_mha__ssm_conv_h3__prompt_kernel_t2x0
    s_add_u32 s28, s34, 0
    s_mov_b32 exec_lo, 15
    s_mov_b32 exec_hi, 15
    buffer_store_dwordx4 v[36:39], v7, s[4:7], s28 offen
    s_mov_b64 exec, -1
L_interleave_layers__softmax_full_mha__ssm_conv_h3__prompt_kernel_t2x0:
    v_lshlrev_b32 v20, 16, v32
    v_and_b32 v21, 0xffff0000, v32
    v_add_f32 v30, v30, v20
    v_add_f32 v30, v30, v21
    v_lshlrev_b32 v20, 16, v36
    v_and_b32 v21, 0xffff0000, v36
    v_add_f32 v31, v31, v20
    v_add_f32 v31, v31, v21
    v_lshlrev_b32 v20, 16, v33
    v_and_b32 v21, 0xffff0000, v33
    v_add_f32 v30, v30, v20
    v_add_f32 v30, v30, v21
    v_lshlrev_b32 v20, 16, v37
    v_and_b32 v21, 0xffff0000, v37
    v_add_f32 v31, v31, v20
    v_add_f32 v31, v31, v21
    v_lshlrev_b32 v20, 16, v34
    v_and_b32 v21, 0xffff0000, v34
    v_add_f32 v30, v30, v20
    v_add_f32 v30, v30, v21
    v_lshlrev_b32 v20, 16, v38
    v_and_b32 v21, 0xffff0000, v38
    v_add_f32 v31, v31, v20
    v_add_f32 v31, v31, v21
    v_lshlrev_b32 v20, 16, v35
    v_and_b32 v21, 0xffff0000, v35
    v_add_f32 v30, v30, v20
    v_add_f32 v30, v30, v21
    v_lshlrev_b32 v20, 16, v39
    v_and_b32 v21, 0xffff0000, v39
    v_add_f32 v31, v31, v20
    v_add_f32 v31, v31, v21
    s_add_u32 s28, s31, 8192
    buffer_store_dwordx4 v[40:43], v7, s[4:7], s28 offen
    s_cmp_eq_u32 s11, 0
    s_cbranch_scc0 L_interleave_layers__softmax_full_mha__ssm_conv_h3__prompt_kernel_t2x1
    s_add_u32 s28, s34, 8192
    s_mov_b32 exec_lo, 15
    s_mov_b32 exec_hi, 15
    buffer_store_dwordx4 v[44:47], v7, s[4:7], s28 offen
    s_mov_b64 exec, -1
L_interleave_layers__softmax_full_mha__ssm_conv_h3__prompt_kernel_t2x1:
    v_lshlrev_b32 v20, 16, v40
    v_and_b32 v21, 0xffff0000, v40
    v_add_f32 v30, v30, v20
    v_add_f32 v30, v30, v21
    v_lshlrev_b32 v20, 16, v44
    v_and_b32 v21, 0xffff0000, v44
    v_add_f32 v31, v31, v20
    v_add_f32 v31, v31, v21
    v_lshlrev_b32 v20, 16, v41
    v_and_b32 v21, 0xffff0000, v41
    v_add_f32 v30, v30, v20
    v_add_f32 v30, v30, v21
    v_lshlrev_b32 v20, 16, v45
    v_and_b32 v21, 0xffff0000, v45
    v_add_f32 v31, v31, v20
    v_add_f32 v31, v31, v21
    v_lshlrev_b32 v20, 16, v42
    v_and_b32 v21, 0xffff0000, v42
    v_add_f32 v30, v30, v20
    v_add_f32 v30, v30, v21
    v_lshlrev_b32 v20, 16, v46
    v_and_b32 v21, 0xffff0000, v46
    v_add_f32 v31, v31, v20
    v_add_f32 v31, v31, v21
    v_lshlrev_b32 v20, 16, v43
    v_and_b32 v21, 0xffff0000, v43
    v_add_f32 v30, v30, v20
    v_add_f32 v30, v30, v21
    v_lshlrev_b32 v20, 16, v47
    v_and_b32 v21, 0xffff0000, v47
    v_add_f32 v31, v31, v20
    v_add_f32 v31, v31, v21
    s_add_u32 s28, s31, 16384
    buffer_store_dwordx4 v[48:51], v7, s[4:7], s28 offen
    s_cmp_eq_u32 s11, 0
    s_cbranch_scc0 L_interleave_layers__softmax_full_mha__ssm_conv_h3__prompt_kernel_t2x2
    s_add_u32 s28, s34, 16384
    s_mov_b32 exec_lo, 15
    s_mov_b32 exec_hi, 15
    buffer_store_dwordx4 v[52:55], v7, s[4:7], s28 offen
    s_mov_b64 exec, -1
L_interleave_layers__softmax_full_mha__ssm_conv_h3__prompt_kernel_t2x2:
    v_lshlrev_b32 v20, 16, v48
    v_and_b32 v21, 0xffff0000, v48
    v_add_f32 v30, v30, v20
    v_add_f32 v30, v30, v21
    v_lshlrev_b32 v20, 16, v52
    v_and_b32 v21, 0xffff0000, v52
    v_add_f32 v31, v31, v20
    v_add_f32 v31, v31, v21
    v_lshlrev_b32 v20, 16, v49
    v_and_b32 v21, 0xffff0000, v49
    v_add_f32 v30, v30, v20
    v_add_f32 v30, v30, v21
    v_lshlrev_b32 v20, 16, v53
    v_and_b32 v21, 0xffff0000, v53
    v_add_f32 v31, v31, v20
    v_add_f32 v31, v31, v21
    v_lshlrev_b32 v20, 16, v50
    v_and_b32 v21, 0xffff0000, v50
    v_add_f32 v30, v30, v20
    v_add_f32 v30, v30, v21
    v_lshlrev_b32 v20, 16, v54
    v_and_b32 v21, 0xffff0000, v54
    v_add_f32 v31, v31, v20
    v_add_f32 v31, v31, v21
    v_lshlrev_b32 v20, 16, v51
    v_and_b32 v21, 0xffff0000, v51
    v_add_f32 v30, v30, v20
    v_add_f32 v30, v30, v21
    v_lshlrev_b32 v20, 16, v55
    v_and_b32 v21, 0xffff0000, v55
    v_add_f32 v31, v31, v20
    v_add_f32 v31, v31, v21
    s_add_u32 s28, s31, 24576
    buffer_store_dwordx4 v[56:59], v7, s[4:7], s28 offen
    s_cmp_eq_u32 s11, 0
    s_cbranch_scc0 L_interleave_layers__softmax_full_mha__ssm_conv_h3__prompt_kernel_t2x3
    s_add_u32 s28, s34, 24576
    s_mov_b32 exec_lo, 15
    s_mov_b32 exec_hi, 15
    buffer_store_dwordx4 v[60:63], v7, s[4:7], s28 offen
    s_mov_b64 exec, -1
L_interleave_layers__softmax_full_mha__ssm_conv_h3__prompt_kernel_t2x3:
    v_lshlrev_b32 v20, 16, v56
    v_and_b32 v21, 0xffff0000, v56
    v_add_f32 v30, v30, v20
    v_add_f32 v30, v30, v21
    v_lshlrev_b32 v20, 16, v60
    v_and_b32 v21, 0xffff0000, v60
    v_add_f32 v31, v31, v20
    v_add_f32 v31, v31, v21
    v_lshlrev_b32 v20, 16, v57
    v_and_b32 v21, 0xffff0000, v57
    v_add_f32 v30, v30, v20
    v_add_f32 v30, v30, v21
    v_lshlrev_b32 v20, 16, v61
    v_and_b32 v21, 0xffff0000, v61
    v_add_f32 v31, v31, v20
    v_add_f32 v31, v31, v21
    v_lshlrev_b32 v20, 16, v58
    v_and_b32 v21, 0xffff0000, v58
    v_add_f32 v30, v30, v20
    v_add_f32 v30, v30, v21
    v_lshlrev_b32 v20, 16, v62
    v_and_b32 v21, 0xffff0000, v62
    v_add_f32 v31, v31, v20
    v_add_f32 v31, v31, v21
    v_lshlrev_b32 v20, 16, v59
    v_and_b32 v21, 0xffff0000, v59
    v_add_f32 v30, v30, v20
    v_add_f32 v30, v30, v21
    v_lshlrev_b32 v20, 16, v63
    v_and_b32 v21, 0xffff0000, v63
    v_add_f32 v31, v31, v20
    v_add_f32 v31, v31, v21
    s_cmp_ge_u32 s10, 4
    s_cbranch_scc1 L_interleave_layers__softmax_full_mha__ssm_conv_h3__prompt_kernel_t2s
    s_add_u32 s28, s31, 32768
    buffer_store_dwordx4 v[64:67], v7, s[4:7], s28 offen
    s_cmp_eq_u32 s11, 0
    s_cbranch_scc0 L_interleave_layers__softmax_full_mha__ssm_conv_h3__prompt_kernel_t2x4
    s_add_u32 s28, s34, 32768
    s_mov_b32 exec_lo, 15
    s_mov_b32 exec_hi, 15
    buffer_store_dwordx4 v[68:71], v7, s[4:7], s28 offen
    s_mov_b64 exec, -1
L_interleave_layers__softmax_full_mha__ssm_conv_h3__prompt_kernel_t2x4:
    v_lshlrev_b32 v20, 16, v64
    v_and_b32 v21, 0xffff0000, v64
    v_add_f32 v30, v30, v20
    v_add_f32 v30, v30, v21
    v_lshlrev_b32 v20, 16, v68
    v_and_b32 v21, 0xffff0000, v68
    v_add_f32 v31, v31, v20
    v_add_f32 v31, v31, v21
    v_lshlrev_b32 v20, 16, v65
    v_and_b32 v21, 0xffff0000, v65
    v_add_f32 v30, v30, v20
    v_add_f32 v30, v30, v21
    v_lshlrev_b32 v20, 16, v69
    v_and_b32 v21, 0xffff0000, v69
    v_add_f32 v31, v31, v20
    v_add_f32 v31, v31, v21
    v_lshlrev_b32 v20, 16, v66
    v_and_b32 v21, 0xffff0000, v66
    v_add_f32 v30, v30, v20
    v_add_f32 v30, v30, v21
    v_lshlrev_b32 v20, 16, v70
    v_and_b32 v21, 0xffff0000, v70
    v_add_f32 v31, v31, v20
    v_add_f32 v31, v31, v21
    v_lshlrev_b32 v20, 16, v67
    v_and_b32 v21, 0xffff0000, v67
    v_add_f32 v30, v30, v20
    v_add_f32 v30, v30, v21
    v_lshlrev_b32 v20, 16, v71
    v_and_b32 v21, 0xffff0000, v71
    v_add_f32 v31, v31, v20
    v_add_f32 v31, v31, v21
L_interleave_layers__softmax_full_mha__ssm_conv_h3__prompt_kernel_t2s:
    v_mov_b32 v20, v30
    v_mov_b32 v21, v31
    s_nop 1
    v_permlane32_swap_b32 v20, v30
    v_permlane32_swap_b32 v21, v31
    s_nop 1
    v_add_f32 v30, v30, v20
    v_add_f32 v31, v31, v21
    s_lshl_b32 s30, s10, 8
    v_and_b32 v3, 31, v2
    v_lshlrev_b32 v22, 2, v3
    v_add_u32 v23, s30, v22
    ds_write_b32 v23, v30 offset:41984
    ds_write_b32 v23, v31 offset:42112
    s_waitcnt lgkmcnt(0)
    s_barrier
    s_cmp_ge_u32 s10, 4
    s_cbranch_scc1 L_interleave_layers__softmax_full_mha__ssm_conv_h3__prompt_kernel_exit
    ds_read_b32 v24, v23 offset:43008
    ds_read_b32 v25, v23 offset:43136
    s_mul_i32 s30, s8, 7168
    s_add_u32 s30, s30, 21495808
    s_lshl_b32 s31, s9, 9
    s_lshl_b32 s28, s26, 7
    s_add_u32 s31, s31, s28
    s_add_u32 s31, s31, s30
    s_waitcnt lgkmcnt(0)
    v_add_f32 v30, v30, v24
    v_add_f32 v31, v31, v25
    s_mov_b32 exec_hi, 0
    buffer_store_dword v30, v22, s[4:7], s31 offen
    s_mov_b64 exec, -1
    s_cmp_eq_u32 s11, 1
    s_cbranch_scc1 L_interleave_layers__softmax_full_mha__ssm_conv_h3__prompt_kernel_exit
    s_lshl_b32 s31, s33, 7
    s_lshl_b32 s28, s32, 4
    s_add_u32 s31, s31, s28
    s_add_u32 s31, s31, s30
    s_add_u32 s31, s31, 6656
    s_mov_b64 exec, 15
    buffer_store_dword v31, v22, s[4:7], s31 offen
    s_mov_b64 exec, -1
    s_branch L_interleave_layers__softmax_full_mha__ssm_conv_h3__prompt_kernel_exit
L_interleave_layers__softmax_full_mha__ssm_conv_h3__prompt_kernel_t1:
    s_load_dwordx2 s[14:15], s[0:1], 0
    s_lshl_b32 s8, s3, 6
    s_mov_b32 s62, 1
    s_lshr_b32 s60, s3, 1
    s_add_u32 s60, s60, 16
    s_mov_b32 s61, -1
    s_lshl_b32 s9, s10, 3
    s_add_u32 s8, s8, s9
    v_lshrrev_b32 v3, 3, v2
    v_and_b32 v4, 7, v2
    v_mul_u32_u24 v5, 1152, v3
    v_lshl_add_u32 v5, v4, 4, v5
    s_mul_i32 s16, s8, 1152
    s_waitcnt lgkmcnt(0)
    s_mov_b32 s4, s12
    s_and_b32 s5, s13, 0xffff
    s_mov_b32 s6, 0x10000000
    s_mov_b32 s7, 0x00020000
    s_mov_b32 s20, s14
    s_and_b32 s21, s15, 0xffff
    s_mov_b32 s22, 0x240000
    s_mov_b32 s23, 0x00020000
    buffer_load_dwordx4 v[8:11], v5, s[20:23], s16 offen offset:0
    buffer_load_dwordx4 v[12:15], v5, s[20:23], s16 offen offset:128
    buffer_load_dwordx4 v[16:19], v5, s[20:23], s16 offen offset:256
    buffer_load_dwordx4 v[20:23], v5, s[20:23], s16 offen offset:384
    buffer_load_dwordx4 v[24:27], v5, s[20:23], s16 offen offset:512
    buffer_load_dwordx4 v[28:31], v5, s[20:23], s16 offen offset:640
    buffer_load_dwordx4 v[32:35], v5, s[20:23], s16 offen offset:768
    buffer_load_dwordx4 v[36:39], v5, s[20:23], s16 offen offset:896
    buffer_load_dwordx4 v[40:43], v5, s[20:23], s16 offen offset:1024
    v_mov_b32 v44, 0
    v_mov_b32 v45, 0
    v_mul_u32_u24 v6, 48, v3
    v_lshl_add_u32 v6, v4, 3, v6
    s_mul_i32 s17, s8, 48
    v_mov_b32 v48, 0
    v_mov_b32 v49, 0
    v_cmp_gt_u32 vcc, 6, v4
    s_add_u32 s18, s17, 22020096
    s_add_u32 s19, s17, 22118400
    s_mov_b64 exec, vcc
    buffer_store_dwordx2 v[48:49], v6, s[4:7], s18 offen
    buffer_store_dwordx2 v[48:49], v6, s[4:7], s19 offen
    s_mov_b64 exec, -1
    s_lshl_b32 s26, s3, 3
    s_add_u32 s26, s26, s10
    s_lshl_b32 s26, s26, 10
    v_mov_b32 v52, 0
    v_mov_b32 v53, 0
    v_mov_b32 v54, 0
    v_mov_b32 v55, 0
    v_lshlrev_b32 v50, 4, v2
    v_add_u32 v50, s26, v50
    s_add_u32 s24, s12, 22544384
    s_addc_u32 s25, s13, 0
    s_and_b32 s25, s25, 0xffff
    s_mov_b32 s26, 655360
    s_mov_b32 s27, 0x00020000
    s_mov_b32 s28, 262144
    s_mov_b32 s29, 524288
    buffer_store_dwordx4 v[52:55], v50, s[24:27], 0 offen
    buffer_store_dwordx4 v[52:55], v50, s[24:27], s28 offen
    buffer_store_dwordx4 v[52:55], v50, s[24:27], s29 offen
    s_waitcnt vmcnt(13)
    v_lshlrev_b32 v46, 16, v8
    v_and_b32 v47, 0xffff0000, v8
    v_add_f32 v44, v44, v46
    v_fmac_f32 v45, v46, v46
    v_add_f32 v44, v44, v47
    v_fmac_f32 v45, v47, v47
    v_lshlrev_b32 v46, 16, v9
    v_and_b32 v47, 0xffff0000, v9
    v_add_f32 v44, v44, v46
    v_fmac_f32 v45, v46, v46
    v_add_f32 v44, v44, v47
    v_fmac_f32 v45, v47, v47
    v_lshlrev_b32 v46, 16, v10
    v_and_b32 v47, 0xffff0000, v10
    v_add_f32 v44, v44, v46
    v_fmac_f32 v45, v46, v46
    v_add_f32 v44, v44, v47
    v_fmac_f32 v45, v47, v47
    v_lshlrev_b32 v46, 16, v11
    v_and_b32 v47, 0xffff0000, v11
    v_add_f32 v44, v44, v46
    v_fmac_f32 v45, v46, v46
    v_add_f32 v44, v44, v47
    v_fmac_f32 v45, v47, v47
    s_waitcnt vmcnt(12)
    v_lshlrev_b32 v46, 16, v12
    v_and_b32 v47, 0xffff0000, v12
    v_add_f32 v44, v44, v46
    v_fmac_f32 v45, v46, v46
    v_add_f32 v44, v44, v47
    v_fmac_f32 v45, v47, v47
    v_lshlrev_b32 v46, 16, v13
    v_and_b32 v47, 0xffff0000, v13
    v_add_f32 v44, v44, v46
    v_fmac_f32 v45, v46, v46
    v_add_f32 v44, v44, v47
    v_fmac_f32 v45, v47, v47
    v_lshlrev_b32 v46, 16, v14
    v_and_b32 v47, 0xffff0000, v14
    v_add_f32 v44, v44, v46
    v_fmac_f32 v45, v46, v46
    v_add_f32 v44, v44, v47
    v_fmac_f32 v45, v47, v47
    v_lshlrev_b32 v46, 16, v15
    v_and_b32 v47, 0xffff0000, v15
    v_add_f32 v44, v44, v46
    v_fmac_f32 v45, v46, v46
    v_add_f32 v44, v44, v47
    v_fmac_f32 v45, v47, v47
    s_waitcnt vmcnt(11)
    v_lshlrev_b32 v46, 16, v16
    v_and_b32 v47, 0xffff0000, v16
    v_add_f32 v44, v44, v46
    v_fmac_f32 v45, v46, v46
    v_add_f32 v44, v44, v47
    v_fmac_f32 v45, v47, v47
    v_lshlrev_b32 v46, 16, v17
    v_and_b32 v47, 0xffff0000, v17
    v_add_f32 v44, v44, v46
    v_fmac_f32 v45, v46, v46
    v_add_f32 v44, v44, v47
    v_fmac_f32 v45, v47, v47
    v_lshlrev_b32 v46, 16, v18
    v_and_b32 v47, 0xffff0000, v18
    v_add_f32 v44, v44, v46
    v_fmac_f32 v45, v46, v46
    v_add_f32 v44, v44, v47
    v_fmac_f32 v45, v47, v47
    v_lshlrev_b32 v46, 16, v19
    v_and_b32 v47, 0xffff0000, v19
    v_add_f32 v44, v44, v46
    v_fmac_f32 v45, v46, v46
    v_add_f32 v44, v44, v47
    v_fmac_f32 v45, v47, v47
    s_waitcnt vmcnt(10)
    v_lshlrev_b32 v46, 16, v20
    v_and_b32 v47, 0xffff0000, v20
    v_add_f32 v44, v44, v46
    v_fmac_f32 v45, v46, v46
    v_add_f32 v44, v44, v47
    v_fmac_f32 v45, v47, v47
    v_lshlrev_b32 v46, 16, v21
    v_and_b32 v47, 0xffff0000, v21
    v_add_f32 v44, v44, v46
    v_fmac_f32 v45, v46, v46
    v_add_f32 v44, v44, v47
    v_fmac_f32 v45, v47, v47
    v_lshlrev_b32 v46, 16, v22
    v_and_b32 v47, 0xffff0000, v22
    v_add_f32 v44, v44, v46
    v_fmac_f32 v45, v46, v46
    v_add_f32 v44, v44, v47
    v_fmac_f32 v45, v47, v47
    v_lshlrev_b32 v46, 16, v23
    v_and_b32 v47, 0xffff0000, v23
    v_add_f32 v44, v44, v46
    v_fmac_f32 v45, v46, v46
    v_add_f32 v44, v44, v47
    v_fmac_f32 v45, v47, v47
    s_waitcnt vmcnt(9)
    v_lshlrev_b32 v46, 16, v24
    v_and_b32 v47, 0xffff0000, v24
    v_add_f32 v44, v44, v46
    v_fmac_f32 v45, v46, v46
    v_add_f32 v44, v44, v47
    v_fmac_f32 v45, v47, v47
    v_lshlrev_b32 v46, 16, v25
    v_and_b32 v47, 0xffff0000, v25
    v_add_f32 v44, v44, v46
    v_fmac_f32 v45, v46, v46
    v_add_f32 v44, v44, v47
    v_fmac_f32 v45, v47, v47
    v_lshlrev_b32 v46, 16, v26
    v_and_b32 v47, 0xffff0000, v26
    v_add_f32 v44, v44, v46
    v_fmac_f32 v45, v46, v46
    v_add_f32 v44, v44, v47
    v_fmac_f32 v45, v47, v47
    v_lshlrev_b32 v46, 16, v27
    v_and_b32 v47, 0xffff0000, v27
    v_add_f32 v44, v44, v46
    v_fmac_f32 v45, v46, v46
    v_add_f32 v44, v44, v47
    v_fmac_f32 v45, v47, v47
    s_waitcnt vmcnt(8)
    v_lshlrev_b32 v46, 16, v28
    v_and_b32 v47, 0xffff0000, v28
    v_add_f32 v44, v44, v46
    v_fmac_f32 v45, v46, v46
    v_add_f32 v44, v44, v47
    v_fmac_f32 v45, v47, v47
    v_lshlrev_b32 v46, 16, v29
    v_and_b32 v47, 0xffff0000, v29
    v_add_f32 v44, v44, v46
    v_fmac_f32 v45, v46, v46
    v_add_f32 v44, v44, v47
    v_fmac_f32 v45, v47, v47
    v_lshlrev_b32 v46, 16, v30
    v_and_b32 v47, 0xffff0000, v30
    v_add_f32 v44, v44, v46
    v_fmac_f32 v45, v46, v46
    v_add_f32 v44, v44, v47
    v_fmac_f32 v45, v47, v47
    v_lshlrev_b32 v46, 16, v31
    v_and_b32 v47, 0xffff0000, v31
    v_add_f32 v44, v44, v46
    v_fmac_f32 v45, v46, v46
    v_add_f32 v44, v44, v47
    v_fmac_f32 v45, v47, v47
    s_waitcnt vmcnt(7)
    v_lshlrev_b32 v46, 16, v32
    v_and_b32 v47, 0xffff0000, v32
    v_add_f32 v44, v44, v46
    v_fmac_f32 v45, v46, v46
    v_add_f32 v44, v44, v47
    v_fmac_f32 v45, v47, v47
    v_lshlrev_b32 v46, 16, v33
    v_and_b32 v47, 0xffff0000, v33
    v_add_f32 v44, v44, v46
    v_fmac_f32 v45, v46, v46
    v_add_f32 v44, v44, v47
    v_fmac_f32 v45, v47, v47
    v_lshlrev_b32 v46, 16, v34
    v_and_b32 v47, 0xffff0000, v34
    v_add_f32 v44, v44, v46
    v_fmac_f32 v45, v46, v46
    v_add_f32 v44, v44, v47
    v_fmac_f32 v45, v47, v47
    v_lshlrev_b32 v46, 16, v35
    v_and_b32 v47, 0xffff0000, v35
    v_add_f32 v44, v44, v46
    v_fmac_f32 v45, v46, v46
    v_add_f32 v44, v44, v47
    v_fmac_f32 v45, v47, v47
    s_waitcnt vmcnt(6)
    v_lshlrev_b32 v46, 16, v36
    v_and_b32 v47, 0xffff0000, v36
    v_add_f32 v44, v44, v46
    v_fmac_f32 v45, v46, v46
    v_add_f32 v44, v44, v47
    v_fmac_f32 v45, v47, v47
    v_lshlrev_b32 v46, 16, v37
    v_and_b32 v47, 0xffff0000, v37
    v_add_f32 v44, v44, v46
    v_fmac_f32 v45, v46, v46
    v_add_f32 v44, v44, v47
    v_fmac_f32 v45, v47, v47
    v_lshlrev_b32 v46, 16, v38
    v_and_b32 v47, 0xffff0000, v38
    v_add_f32 v44, v44, v46
    v_fmac_f32 v45, v46, v46
    v_add_f32 v44, v44, v47
    v_fmac_f32 v45, v47, v47
    v_lshlrev_b32 v46, 16, v39
    v_and_b32 v47, 0xffff0000, v39
    v_add_f32 v44, v44, v46
    v_fmac_f32 v45, v46, v46
    v_add_f32 v44, v44, v47
    v_fmac_f32 v45, v47, v47
    s_waitcnt vmcnt(5)
    v_lshlrev_b32 v46, 16, v40
    v_and_b32 v47, 0xffff0000, v40
    v_add_f32 v44, v44, v46
    v_fmac_f32 v45, v46, v46
    v_add_f32 v44, v44, v47
    v_fmac_f32 v45, v47, v47
    v_lshlrev_b32 v46, 16, v41
    v_and_b32 v47, 0xffff0000, v41
    v_add_f32 v44, v44, v46
    v_fmac_f32 v45, v46, v46
    v_add_f32 v44, v44, v47
    v_fmac_f32 v45, v47, v47
    v_lshlrev_b32 v46, 16, v42
    v_and_b32 v47, 0xffff0000, v42
    v_add_f32 v44, v44, v46
    v_fmac_f32 v45, v46, v46
    v_add_f32 v44, v44, v47
    v_fmac_f32 v45, v47, v47
    v_lshlrev_b32 v46, 16, v43
    v_and_b32 v47, 0xffff0000, v43
    v_add_f32 v44, v44, v46
    v_fmac_f32 v45, v46, v46
    v_add_f32 v44, v44, v47
    v_fmac_f32 v45, v47, v47
    s_nop 1
    v_add_f32_dpp v44, v44, v44 quad_perm:[1,0,3,2] row_mask:0xf bank_mask:0xf
    v_add_f32_dpp v45, v45, v45 quad_perm:[1,0,3,2] row_mask:0xf bank_mask:0xf
    s_nop 1
    v_add_f32_dpp v44, v44, v44 quad_perm:[2,3,0,1] row_mask:0xf bank_mask:0xf
    v_add_f32_dpp v45, v45, v45 quad_perm:[2,3,0,1] row_mask:0xf bank_mask:0xf
    s_nop 1
    v_add_f32_dpp v44, v44, v44 row_half_mirror row_mask:0xf bank_mask:0xf
    v_add_f32_dpp v45, v45, v45 row_half_mirror row_mask:0xf bank_mask:0xf
    v_cmp_eq_u32 vcc, 0, v4
    s_add_u32 s17, s17, 20971520
    s_nop 1
    v_cndmask_b32 v44, 0, v44, vcc
    v_cndmask_b32 v45, 0, v45, vcc
    v_cmp_gt_u32 vcc, 6, v4
    s_nop 4
    s_mov_b64 exec, vcc
    buffer_store_dwordx2 v[44:45], v6, s[4:7], s17 offen
    s_mov_b64 exec, -1
    s_branch L_interleave_layers__softmax_full_mha__ssm_conv_h3__prompt_kernel_exit
L_interleave_layers__softmax_full_mha__ssm_conv_h3__prompt_kernel_t4:
    s_load_dwordx2 s[14:15], s[0:1], 32
    s_load_dwordx2 s[16:17], s[0:1], 40
    s_load_dwordx2 s[18:19], s[0:1], 48
    s_mov_b32 s8, s3
    s_mul_i32 s9, s8, 57
    s_lshr_b32 s9, s9, 9
    s_mul_i32 s11, s9, 9
    s_sub_u32 s8, s8, s11
    s_mov_b32 s62, 4
    s_add_u32 s60, s8, 32
    s_mov_b32 s61, -1
    v_lshrrev_b32 v3, 3, v0
    v_and_b32 v4, 7, v0
    s_lshl_b32 s11, s8, 7
    v_lshlrev_b32 v5, 4, v4
    v_add_u32 v5, s11, v5
    v_lshlrev_b32 v6, 2, v5
    s_waitcnt lgkmcnt(0)
    s_mov_b32 s4, s12
    s_and_b32 s5, s13, 0xffff
    s_mov_b32 s6, 0x10000000
    s_mov_b32 s7, 0x00020000
    s_mov_b32 s20, s14
    s_and_b32 s21, s15, 0xffff
    s_mov_b32 s22, 0x240000
    s_mov_b32 s23, 0x00020000
    s_mov_b32 s24, s16
    s_and_b32 s25, s17, 0xffff
    s_mov_b32 s26, 0x240000
    s_mov_b32 s27, 0x00020000
    s_mov_b32 s28, s18
    s_and_b32 s29, s19, 0xffff
    s_mov_b32 s30, 0x1200
    s_mov_b32 s31, 0x00020000
    buffer_load_dwordx4 v[44:47], v6, s[28:31], 0 offen offset:0
    buffer_load_dwordx4 v[48:51], v6, s[28:31], 0 offen offset:16
    buffer_load_dwordx4 v[52:55], v6, s[28:31], 0 offen offset:32
    buffer_load_dwordx4 v[56:59], v6, s[28:31], 0 offen offset:48
    s_lshl_b32 s33, s9, 7
    v_lshlrev_b32 v7, 1, v3
    v_add_u32 v7, 0, v7
    v_add_u32 v8, s33, v7
    v_subrev_u32 v9, 3, v8
    v_mul_u32_u24 v10, 1152, v9
    v_add_u32 v10, v10, v5
    v_cmp_gt_i32 vcc, 0, v9
    v_mov_b32 v11, 0x80000000
    s_nop 0
    v_cndmask_b32 v10, v10, v11, vcc
    buffer_load_dwordx4 v[16:19], v10, s[20:23], 0 offen
    v_subrev_u32 v9, 2, v8
    v_mul_u32_u24 v10, 1152, v9
    v_add_u32 v10, v10, v5
    v_cmp_gt_i32 vcc, 0, v9
    v_mov_b32 v11, 0x80000000
    s_nop 0
    v_cndmask_b32 v10, v10, v11, vcc
    buffer_load_dwordx4 v[20:23], v10, s[20:23], 0 offen
    v_subrev_u32 v9, 1, v8
    v_mul_u32_u24 v10, 1152, v9
    v_add_u32 v10, v10, v5
    v_cmp_gt_i32 vcc, 0, v9
    v_mov_b32 v11, 0x80000000
    s_nop 0
    v_cndmask_b32 v10, v10, v11, vcc
    buffer_load_dwordx4 v[24:27], v10, s[20:23], 0 offen
    v_subrev_u32 v9, 0, v8
    v_mul_u32_u24 v10, 1152, v9
    v_add_u32 v10, v10, v5
    v_cmp_gt_i32 vcc, 0, v9
    v_mov_b32 v11, 0x80000000
    s_nop 0
    v_cndmask_b32 v10, v10, v11, vcc
    buffer_load_dwordx4 v[28:31], v10, s[20:23], 0 offen
    v_add_u32 v9, 1, v8
    v_mul_u32_u24 v10, 1152, v9
    v_add_u32 v10, v10, v5
    v_cmp_gt_i32 vcc, 0, v9
    v_mov_b32 v11, 0x80000000
    s_nop 0
    v_cndmask_b32 v10, v10, v11, vcc
    buffer_load_dwordx4 v[32:35], v10, s[20:23], 0 offen
    v_mul_u32_u24 v10, 1152, v8
    v_add_u32 v10, v10, v5
    buffer_load_dwordx4 v[36:39], v10, s[24:27], 0 offen
    buffer_load_dwordx4 v[40:43], v10, s[24:27], 0 offen offset:1152
    v_lshrrev_b32 v12, 1, v7
    v_and_b32 v13, 7, v12
    v_sub_u32 v13, 7, v13
    v_and_b32 v12, 0x38, v12
    v_add_u32 v12, v12, v13
    v_lshlrev_b32 v12, 2, v12
    v_mul_u32_u24 v13, 2080, v4
    v_add_u32 v12, v12, v13
    s_waitcnt vmcnt(0)
    v_lshlrev_b32 v60, 16, v16
    v_lshlrev_b32 v61, 16, v20
    v_lshlrev_b32 v62, 16, v24
    v_lshlrev_b32 v63, 16, v28
    v_lshlrev_b32 v64, 16, v32
    v_lshlrev_b32 v65, 16, v36
    v_lshlrev_b32 v66, 16, v40
    v_lshlrev_b32 v67, 16, v44
    v_and_b32 v68, 0xffff0000, v44
    v_lshlrev_b32 v69, 16, v45
    v_and_b32 v70, 0xffff0000, v45
    v_mul_f32 v71, v60, v70
    v_mul_f32 v72, v61, v70
    v_fmac_f32 v71, v61, v69
    v_fmac_f32 v72, v62, v69
    v_fmac_f32 v71, v62, v68
    v_fmac_f32 v72, v63, v68
    v_fmac_f32 v71, v63, v67
    v_fmac_f32 v72, v64, v67
    v_mul_f32 v71, v71, v65
    v_mul_f32 v72, v72, v66
    v_cvt_pk_bf16_f32 v73, v72, v71
    ds_write_b32 v12, v73 offset:0
    v_and_b32 v60, 0xffff0000, v16
    v_and_b32 v61, 0xffff0000, v20
    v_and_b32 v62, 0xffff0000, v24
    v_and_b32 v63, 0xffff0000, v28
    v_and_b32 v64, 0xffff0000, v32
    v_and_b32 v65, 0xffff0000, v36
    v_and_b32 v66, 0xffff0000, v40
    v_lshlrev_b32 v67, 16, v46
    v_and_b32 v68, 0xffff0000, v46
    v_lshlrev_b32 v69, 16, v47
    v_and_b32 v70, 0xffff0000, v47
    v_mul_f32 v71, v60, v70
    v_mul_f32 v72, v61, v70
    v_fmac_f32 v71, v61, v69
    v_fmac_f32 v72, v62, v69
    v_fmac_f32 v71, v62, v68
    v_fmac_f32 v72, v63, v68
    v_fmac_f32 v71, v63, v67
    v_fmac_f32 v72, v64, v67
    v_mul_f32 v71, v71, v65
    v_mul_f32 v72, v72, v66
    v_cvt_pk_bf16_f32 v73, v72, v71
    ds_write_b32 v12, v73 offset:260
    v_lshlrev_b32 v60, 16, v17
    v_lshlrev_b32 v61, 16, v21
    v_lshlrev_b32 v62, 16, v25
    v_lshlrev_b32 v63, 16, v29
    v_lshlrev_b32 v64, 16, v33
    v_lshlrev_b32 v65, 16, v37
    v_lshlrev_b32 v66, 16, v41
    v_lshlrev_b32 v67, 16, v48
    v_and_b32 v68, 0xffff0000, v48
    v_lshlrev_b32 v69, 16, v49
    v_and_b32 v70, 0xffff0000, v49
    v_mul_f32 v71, v60, v70
    v_mul_f32 v72, v61, v70
    v_fmac_f32 v71, v61, v69
    v_fmac_f32 v72, v62, v69
    v_fmac_f32 v71, v62, v68
    v_fmac_f32 v72, v63, v68
    v_fmac_f32 v71, v63, v67
    v_fmac_f32 v72, v64, v67
    v_mul_f32 v71, v71, v65
    v_mul_f32 v72, v72, v66
    v_cvt_pk_bf16_f32 v73, v72, v71
    ds_write_b32 v12, v73 offset:520
    v_and_b32 v60, 0xffff0000, v17
    v_and_b32 v61, 0xffff0000, v21
    v_and_b32 v62, 0xffff0000, v25
    v_and_b32 v63, 0xffff0000, v29
    v_and_b32 v64, 0xffff0000, v33
    v_and_b32 v65, 0xffff0000, v37
    v_and_b32 v66, 0xffff0000, v41
    v_lshlrev_b32 v67, 16, v50
    v_and_b32 v68, 0xffff0000, v50
    v_lshlrev_b32 v69, 16, v51
    v_and_b32 v70, 0xffff0000, v51
    v_mul_f32 v71, v60, v70
    v_mul_f32 v72, v61, v70
    v_fmac_f32 v71, v61, v69
    v_fmac_f32 v72, v62, v69
    v_fmac_f32 v71, v62, v68
    v_fmac_f32 v72, v63, v68
    v_fmac_f32 v71, v63, v67
    v_fmac_f32 v72, v64, v67
    v_mul_f32 v71, v71, v65
    v_mul_f32 v72, v72, v66
    v_cvt_pk_bf16_f32 v73, v72, v71
    ds_write_b32 v12, v73 offset:780
    v_lshlrev_b32 v60, 16, v18
    v_lshlrev_b32 v61, 16, v22
    v_lshlrev_b32 v62, 16, v26
    v_lshlrev_b32 v63, 16, v30
    v_lshlrev_b32 v64, 16, v34
    v_lshlrev_b32 v65, 16, v38
    v_lshlrev_b32 v66, 16, v42
    v_lshlrev_b32 v67, 16, v52
    v_and_b32 v68, 0xffff0000, v52
    v_lshlrev_b32 v69, 16, v53
    v_and_b32 v70, 0xffff0000, v53
    v_mul_f32 v71, v60, v70
    v_mul_f32 v72, v61, v70
    v_fmac_f32 v71, v61, v69
    v_fmac_f32 v72, v62, v69
    v_fmac_f32 v71, v62, v68
    v_fmac_f32 v72, v63, v68
    v_fmac_f32 v71, v63, v67
    v_fmac_f32 v72, v64, v67
    v_mul_f32 v71, v71, v65
    v_mul_f32 v72, v72, v66
    v_cvt_pk_bf16_f32 v73, v72, v71
    ds_write_b32 v12, v73 offset:1040
    v_and_b32 v60, 0xffff0000, v18
    v_and_b32 v61, 0xffff0000, v22
    v_and_b32 v62, 0xffff0000, v26
    v_and_b32 v63, 0xffff0000, v30
    v_and_b32 v64, 0xffff0000, v34
    v_and_b32 v65, 0xffff0000, v38
    v_and_b32 v66, 0xffff0000, v42
    v_lshlrev_b32 v67, 16, v54
    v_and_b32 v68, 0xffff0000, v54
    v_lshlrev_b32 v69, 16, v55
    v_and_b32 v70, 0xffff0000, v55
    v_mul_f32 v71, v60, v70
    v_mul_f32 v72, v61, v70
    v_fmac_f32 v71, v61, v69
    v_fmac_f32 v72, v62, v69
    v_fmac_f32 v71, v62, v68
    v_fmac_f32 v72, v63, v68
    v_fmac_f32 v71, v63, v67
    v_fmac_f32 v72, v64, v67
    v_mul_f32 v71, v71, v65
    v_mul_f32 v72, v72, v66
    v_cvt_pk_bf16_f32 v73, v72, v71
    ds_write_b32 v12, v73 offset:1300
    v_lshlrev_b32 v60, 16, v19
    v_lshlrev_b32 v61, 16, v23
    v_lshlrev_b32 v62, 16, v27
    v_lshlrev_b32 v63, 16, v31
    v_lshlrev_b32 v64, 16, v35
    v_lshlrev_b32 v65, 16, v39
    v_lshlrev_b32 v66, 16, v43
    v_lshlrev_b32 v67, 16, v56
    v_and_b32 v68, 0xffff0000, v56
    v_lshlrev_b32 v69, 16, v57
    v_and_b32 v70, 0xffff0000, v57
    v_mul_f32 v71, v60, v70
    v_mul_f32 v72, v61, v70
    v_fmac_f32 v71, v61, v69
    v_fmac_f32 v72, v62, v69
    v_fmac_f32 v71, v62, v68
    v_fmac_f32 v72, v63, v68
    v_fmac_f32 v71, v63, v67
    v_fmac_f32 v72, v64, v67
    v_mul_f32 v71, v71, v65
    v_mul_f32 v72, v72, v66
    v_cvt_pk_bf16_f32 v73, v72, v71
    ds_write_b32 v12, v73 offset:1560
    v_and_b32 v60, 0xffff0000, v19
    v_and_b32 v61, 0xffff0000, v23
    v_and_b32 v62, 0xffff0000, v27
    v_and_b32 v63, 0xffff0000, v31
    v_and_b32 v64, 0xffff0000, v35
    v_and_b32 v65, 0xffff0000, v39
    v_and_b32 v66, 0xffff0000, v43
    v_lshlrev_b32 v67, 16, v58
    v_and_b32 v68, 0xffff0000, v58
    v_lshlrev_b32 v69, 16, v59
    v_and_b32 v70, 0xffff0000, v59
    v_mul_f32 v71, v60, v70
    v_mul_f32 v72, v61, v70
    v_fmac_f32 v71, v61, v69
    v_fmac_f32 v72, v62, v69
    v_fmac_f32 v71, v62, v68
    v_fmac_f32 v72, v63, v68
    v_fmac_f32 v71, v63, v67
    v_fmac_f32 v72, v64, v67
    v_mul_f32 v71, v71, v65
    v_mul_f32 v72, v72, v66
    v_cvt_pk_bf16_f32 v73, v72, v71
    ds_write_b32 v12, v73 offset:1820
    s_waitcnt lgkmcnt(0)
    s_barrier
    v_lshlrev_b32 v3, 2, v2
    s_mul_i32 s33, s10, 2080
    v_add_u32 v4, s33, v3
    s_lshl_b32 s34, s8, 6
    s_lshl_b32 s35, s10, 3
    s_add_u32 s34, s34, s35
    s_lshl_b32 s34, s34, 12
    s_lshl_b32 s35, s9, 8
    s_add_u32 s34, s34, s35
    s_add_u32 s34, s34, 17825792
    ds_read_b32 v8, v4 offset:0
    ds_read_b32 v9, v4 offset:260
    ds_read_b32 v10, v4 offset:520
    ds_read_b32 v11, v4 offset:780
    ds_read_b32 v12, v4 offset:1040
    ds_read_b32 v13, v4 offset:1300
    ds_read_b32 v14, v4 offset:1560
    ds_read_b32 v15, v4 offset:1820
    s_waitcnt lgkmcnt(7)
    buffer_store_dword v8, v3, s[4:7], s34 offen
    s_add_u32 s34, s34, 4096
    s_waitcnt lgkmcnt(6)
    buffer_store_dword v9, v3, s[4:7], s34 offen
    s_add_u32 s34, s34, 4096
    s_waitcnt lgkmcnt(5)
    buffer_store_dword v10, v3, s[4:7], s34 offen
    s_add_u32 s34, s34, 4096
    s_waitcnt lgkmcnt(4)
    buffer_store_dword v11, v3, s[4:7], s34 offen
    s_add_u32 s34, s34, 4096
    s_waitcnt lgkmcnt(3)
    buffer_store_dword v12, v3, s[4:7], s34 offen
    s_add_u32 s34, s34, 4096
    s_waitcnt lgkmcnt(2)
    buffer_store_dword v13, v3, s[4:7], s34 offen
    s_add_u32 s34, s34, 4096
    s_waitcnt lgkmcnt(1)
    buffer_store_dword v14, v3, s[4:7], s34 offen
    s_add_u32 s34, s34, 4096
    s_waitcnt lgkmcnt(0)
    buffer_store_dword v15, v3, s[4:7], s34 offen
    s_add_u32 s34, s34, 4096
L_interleave_layers__softmax_full_mha__ssm_conv_h3__prompt_kernel_exit:
L_interleave_layers__softmax_full_mha__ssm_conv_h3__prompt_kernel_exit2:
    s_endpgm
.section .rodata,"a"
.p2align 6
.amdhsa_kernel interleave_layers__softmax_full_mha__ssm_conv_h3__prompt_kernel
.amdhsa_next_free_vgpr 80
.amdhsa_next_free_sgpr 102
.amdhsa_accum_offset 80
.amdhsa_group_segment_fixed_size 0
.amdhsa_kernarg_size 96
.amdhsa_user_sgpr_count 2
.amdhsa_user_sgpr_kernarg_segment_ptr 1
.amdhsa_system_sgpr_workgroup_id_x 1
.amdhsa_float_denorm_mode_32 3
.end_amdhsa_kernel
.text
.text
.globl qkv1_conv_kernel
.p2align 8
.type qkv1_conv_kernel,@function
qkv1_conv_kernel:
    s_cmp_ge_u32 s2, 512
    s_cbranch_scc1 L_qkv1_conv_kernel_exit
    s_cmp_ge_u32 s2, 224
    s_cbranch_scc1 L_qkv1_conv_kernel_conv
    s_load_dwordx2 s[12:13], s[0:1], 88
    s_load_dwordx2 s[16:17], s[0:1], 0
    s_and_b32 s11, s2, 7
    s_lshr_b32 s9, s2, 3
    s_lshr_b32 s8, s11, 1
    s_lshl_b32 s8, s8, 2
    s_and_b32 s14, s9, 3
    s_or_b32 s8, s8, s14
    s_and_b32 s11, s11, 1
    s_mul_i32 s11, s11, 7
    s_lshr_b32 s9, s9, 2
    s_add_u32 s9, s9, s11
    v_lshrrev_b32 v1, 6, v0
    v_and_b32 v2, 63, v0
    v_readfirstlane_b32 s10, v1
    v_lshlrev_b32 v7, 4, v2
    s_cmp_ge_u32 s10, 4
    s_cbranch_scc0 L_qkv1_conv_kernel_compute
    s_sub_u32 s28, s10, 4
    s_lshl_b32 s38, s28, 11
    s_mul_i32 s36, s9, 147456
    s_add_u32 s36, s36, s38
    s_add_u32 s36, s36, 25165824
    s_lshl_b32 s30, s8, 7
    s_lshl_b32 s31, s28, 5
    s_add_u32 s30, s30, s31
    v_lshrrev_b32 v5, 2, v2
    v_bfe_u32 v6, v2, 4, 2
    v_and_b32 v8, 3, v2
    v_xor_b32 v6, v6, v8
    v_mul_u32_u24 v3, 1152, v5
    v_lshl_add_u32 v3, v6, 4, v3
    s_mul_i32 s32, s30, 1152
    s_mov_b32 s33, 18432
    s_mov_b32 s34, 64
    s_waitcnt lgkmcnt(0)
    s_mov_b32 s4, s12
    s_and_b32 s5, s13, 0xffff
    s_mov_b32 s6, 0x10000000
    s_mov_b32 s7, 0x00020000
    s_mov_b32 s24, s16
    s_and_b32 s25, s17, 0xffff
    s_mov_b32 s26, 0x240000
    s_mov_b32 s27, 0x00020000
    s_add_u32 m0, s38, 0
    s_add_u32 s40, s32, s33
    buffer_load_dwordx4 v3, s[24:27], s32 offen  lds
    s_add_u32 m0, s38, 1024
    s_add_u32 s32, s32, s34
    buffer_load_dwordx4 v3, s[24:27], s40 offen  lds
    s_add_u32 m0, s38, 40960
    s_add_u32 s40, s36, 1024
    buffer_load_dwordx4 v7, s[4:7], s36 offen  lds
    s_add_u32 m0, s38, 41984
    s_add_u32 s36, s36, 8192
    buffer_load_dwordx4 v7, s[4:7], s40 offen  lds
    s_add_u32 m0, s38, 8192
    s_add_u32 s40, s32, s33
    buffer_load_dwordx4 v3, s[24:27], s32 offen  lds
    s_add_u32 m0, s38, 9216
    s_add_u32 s32, s32, s34
    buffer_load_dwordx4 v3, s[24:27], s40 offen  lds
    s_add_u32 m0, s38, 49152
    s_add_u32 s40, s36, 1024
    buffer_load_dwordx4 v7, s[4:7], s36 offen  lds
    s_add_u32 m0, s38, 50176
    s_add_u32 s36, s36, 8192
    buffer_load_dwordx4 v7, s[4:7], s40 offen  lds
    s_add_u32 m0, s38, 16384
    s_add_u32 s40, s32, s33
    buffer_load_dwordx4 v3, s[24:27], s32 offen  lds
    s_add_u32 m0, s38, 17408
    s_add_u32 s32, s32, s34
    buffer_load_dwordx4 v3, s[24:27], s40 offen  lds
    s_add_u32 m0, s38, 57344
    s_add_u32 s40, s36, 1024
    buffer_load_dwordx4 v7, s[4:7], s36 offen  lds
    s_add_u32 m0, s38, 58368
    s_add_u32 s36, s36, 8192
    buffer_load_dwordx4 v7, s[4:7], s40 offen  lds
    s_add_u32 m0, s38, 24576
    s_add_u32 s40, s32, s33
    buffer_load_dwordx4 v3, s[24:27], s32 offen  lds
    s_add_u32 m0, s38, 25600
    s_add_u32 s32, s32, s34
    buffer_load_dwordx4 v3, s[24:27], s40 offen  lds
    s_add_u32 m0, s38, 65536
    s_add_u32 s40, s36, 1024
    buffer_load_dwordx4 v7, s[4:7], s36 offen  lds
    s_add_u32 m0, s38, 66560
    s_add_u32 s36, s36, 8192
    buffer_load_dwordx4 v7, s[4:7], s40 offen  lds
    v_and_b32 v10, 31, v2
    v_lshrrev_b32 v11, 5, v2
    v_mul_u32_u24 v12, 48, v10
    v_mul_u32_u24 v13, 24, v11
    v_add_u32 v12, v12, v13
    s_mul_i32 s41, s30, 48
    s_add_u32 s41, s41, 20971520
    buffer_load_dwordx2 v[16:17], v12, s[4:7], s41 offen
    buffer_load_dwordx2 v[18:19], v12, s[4:7], s41 offen offset:8
    buffer_load_dwordx2 v[20:21], v12, s[4:7], s41 offen offset:16
    s_lshl_b32 s42, s9, 9
    s_lshl_b32 s43, s28, 7
    s_add_u32 s42, s42, s43
    s_add_u32 s42, s42, 21495808
    v_lshlrev_b32 v13, 2, v10
    buffer_load_dword v22, v13, s[4:7], s42 offen
    s_add_u32 s42, s42, 7168
    buffer_load_dword v23, v13, s[4:7], s42 offen
    s_add_u32 s42, s42, 7168
    buffer_load_dword v24, v13, s[4:7], s42 offen
    s_add_u32 s42, s42, 7168
    buffer_load_dword v25, v13, s[4:7], s42 offen
    s_waitcnt vmcnt(15)
    s_barrier
    s_add_u32 m0, s38, 32768
    s_add_u32 s40, s32, s33
    buffer_load_dwordx4 v3, s[24:27], s32 offen  lds
    s_add_u32 m0, s38, 33792
    s_add_u32 s32, s32, s34
    buffer_load_dwordx4 v3, s[24:27], s40 offen  lds
    s_add_u32 m0, s38, 73728
    s_add_u32 s40, s36, 1024
    buffer_load_dwordx4 v7, s[4:7], s36 offen  lds
    s_add_u32 m0, s38, 74752
    s_add_u32 s36, s36, 8192
    buffer_load_dwordx4 v7, s[4:7], s40 offen  lds
    s_waitcnt vmcnt(15)
    s_barrier
    s_add_u32 m0, s38, 0
    s_add_u32 s40, s32, s33
    buffer_load_dwordx4 v3, s[24:27], s32 offen  lds
    s_add_u32 m0, s38, 1024
    s_add_u32 s32, s32, s34
    buffer_load_dwordx4 v3, s[24:27], s40 offen  lds
    s_add_u32 m0, s38, 40960
    s_add_u32 s40, s36, 1024
    buffer_load_dwordx4 v7, s[4:7], s36 offen  lds
    s_add_u32 m0, s38, 41984
    s_add_u32 s36, s36, 8192
    buffer_load_dwordx4 v7, s[4:7], s40 offen  lds
    s_waitcnt vmcnt(15)
    s_barrier
    s_add_u32 m0, s38, 8192
    s_add_u32 s40, s32, s33
    buffer_load_dwordx4 v3, s[24:27], s32 offen  lds
    s_add_u32 m0, s38, 9216
    s_add_u32 s32, s32, s34
    buffer_load_dwordx4 v3, s[24:27], s40 offen  lds
    s_add_u32 m0, s38, 49152
    s_add_u32 s40, s36, 1024
    buffer_load_dwordx4 v7, s[4:7], s36 offen  lds
    s_add_u32 m0, s38, 50176
    s_add_u32 s36, s36, 8192
    buffer_load_dwordx4 v7, s[4:7], s40 offen  lds
    s_waitcnt vmcnt(8)
    s_barrier
    s_add_u32 m0, s38, 16384
    s_add_u32 s40, s32, s33
    buffer_load_dwordx4 v3, s[24:27], s32 offen  lds
    s_add_u32 m0, s38, 17408
    s_add_u32 s32, s32, s34
    buffer_load_dwordx4 v3, s[24:27], s40 offen  lds
    s_add_u32 m0, s38, 57344
    s_add_u32 s40, s36, 1024
    buffer_load_dwordx4 v7, s[4:7], s36 offen  lds
    s_add_u32 m0, s38, 58368
    s_add_u32 s36, s36, 8192
    buffer_load_dwordx4 v7, s[4:7], s40 offen  lds
    s_waitcnt vmcnt(8)
    s_barrier
    s_add_u32 m0, s38, 24576
    s_add_u32 s40, s32, s33
    buffer_load_dwordx4 v3, s[24:27], s32 offen  lds
    s_add_u32 m0, s38, 25600
    s_add_u32 s32, s32, s34
    buffer_load_dwordx4 v3, s[24:27], s40 offen  lds
    s_add_u32 m0, s38, 65536
    s_add_u32 s40, s36, 1024
    buffer_load_dwordx4 v7, s[4:7], s36 offen  lds
    s_add_u32 m0, s38, 66560
    s_add_u32 s36, s36, 8192
    buffer_load_dwordx4 v7, s[4:7], s40 offen  lds
    s_waitcnt vmcnt(8)
    s_barrier
    s_add_u32 m0, s38, 32768
    s_add_u32 s40, s32, s33
    buffer_load_dwordx4 v3, s[24:27], s32 offen  lds
    s_add_u32 m0, s38, 33792
    s_add_u32 s32, s32, s34
    buffer_load_dwordx4 v3, s[24:27], s40 offen  lds
    s_add_u32 m0, s38, 73728
    s_add_u32 s40, s36, 1024
    buffer_load_dwordx4 v7, s[4:7], s36 offen  lds
    s_add_u32 m0, s38, 74752
    s_add_u32 s36, s36, 8192
    buffer_load_dwordx4 v7, s[4:7], s40 offen  lds
    s_waitcnt vmcnt(8)
    s_barrier
    s_add_u32 m0, s38, 0
    s_add_u32 s40, s32, s33
    buffer_load_dwordx4 v3, s[24:27], s32 offen  lds
    s_add_u32 m0, s38, 1024
    s_add_u32 s32, s32, s34
    buffer_load_dwordx4 v3, s[24:27], s40 offen  lds
    s_add_u32 m0, s38, 40960
    s_add_u32 s40, s36, 1024
    buffer_load_dwordx4 v7, s[4:7], s36 offen  lds
    s_add_u32 m0, s38, 41984
    s_add_u32 s36, s36, 8192
    buffer_load_dwordx4 v7, s[4:7], s40 offen  lds
    s_waitcnt vmcnt(8)
    s_barrier
    s_add_u32 m0, s38, 8192
    s_add_u32 s40, s32, s33
    buffer_load_dwordx4 v3, s[24:27], s32 offen  lds
    s_add_u32 m0, s38, 9216
    s_add_u32 s32, s32, s34
    buffer_load_dwordx4 v3, s[24:27], s40 offen  lds
    s_add_u32 m0, s38, 49152
    s_add_u32 s40, s36, 1024
    buffer_load_dwordx4 v7, s[4:7], s36 offen  lds
    s_add_u32 m0, s38, 50176
    s_add_u32 s36, s36, 8192
    buffer_load_dwordx4 v7, s[4:7], s40 offen  lds
    s_waitcnt vmcnt(8)
    s_barrier
    s_add_u32 m0, s38, 16384
    s_add_u32 s40, s32, s33
    buffer_load_dwordx4 v3, s[24:27], s32 offen  lds
    s_add_u32 m0, s38, 17408
    s_add_u32 s32, s32, s34
    buffer_load_dwordx4 v3, s[24:27], s40 offen  lds
    s_add_u32 m0, s38, 57344
    s_add_u32 s40, s36, 1024
    buffer_load_dwordx4 v7, s[4:7], s36 offen  lds
    s_add_u32 m0, s38, 58368
    s_add_u32 s36, s36, 8192
    buffer_load_dwordx4 v7, s[4:7], s40 offen  lds
    s_waitcnt vmcnt(8)
    s_barrier
    s_add_u32 m0, s38, 24576
    s_add_u32 s40, s32, s33
    buffer_load_dwordx4 v3, s[24:27], s32 offen  lds
    s_add_u32 m0, s38, 25600
    s_add_u32 s32, s32, s34
    buffer_load_dwordx4 v3, s[24:27], s40 offen  lds
    s_add_u32 m0, s38, 65536
    s_add_u32 s40, s36, 1024
    buffer_load_dwordx4 v7, s[4:7], s36 offen  lds
    s_add_u32 m0, s38, 66560
    s_add_u32 s36, s36, 8192
    buffer_load_dwordx4 v7, s[4:7], s40 offen  lds
    s_waitcnt vmcnt(8)
    s_barrier
    s_add_u32 m0, s38, 32768
    s_add_u32 s40, s32, s33
    buffer_load_dwordx4 v3, s[24:27], s32 offen  lds
    s_add_u32 m0, s38, 33792
    s_add_u32 s32, s32, s34
    buffer_load_dwordx4 v3, s[24:27], s40 offen  lds
    s_add_u32 m0, s38, 73728
    s_add_u32 s40, s36, 1024
    buffer_load_dwordx4 v7, s[4:7], s36 offen  lds
    s_add_u32 m0, s38, 74752
    s_add_u32 s36, s36, 8192
    buffer_load_dwordx4 v7, s[4:7], s40 offen  lds
    s_waitcnt vmcnt(8)
    s_barrier
    s_add_u32 m0, s38, 0
    s_add_u32 s40, s32, s33
    buffer_load_dwordx4 v3, s[24:27], s32 offen  lds
    s_add_u32 m0, s38, 1024
    s_add_u32 s32, s32, s34
    buffer_load_dwordx4 v3, s[24:27], s40 offen  lds
    s_add_u32 m0, s38, 40960
    s_add_u32 s40, s36, 1024
    buffer_load_dwordx4 v7, s[4:7], s36 offen  lds
    s_add_u32 m0, s38, 41984
    s_add_u32 s36, s36, 8192
    buffer_load_dwordx4 v7, s[4:7], s40 offen  lds
    s_waitcnt vmcnt(8)
    s_barrier
    s_add_u32 m0, s38, 8192
    s_add_u32 s40, s32, s33
    buffer_load_dwordx4 v3, s[24:27], s32 offen  lds
    s_add_u32 m0, s38, 9216
    s_add_u32 s32, s32, s34
    buffer_load_dwordx4 v3, s[24:27], s40 offen  lds
    s_add_u32 m0, s38, 49152
    s_add_u32 s40, s36, 1024
    buffer_load_dwordx4 v7, s[4:7], s36 offen  lds
    s_add_u32 m0, s38, 50176
    s_add_u32 s36, s36, 8192
    buffer_load_dwordx4 v7, s[4:7], s40 offen  lds
    s_waitcnt vmcnt(8)
    s_barrier
    s_add_u32 m0, s38, 16384
    s_add_u32 s40, s32, s33
    buffer_load_dwordx4 v3, s[24:27], s32 offen  lds
    s_add_u32 m0, s38, 17408
    s_add_u32 s32, s32, s34
    buffer_load_dwordx4 v3, s[24:27], s40 offen  lds
    s_add_u32 m0, s38, 57344
    s_add_u32 s40, s36, 1024
    buffer_load_dwordx4 v7, s[4:7], s36 offen  lds
    s_add_u32 m0, s38, 58368
    s_add_u32 s36, s36, 8192
    buffer_load_dwordx4 v7, s[4:7], s40 offen  lds
    s_waitcnt vmcnt(8)
    s_barrier
    s_waitcnt vmcnt(56)
    v_add_f32 v22, v22, v23
    v_add_f32 v24, v24, v25
    v_add_f32 v16, v16, v18
    v_add_f32 v17, v17, v19
    v_add_f32 v22, v22, v24
    v_add_f32 v16, v16, v20
    v_add_f32 v17, v17, v21
    s_nop 1
    v_mov_b32 v18, v16
    v_mov_b32 v19, v17
    s_nop 1
    v_permlane32_swap_b32 v18, v16
    v_permlane32_swap_b32 v19, v17
    s_nop 1
    v_add_f32 v16, v16, v18
    v_add_f32 v17, v17, v19
    s_mov_b32 s42, 0x3ae38e39
    v_mul_f32 v16, s42, v16
    v_mul_f32 v17, s42, v17
    v_fma_f32 v17, -v16, v16, v17
    v_max_f32 v17, 0, v17
    v_add_f32 v17, 0x3727c5ac, v17
    v_rsq_f32 v17, v17
    s_lshl_b32 s42, s28, 7
    v_lshlrev_b32 v18, 2, v10
    v_add_u32 v18, s42, v18
    v_mul_f32 v16, v16, v17
    v_lshlrev_b32 v19, 1, v18
    s_mov_b32 exec_hi, 0
    ds_write_b32 v18, v17 offset:24576
    ds_write_b32 v18, v16 offset:25088
    ds_write_b32 v19, v17 offset:25600
    ds_write_b32 v19, v16 offset:25604
    ds_write_b32 v18, v22 offset:26624
    s_mov_b32 exec_hi, -1
    s_waitcnt lgkmcnt(0)
    s_waitcnt vmcnt(4)
    s_barrier
    s_waitcnt vmcnt(0)
    s_barrier
    s_barrier
    s_branch L_qkv1_conv_kernel_end
L_qkv1_conv_kernel_compute:
    s_and_b32 s28, s10, 1
    s_lshr_b32 s29, s10, 1
    v_and_b32 v105, 31, v2
    v_lshrrev_b32 v106, 5, v2
    s_cmp_ge_u32 s9, 8
    s_cselect_b32 s33, 1, 0
    s_cmp_ge_u32 s9, 13
    s_cselect_b32 s33, 0, s33
    v_bfe_u32 v107, v2, 2, 2
    v_xor_b32 v107, v106, v107
    v_lshlrev_b32 v3, 6, v105
    v_lshl_add_u32 v3, v107, 4, v3
    s_lshl_b32 s30, s28, 12
    v_add_u32 v3, s30, v3
    v_xor_b32 v4, 32, v3
    s_lshl_b32 s30, s29, 11
    s_add_u32 s30, s30, 40960
    v_add_u32 v5, s30, v7
    s_lshl_b32 s31, s8, 2
    s_lshl_b32 s30, s28, 1
    s_add_u32 s31, s31, s30
    s_waitcnt lgkmcnt(0)
    s_mov_b32 s4, s12
    s_and_b32 s5, s13, 0xffff
    s_mov_b32 s6, 0x10000000
    s_mov_b32 s7, 0x00020000
    s_cmp_eq_u32 s33, 1
    s_cbranch_scc1 L_qkv1_conv_kernel_vt
    s_barrier
    ds_read_b128 v[8:11], v3 offset:0
    ds_read_b128 v[24:27], v5 offset:0
    ds_read_b128 v[12:15], v3 offset:2048
    ds_read_b128 v[28:31], v5 offset:1024
    s_waitcnt lgkmcnt(2)
    v_mfma_f32_32x32x16_bf16 v[40:55], v[24:27], v[8:11], 0
    ds_read_b128 v[16:19], v4 offset:0
    ds_read_b128 v[32:35], v5 offset:4096
    s_waitcnt lgkmcnt(2)
    v_mfma_f32_32x32x16_bf16 v[56:71], v[28:31], v[8:11], 0
    ds_read_b128 v[20:23], v4 offset:2048
    ds_read_b128 v[36:39], v5 offset:5120
    v_mfma_f32_32x32x16_bf16 v[72:87], v[24:27], v[12:15], 0
    v_mfma_f32_32x32x16_bf16 v[88:103], v[28:31], v[12:15], 0
    s_waitcnt lgkmcnt(2)
    v_mfma_f32_32x32x16_bf16 v[40:55], v[32:35], v[16:19], v[40:55]
    ds_read_b128 v[8:11], v3 offset:8192
    ds_read_b128 v[24:27], v5 offset:8192
    s_waitcnt lgkmcnt(2)
    v_mfma_f32_32x32x16_bf16 v[56:71], v[36:39], v[16:19], v[56:71]
    ds_read_b128 v[12:15], v3 offset:10240
    ds_read_b128 v[28:31], v5 offset:9216
    v_mfma_f32_32x32x16_bf16 v[72:87], v[32:35], v[20:23], v[72:87]
    v_mfma_f32_32x32x16_bf16 v[88:103], v[36:39], v[20:23], v[88:103]
    s_barrier
    s_waitcnt lgkmcnt(2)
    v_mfma_f32_32x32x16_bf16 v[40:55], v[24:27], v[8:11], v[40:55]
    ds_read_b128 v[16:19], v4 offset:8192
    ds_read_b128 v[32:35], v5 offset:12288
    s_waitcnt lgkmcnt(2)
    v_mfma_f32_32x32x16_bf16 v[56:71], v[28:31], v[8:11], v[56:71]
    ds_read_b128 v[20:23], v4 offset:10240
    ds_read_b128 v[36:39], v5 offset:13312
    v_mfma_f32_32x32x16_bf16 v[72:87], v[24:27], v[12:15], v[72:87]
    v_mfma_f32_32x32x16_bf16 v[88:103], v[28:31], v[12:15], v[88:103]
    s_waitcnt lgkmcnt(2)
    v_mfma_f32_32x32x16_bf16 v[40:55], v[32:35], v[16:19], v[40:55]
    ds_read_b128 v[8:11], v3 offset:16384
    ds_read_b128 v[24:27], v5 offset:16384
    s_waitcnt lgkmcnt(2)
    v_mfma_f32_32x32x16_bf16 v[56:71], v[36:39], v[16:19], v[56:71]
    ds_read_b128 v[12:15], v3 offset:18432
    ds_read_b128 v[28:31], v5 offset:17408
    v_mfma_f32_32x32x16_bf16 v[72:87], v[32:35], v[20:23], v[72:87]
    v_mfma_f32_32x32x16_bf16 v[88:103], v[36:39], v[20:23], v[88:103]
    s_barrier
    s_waitcnt lgkmcnt(2)
    v_mfma_f32_32x32x16_bf16 v[40:55], v[24:27], v[8:11], v[40:55]
    ds_read_b128 v[16:19], v4 offset:16384
    ds_read_b128 v[32:35], v5 offset:20480
    s_waitcnt lgkmcnt(2)
    v_mfma_f32_32x32x16_bf16 v[56:71], v[28:31], v[8:11], v[56:71]
    ds_read_b128 v[20:23], v4 offset:18432
    ds_read_b128 v[36:39], v5 offset:21504
    v_mfma_f32_32x32x16_bf16 v[72:87], v[24:27], v[12:15], v[72:87]
    v_mfma_f32_32x32x16_bf16 v[88:103], v[28:31], v[12:15], v[88:103]
    s_waitcnt lgkmcnt(2)
    v_mfma_f32_32x32x16_bf16 v[40:55], v[32:35], v[16:19], v[40:55]
    ds_read_b128 v[8:11], v3 offset:24576
    ds_read_b128 v[24:27], v5 offset:24576
    s_waitcnt lgkmcnt(2)
    v_mfma_f32_32x32x16_bf16 v[56:71], v[36:39], v[16:19], v[56:71]
    ds_read_b128 v[12:15], v3 offset:26624
    ds_read_b128 v[28:31], v5 offset:25600
    v_mfma_f32_32x32x16_bf16 v[72:87], v[32:35], v[20:23], v[72:87]
    v_mfma_f32_32x32x16_bf16 v[88:103], v[36:39], v[20:23], v[88:103]
    s_barrier
    s_waitcnt lgkmcnt(2)
    v_mfma_f32_32x32x16_bf16 v[40:55], v[24:27], v[8:11], v[40:55]
    ds_read_b128 v[16:19], v4 offset:24576
    ds_read_b128 v[32:35], v5 offset:28672
    s_waitcnt lgkmcnt(2)
    v_mfma_f32_32x32x16_bf16 v[56:71], v[28:31], v[8:11], v[56:71]
    ds_read_b128 v[20:23], v4 offset:26624
    ds_read_b128 v[36:39], v5 offset:29696
    v_mfma_f32_32x32x16_bf16 v[72:87], v[24:27], v[12:15], v[72:87]
    v_mfma_f32_32x32x16_bf16 v[88:103], v[28:31], v[12:15], v[88:103]
    s_waitcnt lgkmcnt(2)
    v_mfma_f32_32x32x16_bf16 v[40:55], v[32:35], v[16:19], v[40:55]
    ds_read_b128 v[8:11], v3 offset:32768
    ds_read_b128 v[24:27], v5 offset:32768
    s_waitcnt lgkmcnt(2)
    v_mfma_f32_32x32x16_bf16 v[56:71], v[36:39], v[16:19], v[56:71]
    ds_read_b128 v[12:15], v3 offset:34816
    ds_read_b128 v[28:31], v5 offset:33792
    v_mfma_f32_32x32x16_bf16 v[72:87], v[32:35], v[20:23], v[72:87]
    v_mfma_f32_32x32x16_bf16 v[88:103], v[36:39], v[20:23], v[88:103]
    s_barrier
    s_waitcnt lgkmcnt(2)
    v_mfma_f32_32x32x16_bf16 v[40:55], v[24:27], v[8:11], v[40:55]
    ds_read_b128 v[16:19], v4 offset:32768
    ds_read_b128 v[32:35], v5 offset:36864
    s_waitcnt lgkmcnt(2)
    v_mfma_f32_32x32x16_bf16 v[56:71], v[28:31], v[8:11], v[56:71]
    ds_read_b128 v[20:23], v4 offset:34816
    ds_read_b128 v[36:39], v5 offset:37888
    v_mfma_f32_32x32x16_bf16 v[72:87], v[24:27], v[12:15], v[72:87]
    v_mfma_f32_32x32x16_bf16 v[88:103], v[28:31], v[12:15], v[88:103]
    s_waitcnt lgkmcnt(2)
    v_mfma_f32_32x32x16_bf16 v[40:55], v[32:35], v[16:19], v[40:55]
    ds_read_b128 v[8:11], v3 offset:0
    ds_read_b128 v[24:27], v5 offset:0
    s_waitcnt lgkmcnt(2)
    v_mfma_f32_32x32x16_bf16 v[56:71], v[36:39], v[16:19], v[56:71]
    ds_read_b128 v[12:15], v3 offset:2048
    ds_read_b128 v[28:31], v5 offset:1024
    v_mfma_f32_32x32x16_bf16 v[72:87], v[32:35], v[20:23], v[72:87]
    v_mfma_f32_32x32x16_bf16 v[88:103], v[36:39], v[20:23], v[88:103]
    s_barrier
    s_waitcnt lgkmcnt(2)
    v_mfma_f32_32x32x16_bf16 v[40:55], v[24:27], v[8:11], v[40:55]
    ds_read_b128 v[16:19], v4 offset:0
    ds_read_b128 v[32:35], v5 offset:4096
    s_waitcnt lgkmcnt(2)
    v_mfma_f32_32x32x16_bf16 v[56:71], v[28:31], v[8:11], v[56:71]
    ds_read_b128 v[20:23], v4 offset:2048
    ds_read_b128 v[36:39], v5 offset:5120
    v_mfma_f32_32x32x16_bf16 v[72:87], v[24:27], v[12:15], v[72:87]
    v_mfma_f32_32x32x16_bf16 v[88:103], v[28:31], v[12:15], v[88:103]
    s_waitcnt lgkmcnt(2)
    v_mfma_f32_32x32x16_bf16 v[40:55], v[32:35], v[16:19], v[40:55]
    ds_read_b128 v[8:11], v3 offset:8192
    ds_read_b128 v[24:27], v5 offset:8192
    s_waitcnt lgkmcnt(2)
    v_mfma_f32_32x32x16_bf16 v[56:71], v[36:39], v[16:19], v[56:71]
    ds_read_b128 v[12:15], v3 offset:10240
    ds_read_b128 v[28:31], v5 offset:9216
    v_mfma_f32_32x32x16_bf16 v[72:87], v[32:35], v[20:23], v[72:87]
    v_mfma_f32_32x32x16_bf16 v[88:103], v[36:39], v[20:23], v[88:103]
    s_barrier
    s_waitcnt lgkmcnt(2)
    v_mfma_f32_32x32x16_bf16 v[40:55], v[24:27], v[8:11], v[40:55]
    ds_read_b128 v[16:19], v4 offset:8192
    ds_read_b128 v[32:35], v5 offset:12288
    s_waitcnt lgkmcnt(2)
    v_mfma_f32_32x32x16_bf16 v[56:71], v[28:31], v[8:11], v[56:71]
    ds_read_b128 v[20:23], v4 offset:10240
    ds_read_b128 v[36:39], v5 offset:13312
    v_mfma_f32_32x32x16_bf16 v[72:87], v[24:27], v[12:15], v[72:87]
    v_mfma_f32_32x32x16_bf16 v[88:103], v[28:31], v[12:15], v[88:103]
    s_waitcnt lgkmcnt(2)
    v_mfma_f32_32x32x16_bf16 v[40:55], v[32:35], v[16:19], v[40:55]
    ds_read_b128 v[8:11], v3 offset:16384
    ds_read_b128 v[24:27], v5 offset:16384
    s_waitcnt lgkmcnt(2)
    v_mfma_f32_32x32x16_bf16 v[56:71], v[36:39], v[16:19], v[56:71]
    ds_read_b128 v[12:15], v3 offset:18432
    ds_read_b128 v[28:31], v5 offset:17408
    v_mfma_f32_32x32x16_bf16 v[72:87], v[32:35], v[20:23], v[72:87]
    v_mfma_f32_32x32x16_bf16 v[88:103], v[36:39], v[20:23], v[88:103]
    s_barrier
    s_waitcnt lgkmcnt(2)
    v_mfma_f32_32x32x16_bf16 v[40:55], v[24:27], v[8:11], v[40:55]
    ds_read_b128 v[16:19], v4 offset:16384
    ds_read_b128 v[32:35], v5 offset:20480
    s_waitcnt lgkmcnt(2)
    v_mfma_f32_32x32x16_bf16 v[56:71], v[28:31], v[8:11], v[56:71]
    ds_read_b128 v[20:23], v4 offset:18432
    ds_read_b128 v[36:39], v5 offset:21504
    v_mfma_f32_32x32x16_bf16 v[72:87], v[24:27], v[12:15], v[72:87]
    v_mfma_f32_32x32x16_bf16 v[88:103], v[28:31], v[12:15], v[88:103]
    s_waitcnt lgkmcnt(2)
    v_mfma_f32_32x32x16_bf16 v[40:55], v[32:35], v[16:19], v[40:55]
    ds_read_b128 v[8:11], v3 offset:24576
    ds_read_b128 v[24:27], v5 offset:24576
    s_waitcnt lgkmcnt(2)
    v_mfma_f32_32x32x16_bf16 v[56:71], v[36:39], v[16:19], v[56:71]
    ds_read_b128 v[12:15], v3 offset:26624
    ds_read_b128 v[28:31], v5 offset:25600
    v_mfma_f32_32x32x16_bf16 v[72:87], v[32:35], v[20:23], v[72:87]
    v_mfma_f32_32x32x16_bf16 v[88:103], v[36:39], v[20:23], v[88:103]
    s_barrier
    s_waitcnt lgkmcnt(2)
    v_mfma_f32_32x32x16_bf16 v[40:55], v[24:27], v[8:11], v[40:55]
    ds_read_b128 v[16:19], v4 offset:24576
    ds_read_b128 v[32:35], v5 offset:28672
    s_waitcnt lgkmcnt(2)
    v_mfma_f32_32x32x16_bf16 v[56:71], v[28:31], v[8:11], v[56:71]
    ds_read_b128 v[20:23], v4 offset:26624
    ds_read_b128 v[36:39], v5 offset:29696
    v_mfma_f32_32x32x16_bf16 v[72:87], v[24:27], v[12:15], v[72:87]
    v_mfma_f32_32x32x16_bf16 v[88:103], v[28:31], v[12:15], v[88:103]
    s_waitcnt lgkmcnt(2)
    v_mfma_f32_32x32x16_bf16 v[40:55], v[32:35], v[16:19], v[40:55]
    ds_read_b128 v[8:11], v3 offset:32768
    ds_read_b128 v[24:27], v5 offset:32768
    s_waitcnt lgkmcnt(2)
    v_mfma_f32_32x32x16_bf16 v[56:71], v[36:39], v[16:19], v[56:71]
    ds_read_b128 v[12:15], v3 offset:34816
    ds_read_b128 v[28:31], v5 offset:33792
    v_mfma_f32_32x32x16_bf16 v[72:87], v[32:35], v[20:23], v[72:87]
    v_mfma_f32_32x32x16_bf16 v[88:103], v[36:39], v[20:23], v[88:103]
    s_barrier
    s_waitcnt lgkmcnt(2)
    v_mfma_f32_32x32x16_bf16 v[40:55], v[24:27], v[8:11], v[40:55]
    ds_read_b128 v[16:19], v4 offset:32768
    ds_read_b128 v[32:35], v5 offset:36864
    s_waitcnt lgkmcnt(2)
    v_mfma_f32_32x32x16_bf16 v[56:71], v[28:31], v[8:11], v[56:71]
    ds_read_b128 v[20:23], v4 offset:34816
    ds_read_b128 v[36:39], v5 offset:37888
    v_mfma_f32_32x32x16_bf16 v[72:87], v[24:27], v[12:15], v[72:87]
    v_mfma_f32_32x32x16_bf16 v[88:103], v[28:31], v[12:15], v[88:103]
    s_waitcnt lgkmcnt(2)
    v_mfma_f32_32x32x16_bf16 v[40:55], v[32:35], v[16:19], v[40:55]
    ds_read_b128 v[8:11], v3 offset:0
    ds_read_b128 v[24:27], v5 offset:0
    s_waitcnt lgkmcnt(2)
    v_mfma_f32_32x32x16_bf16 v[56:71], v[36:39], v[16:19], v[56:71]
    ds_read_b128 v[12:15], v3 offset:2048
    ds_read_b128 v[28:31], v5 offset:1024
    v_mfma_f32_32x32x16_bf16 v[72:87], v[32:35], v[20:23], v[72:87]
    v_mfma_f32_32x32x16_bf16 v[88:103], v[36:39], v[20:23], v[88:103]
    s_barrier
    s_waitcnt lgkmcnt(2)
    v_mfma_f32_32x32x16_bf16 v[40:55], v[24:27], v[8:11], v[40:55]
    ds_read_b128 v[16:19], v4 offset:0
    ds_read_b128 v[32:35], v5 offset:4096
    s_waitcnt lgkmcnt(2)
    v_mfma_f32_32x32x16_bf16 v[56:71], v[28:31], v[8:11], v[56:71]
    ds_read_b128 v[20:23], v4 offset:2048
    ds_read_b128 v[36:39], v5 offset:5120
    v_mfma_f32_32x32x16_bf16 v[72:87], v[24:27], v[12:15], v[72:87]
    v_mfma_f32_32x32x16_bf16 v[88:103], v[28:31], v[12:15], v[88:103]
    s_waitcnt lgkmcnt(2)
    v_mfma_f32_32x32x16_bf16 v[40:55], v[32:35], v[16:19], v[40:55]
    ds_read_b128 v[8:11], v3 offset:8192
    ds_read_b128 v[24:27], v5 offset:8192
    s_waitcnt lgkmcnt(2)
    v_mfma_f32_32x32x16_bf16 v[56:71], v[36:39], v[16:19], v[56:71]
    ds_read_b128 v[12:15], v3 offset:10240
    ds_read_b128 v[28:31], v5 offset:9216
    v_mfma_f32_32x32x16_bf16 v[72:87], v[32:35], v[20:23], v[72:87]
    v_mfma_f32_32x32x16_bf16 v[88:103], v[36:39], v[20:23], v[88:103]
    s_barrier
    s_waitcnt lgkmcnt(2)
    v_mfma_f32_32x32x16_bf16 v[40:55], v[24:27], v[8:11], v[40:55]
    ds_read_b128 v[16:19], v4 offset:8192
    ds_read_b128 v[32:35], v5 offset:12288
    s_waitcnt lgkmcnt(2)
    v_mfma_f32_32x32x16_bf16 v[56:71], v[28:31], v[8:11], v[56:71]
    ds_read_b128 v[20:23], v4 offset:10240
    ds_read_b128 v[36:39], v5 offset:13312
    v_mfma_f32_32x32x16_bf16 v[72:87], v[24:27], v[12:15], v[72:87]
    v_mfma_f32_32x32x16_bf16 v[88:103], v[28:31], v[12:15], v[88:103]
    s_waitcnt lgkmcnt(2)
    v_mfma_f32_32x32x16_bf16 v[40:55], v[32:35], v[16:19], v[40:55]
    ds_read_b128 v[8:11], v3 offset:16384
    ds_read_b128 v[24:27], v5 offset:16384
    s_waitcnt lgkmcnt(2)
    v_mfma_f32_32x32x16_bf16 v[56:71], v[36:39], v[16:19], v[56:71]
    ds_read_b128 v[12:15], v3 offset:18432
    ds_read_b128 v[28:31], v5 offset:17408
    v_mfma_f32_32x32x16_bf16 v[72:87], v[32:35], v[20:23], v[72:87]
    v_mfma_f32_32x32x16_bf16 v[88:103], v[36:39], v[20:23], v[88:103]
    s_barrier
    s_waitcnt lgkmcnt(2)
    v_mfma_f32_32x32x16_bf16 v[40:55], v[24:27], v[8:11], v[40:55]
    ds_read_b128 v[16:19], v4 offset:16384
    ds_read_b128 v[32:35], v5 offset:20480
    s_waitcnt lgkmcnt(2)
    v_mfma_f32_32x32x16_bf16 v[56:71], v[28:31], v[8:11], v[56:71]
    ds_read_b128 v[20:23], v4 offset:18432
    ds_read_b128 v[36:39], v5 offset:21504
    v_mfma_f32_32x32x16_bf16 v[72:87], v[24:27], v[12:15], v[72:87]
    v_mfma_f32_32x32x16_bf16 v[88:103], v[28:31], v[12:15], v[88:103]
    s_waitcnt lgkmcnt(2)
    v_mfma_f32_32x32x16_bf16 v[40:55], v[32:35], v[16:19], v[40:55]
    ds_read_b128 v[8:11], v3 offset:24576
    ds_read_b128 v[24:27], v5 offset:24576
    s_waitcnt lgkmcnt(2)
    v_mfma_f32_32x32x16_bf16 v[56:71], v[36:39], v[16:19], v[56:71]
    ds_read_b128 v[12:15], v3 offset:26624
    ds_read_b128 v[28:31], v5 offset:25600
    v_mfma_f32_32x32x16_bf16 v[72:87], v[32:35], v[20:23], v[72:87]
    v_mfma_f32_32x32x16_bf16 v[88:103], v[36:39], v[20:23], v[88:103]
    s_barrier
    s_waitcnt lgkmcnt(2)
    v_mfma_f32_32x32x16_bf16 v[40:55], v[24:27], v[8:11], v[40:55]
    ds_read_b128 v[16:19], v4 offset:24576
    ds_read_b128 v[32:35], v5 offset:28672
    s_waitcnt lgkmcnt(2)
    v_mfma_f32_32x32x16_bf16 v[56:71], v[28:31], v[8:11], v[56:71]
    ds_read_b128 v[20:23], v4 offset:26624
    ds_read_b128 v[36:39], v5 offset:29696
    v_mfma_f32_32x32x16_bf16 v[72:87], v[24:27], v[12:15], v[72:87]
    v_mfma_f32_32x32x16_bf16 v[88:103], v[28:31], v[12:15], v[88:103]
    s_waitcnt lgkmcnt(2)
    v_mfma_f32_32x32x16_bf16 v[40:55], v[32:35], v[16:19], v[40:55]
    ds_read_b128 v[8:11], v3 offset:32768
    ds_read_b128 v[24:27], v5 offset:32768
    s_waitcnt lgkmcnt(2)
    v_mfma_f32_32x32x16_bf16 v[56:71], v[36:39], v[16:19], v[56:71]
    ds_read_b128 v[12:15], v3 offset:34816
    ds_read_b128 v[28:31], v5 offset:33792
    v_mfma_f32_32x32x16_bf16 v[72:87], v[32:35], v[20:23], v[72:87]
    v_mfma_f32_32x32x16_bf16 v[88:103], v[36:39], v[20:23], v[88:103]
    s_barrier
    s_waitcnt lgkmcnt(2)
    v_mfma_f32_32x32x16_bf16 v[40:55], v[24:27], v[8:11], v[40:55]
    ds_read_b128 v[16:19], v4 offset:32768
    ds_read_b128 v[32:35], v5 offset:36864
    s_waitcnt lgkmcnt(2)
    v_mfma_f32_32x32x16_bf16 v[56:71], v[28:31], v[8:11], v[56:71]
    ds_read_b128 v[20:23], v4 offset:34816
    ds_read_b128 v[36:39], v5 offset:37888
    v_mfma_f32_32x32x16_bf16 v[72:87], v[24:27], v[12:15], v[72:87]
    v_mfma_f32_32x32x16_bf16 v[88:103], v[28:31], v[12:15], v[88:103]
    s_waitcnt lgkmcnt(2)
    v_mfma_f32_32x32x16_bf16 v[40:55], v[32:35], v[16:19], v[40:55]
    ds_read_b128 v[8:11], v3 offset:0
    ds_read_b128 v[24:27], v5 offset:0
    s_waitcnt lgkmcnt(2)
    v_mfma_f32_32x32x16_bf16 v[56:71], v[36:39], v[16:19], v[56:71]
    ds_read_b128 v[12:15], v3 offset:2048
    ds_read_b128 v[28:31], v5 offset:1024
    v_mfma_f32_32x32x16_bf16 v[72:87], v[32:35], v[20:23], v[72:87]
    v_mfma_f32_32x32x16_bf16 v[88:103], v[36:39], v[20:23], v[88:103]
    s_barrier
    s_waitcnt lgkmcnt(2)
    v_mfma_f32_32x32x16_bf16 v[40:55], v[24:27], v[8:11], v[40:55]
    ds_read_b128 v[16:19], v4 offset:0
    ds_read_b128 v[32:35], v5 offset:4096
    s_waitcnt lgkmcnt(2)
    v_mfma_f32_32x32x16_bf16 v[56:71], v[28:31], v[8:11], v[56:71]
    ds_read_b128 v[20:23], v4 offset:2048
    ds_read_b128 v[36:39], v5 offset:5120
    v_mfma_f32_32x32x16_bf16 v[72:87], v[24:27], v[12:15], v[72:87]
    v_mfma_f32_32x32x16_bf16 v[88:103], v[28:31], v[12:15], v[88:103]
    s_waitcnt lgkmcnt(2)
    v_mfma_f32_32x32x16_bf16 v[40:55], v[32:35], v[16:19], v[40:55]
    ds_read_b128 v[8:11], v3 offset:8192
    ds_read_b128 v[24:27], v5 offset:8192
    s_waitcnt lgkmcnt(2)
    v_mfma_f32_32x32x16_bf16 v[56:71], v[36:39], v[16:19], v[56:71]
    ds_read_b128 v[12:15], v3 offset:10240
    ds_read_b128 v[28:31], v5 offset:9216
    v_mfma_f32_32x32x16_bf16 v[72:87], v[32:35], v[20:23], v[72:87]
    v_mfma_f32_32x32x16_bf16 v[88:103], v[36:39], v[20:23], v[88:103]
    s_barrier
    s_waitcnt lgkmcnt(2)
    v_mfma_f32_32x32x16_bf16 v[40:55], v[24:27], v[8:11], v[40:55]
    ds_read_b128 v[16:19], v4 offset:8192
    ds_read_b128 v[32:35], v5 offset:12288
    s_waitcnt lgkmcnt(2)
    v_mfma_f32_32x32x16_bf16 v[56:71], v[28:31], v[8:11], v[56:71]
    ds_read_b128 v[20:23], v4 offset:10240
    ds_read_b128 v[36:39], v5 offset:13312
    v_mfma_f32_32x32x16_bf16 v[72:87], v[24:27], v[12:15], v[72:87]
    v_mfma_f32_32x32x16_bf16 v[88:103], v[28:31], v[12:15], v[88:103]
    s_waitcnt lgkmcnt(2)
    v_mfma_f32_32x32x16_bf16 v[40:55], v[32:35], v[16:19], v[40:55]
    ds_read_b128 v[8:11], v3 offset:16384
    ds_read_b128 v[24:27], v5 offset:16384
    s_waitcnt lgkmcnt(2)
    v_mfma_f32_32x32x16_bf16 v[56:71], v[36:39], v[16:19], v[56:71]
    ds_read_b128 v[12:15], v3 offset:18432
    ds_read_b128 v[28:31], v5 offset:17408
    v_mfma_f32_32x32x16_bf16 v[72:87], v[32:35], v[20:23], v[72:87]
    v_mfma_f32_32x32x16_bf16 v[88:103], v[36:39], v[20:23], v[88:103]
    s_barrier
    s_waitcnt lgkmcnt(2)
    v_mfma_f32_32x32x16_bf16 v[40:55], v[24:27], v[8:11], v[40:55]
    ds_read_b128 v[16:19], v4 offset:16384
    ds_read_b128 v[32:35], v5 offset:20480
    s_waitcnt lgkmcnt(2)
    v_mfma_f32_32x32x16_bf16 v[56:71], v[28:31], v[8:11], v[56:71]
    ds_read_b128 v[20:23], v4 offset:18432
    ds_read_b128 v[36:39], v5 offset:21504
    v_mfma_f32_32x32x16_bf16 v[72:87], v[24:27], v[12:15], v[72:87]
    v_mfma_f32_32x32x16_bf16 v[88:103], v[28:31], v[12:15], v[88:103]
    s_waitcnt lgkmcnt(2)
    v_mfma_f32_32x32x16_bf16 v[40:55], v[32:35], v[16:19], v[40:55]
    s_waitcnt lgkmcnt(0)
    v_mfma_f32_32x32x16_bf16 v[56:71], v[36:39], v[16:19], v[56:71]
    v_mfma_f32_32x32x16_bf16 v[72:87], v[32:35], v[20:23], v[72:87]
    v_mfma_f32_32x32x16_bf16 v[88:103], v[36:39], v[20:23], v[88:103]
    s_lshl_b32 s30, s28, 9
    v_lshlrev_b32 v109, 3, v105
    v_add_u32 v109, s30, v109
    s_lshl_b32 s30, s29, 8
    v_lshlrev_b32 v110, 4, v106
    v_add_u32 v110, s30, v110
    ds_read_b64 v[112:113], v109 offset:25600
    ds_read_b64 v[114:115], v109 offset:25856
    ds_read_b128 v[8:11], v110 offset:26624
    ds_read_b128 v[12:15], v110 offset:26656
    ds_read_b128 v[16:19], v110 offset:26688
    ds_read_b128 v[20:23], v110 offset:26720
    ds_read_b128 v[24:27], v110 offset:26752
    ds_read_b128 v[28:31], v110 offset:26784
    ds_read_b128 v[32:35], v110 offset:26816
    ds_read_b128 v[36:39], v110 offset:26848
    s_cmp_ge_u32 s9, 4
    s_cselect_b32 s35, 1, 0
    s_cmp_eq_u32 s9, 13
    s_cselect_b32 s35, s29, s35
    s_mov_b32 s36, 0x3eae1a93
    s_cmp_eq_u32 s35, 1
    s_cselect_b32 s36, 1.0, s36
    s_and_b32 s34, s9, 3
    s_lshl_b32 s37, s34, 2
    s_lshl_b32 s38, s29, 1
    s_add_u32 s37, s37, s38
    s_lshl_b32 s37, s37, 1
    s_mul_i32 s38, s37, 151552
    s_lshl_b32 s39, s37, 16
    s_add_u32 s39, s39, 5242880
    s_add_u32 s38, s38, 0
    s_mov_b32 s40, 151552
    s_cmp_eq_u32 s35, 1
    s_cselect_b32 s38, s38, s39
    s_cselect_b32 s40, s40, 65536
    s_lshl_b32 s39, s31, 10
    s_add_u32 s38, s38, s39
    s_add_u32 s39, s38, s40
    s_lshl_b32 s43, s40, 1
    s_waitcnt lgkmcnt(8)
    v_mul_f32 v108, s36, v112
    v_mul_f32 v110, s36, v113
    v_mul_f32 v112, s36, v114
    v_mul_f32 v114, s36, v115
    v_mov_b32 v109, v108
    v_mov_b32 v111, v110
    v_mov_b32 v113, v112
    v_mov_b32 v115, v114
    s_waitcnt lgkmcnt(0)
    s_cmp_eq_u32 s9, 13
    s_cbranch_scc1 L_qkv1_conv_kernel_exst
    v_pk_mul_f32 v[116:117], v[110:111], v[8:9]
    v_pk_fma_f32 v[40:41], v[40:41], v[108:109], v[116:117] neg_lo:[0,0,1] neg_hi:[0,0,1]
    v_pk_mul_f32 v[116:117], v[110:111], v[10:11]
    v_pk_fma_f32 v[42:43], v[42:43], v[108:109], v[116:117] neg_lo:[0,0,1] neg_hi:[0,0,1]
    v_pk_mul_f32 v[116:117], v[110:111], v[12:13]
    v_pk_fma_f32 v[44:45], v[44:45], v[108:109], v[116:117] neg_lo:[0,0,1] neg_hi:[0,0,1]
    v_pk_mul_f32 v[116:117], v[110:111], v[14:15]
    v_pk_fma_f32 v[46:47], v[46:47], v[108:109], v[116:117] neg_lo:[0,0,1] neg_hi:[0,0,1]
    v_pk_mul_f32 v[116:117], v[110:111], v[16:17]
    v_pk_fma_f32 v[48:49], v[48:49], v[108:109], v[116:117] neg_lo:[0,0,1] neg_hi:[0,0,1]
    v_pk_mul_f32 v[116:117], v[110:111], v[18:19]
    v_pk_fma_f32 v[50:51], v[50:51], v[108:109], v[116:117] neg_lo:[0,0,1] neg_hi:[0,0,1]
    v_pk_mul_f32 v[116:117], v[110:111], v[20:21]
    v_pk_fma_f32 v[52:53], v[52:53], v[108:109], v[116:117] neg_lo:[0,0,1] neg_hi:[0,0,1]
    v_pk_mul_f32 v[116:117], v[110:111], v[22:23]
    v_pk_fma_f32 v[54:55], v[54:55], v[108:109], v[116:117] neg_lo:[0,0,1] neg_hi:[0,0,1]
    v_cvt_pk_bf16_f32 v40, v40, v41
    v_cvt_pk_bf16_f32 v41, v42, v43
    v_cvt_pk_bf16_f32 v42, v44, v45
    v_cvt_pk_bf16_f32 v43, v46, v47
    v_cvt_pk_bf16_f32 v44, v48, v49
    v_cvt_pk_bf16_f32 v45, v50, v51
    v_cvt_pk_bf16_f32 v46, v52, v53
    v_cvt_pk_bf16_f32 v47, v54, v55
    buffer_store_dwordx4 v[40:43], v7, s[4:7], s38 offen offset:0 nt
    buffer_store_dwordx4 v[44:47], v7, s[4:7], s39 offen offset:0 nt
    v_pk_mul_f32 v[116:117], v[114:115], v[8:9]
    v_pk_fma_f32 v[72:73], v[72:73], v[112:113], v[116:117] neg_lo:[0,0,1] neg_hi:[0,0,1]
    v_pk_mul_f32 v[116:117], v[114:115], v[10:11]
    v_pk_fma_f32 v[74:75], v[74:75], v[112:113], v[116:117] neg_lo:[0,0,1] neg_hi:[0,0,1]
    v_pk_mul_f32 v[116:117], v[114:115], v[12:13]
    v_pk_fma_f32 v[76:77], v[76:77], v[112:113], v[116:117] neg_lo:[0,0,1] neg_hi:[0,0,1]
    v_pk_mul_f32 v[116:117], v[114:115], v[14:15]
    v_pk_fma_f32 v[78:79], v[78:79], v[112:113], v[116:117] neg_lo:[0,0,1] neg_hi:[0,0,1]
    v_pk_mul_f32 v[116:117], v[114:115], v[16:17]
    v_pk_fma_f32 v[80:81], v[80:81], v[112:113], v[116:117] neg_lo:[0,0,1] neg_hi:[0,0,1]
    v_pk_mul_f32 v[116:117], v[114:115], v[18:19]
    v_pk_fma_f32 v[82:83], v[82:83], v[112:113], v[116:117] neg_lo:[0,0,1] neg_hi:[0,0,1]
    v_pk_mul_f32 v[116:117], v[114:115], v[20:21]
    v_pk_fma_f32 v[84:85], v[84:85], v[112:113], v[116:117] neg_lo:[0,0,1] neg_hi:[0,0,1]
    v_pk_mul_f32 v[116:117], v[114:115], v[22:23]
    v_pk_fma_f32 v[86:87], v[86:87], v[112:113], v[116:117] neg_lo:[0,0,1] neg_hi:[0,0,1]
    v_cvt_pk_bf16_f32 v72, v72, v73
    v_cvt_pk_bf16_f32 v73, v74, v75
    v_cvt_pk_bf16_f32 v74, v76, v77
    v_cvt_pk_bf16_f32 v75, v78, v79
    v_cvt_pk_bf16_f32 v76, v80, v81
    v_cvt_pk_bf16_f32 v77, v82, v83
    v_cvt_pk_bf16_f32 v78, v84, v85
    v_cvt_pk_bf16_f32 v79, v86, v87
    buffer_store_dwordx4 v[72:75], v7, s[4:7], s38 offen offset:1024 nt
    buffer_store_dwordx4 v[76:79], v7, s[4:7], s39 offen offset:1024 nt
    s_add_u32 s38, s38, s43
    s_add_u32 s39, s39, s43
    v_pk_mul_f32 v[116:117], v[110:111], v[24:25]
    v_pk_fma_f32 v[56:57], v[56:57], v[108:109], v[116:117] neg_lo:[0,0,1] neg_hi:[0,0,1]
    v_pk_mul_f32 v[116:117], v[110:111], v[26:27]
    v_pk_fma_f32 v[58:59], v[58:59], v[108:109], v[116:117] neg_lo:[0,0,1] neg_hi:[0,0,1]
    v_pk_mul_f32 v[116:117], v[110:111], v[28:29]
    v_pk_fma_f32 v[60:61], v[60:61], v[108:109], v[116:117] neg_lo:[0,0,1] neg_hi:[0,0,1]
    v_pk_mul_f32 v[116:117], v[110:111], v[30:31]
    v_pk_fma_f32 v[62:63], v[62:63], v[108:109], v[116:117] neg_lo:[0,0,1] neg_hi:[0,0,1]
    v_pk_mul_f32 v[116:117], v[110:111], v[32:33]
    v_pk_fma_f32 v[64:65], v[64:65], v[108:109], v[116:117] neg_lo:[0,0,1] neg_hi:[0,0,1]
    v_pk_mul_f32 v[116:117], v[110:111], v[34:35]
    v_pk_fma_f32 v[66:67], v[66:67], v[108:109], v[116:117] neg_lo:[0,0,1] neg_hi:[0,0,1]
    v_pk_mul_f32 v[116:117], v[110:111], v[36:37]
    v_pk_fma_f32 v[68:69], v[68:69], v[108:109], v[116:117] neg_lo:[0,0,1] neg_hi:[0,0,1]
    v_pk_mul_f32 v[116:117], v[110:111], v[38:39]
    v_pk_fma_f32 v[70:71], v[70:71], v[108:109], v[116:117] neg_lo:[0,0,1] neg_hi:[0,0,1]
    v_cvt_pk_bf16_f32 v56, v56, v57
    v_cvt_pk_bf16_f32 v57, v58, v59
    v_cvt_pk_bf16_f32 v58, v60, v61
    v_cvt_pk_bf16_f32 v59, v62, v63
    v_cvt_pk_bf16_f32 v60, v64, v65
    v_cvt_pk_bf16_f32 v61, v66, v67
    v_cvt_pk_bf16_f32 v62, v68, v69
    v_cvt_pk_bf16_f32 v63, v70, v71
    buffer_store_dwordx4 v[56:59], v7, s[4:7], s38 offen offset:0 nt
    buffer_store_dwordx4 v[60:63], v7, s[4:7], s39 offen offset:0 nt
    v_pk_mul_f32 v[116:117], v[114:115], v[24:25]
    v_pk_fma_f32 v[88:89], v[88:89], v[112:113], v[116:117] neg_lo:[0,0,1] neg_hi:[0,0,1]
    v_pk_mul_f32 v[116:117], v[114:115], v[26:27]
    v_pk_fma_f32 v[90:91], v[90:91], v[112:113], v[116:117] neg_lo:[0,0,1] neg_hi:[0,0,1]
    v_pk_mul_f32 v[116:117], v[114:115], v[28:29]
    v_pk_fma_f32 v[92:93], v[92:93], v[112:113], v[116:117] neg_lo:[0,0,1] neg_hi:[0,0,1]
    v_pk_mul_f32 v[116:117], v[114:115], v[30:31]
    v_pk_fma_f32 v[94:95], v[94:95], v[112:113], v[116:117] neg_lo:[0,0,1] neg_hi:[0,0,1]
    v_pk_mul_f32 v[116:117], v[114:115], v[32:33]
    v_pk_fma_f32 v[96:97], v[96:97], v[112:113], v[116:117] neg_lo:[0,0,1] neg_hi:[0,0,1]
    v_pk_mul_f32 v[116:117], v[114:115], v[34:35]
    v_pk_fma_f32 v[98:99], v[98:99], v[112:113], v[116:117] neg_lo:[0,0,1] neg_hi:[0,0,1]
    v_pk_mul_f32 v[116:117], v[114:115], v[36:37]
    v_pk_fma_f32 v[100:101], v[100:101], v[112:113], v[116:117] neg_lo:[0,0,1] neg_hi:[0,0,1]
    v_pk_mul_f32 v[116:117], v[114:115], v[38:39]
    v_pk_fma_f32 v[102:103], v[102:103], v[112:113], v[116:117] neg_lo:[0,0,1] neg_hi:[0,0,1]
    v_cvt_pk_bf16_f32 v88, v88, v89
    v_cvt_pk_bf16_f32 v89, v90, v91
    v_cvt_pk_bf16_f32 v90, v92, v93
    v_cvt_pk_bf16_f32 v91, v94, v95
    v_cvt_pk_bf16_f32 v92, v96, v97
    v_cvt_pk_bf16_f32 v93, v98, v99
    v_cvt_pk_bf16_f32 v94, v100, v101
    v_cvt_pk_bf16_f32 v95, v102, v103
    buffer_store_dwordx4 v[88:91], v7, s[4:7], s38 offen offset:1024 nt
    buffer_store_dwordx4 v[92:95], v7, s[4:7], s39 offen offset:1024 nt
    s_branch L_qkv1_conv_kernel_end
L_qkv1_conv_kernel_exst:
    v_pk_mul_f32 v[116:117], v[110:111], v[8:9]
    v_pk_fma_f32 v[40:41], v[40:41], v[108:109], v[116:117] neg_lo:[0,0,1] neg_hi:[0,0,1]
    v_pk_mul_f32 v[116:117], v[110:111], v[10:11]
    v_pk_fma_f32 v[42:43], v[42:43], v[108:109], v[116:117] neg_lo:[0,0,1] neg_hi:[0,0,1]
    v_pk_mul_f32 v[116:117], v[110:111], v[12:13]
    v_pk_fma_f32 v[44:45], v[44:45], v[108:109], v[116:117] neg_lo:[0,0,1] neg_hi:[0,0,1]
    v_pk_mul_f32 v[116:117], v[110:111], v[14:15]
    v_pk_fma_f32 v[46:47], v[46:47], v[108:109], v[116:117] neg_lo:[0,0,1] neg_hi:[0,0,1]
    v_pk_mul_f32 v[116:117], v[110:111], v[16:17]
    v_pk_fma_f32 v[48:49], v[48:49], v[108:109], v[116:117] neg_lo:[0,0,1] neg_hi:[0,0,1]
    v_pk_mul_f32 v[116:117], v[110:111], v[18:19]
    v_pk_fma_f32 v[50:51], v[50:51], v[108:109], v[116:117] neg_lo:[0,0,1] neg_hi:[0,0,1]
    v_pk_mul_f32 v[116:117], v[110:111], v[20:21]
    v_pk_fma_f32 v[52:53], v[52:53], v[108:109], v[116:117] neg_lo:[0,0,1] neg_hi:[0,0,1]
    v_pk_mul_f32 v[116:117], v[110:111], v[22:23]
    v_pk_fma_f32 v[54:55], v[54:55], v[108:109], v[116:117] neg_lo:[0,0,1] neg_hi:[0,0,1]
    v_pk_mul_f32 v[116:117], v[114:115], v[8:9]
    v_pk_fma_f32 v[72:73], v[72:73], v[112:113], v[116:117] neg_lo:[0,0,1] neg_hi:[0,0,1]
    v_pk_mul_f32 v[116:117], v[114:115], v[10:11]
    v_pk_fma_f32 v[74:75], v[74:75], v[112:113], v[116:117] neg_lo:[0,0,1] neg_hi:[0,0,1]
    v_pk_mul_f32 v[116:117], v[114:115], v[12:13]
    v_pk_fma_f32 v[76:77], v[76:77], v[112:113], v[116:117] neg_lo:[0,0,1] neg_hi:[0,0,1]
    v_pk_mul_f32 v[116:117], v[114:115], v[14:15]
    v_pk_fma_f32 v[78:79], v[78:79], v[112:113], v[116:117] neg_lo:[0,0,1] neg_hi:[0,0,1]
    v_pk_mul_f32 v[116:117], v[114:115], v[16:17]
    v_pk_fma_f32 v[80:81], v[80:81], v[112:113], v[116:117] neg_lo:[0,0,1] neg_hi:[0,0,1]
    v_pk_mul_f32 v[116:117], v[114:115], v[18:19]
    v_pk_fma_f32 v[82:83], v[82:83], v[112:113], v[116:117] neg_lo:[0,0,1] neg_hi:[0,0,1]
    v_pk_mul_f32 v[116:117], v[114:115], v[20:21]
    v_pk_fma_f32 v[84:85], v[84:85], v[112:113], v[116:117] neg_lo:[0,0,1] neg_hi:[0,0,1]
    v_pk_mul_f32 v[116:117], v[114:115], v[22:23]
    v_pk_fma_f32 v[86:87], v[86:87], v[112:113], v[116:117] neg_lo:[0,0,1] neg_hi:[0,0,1]
    v_pk_mul_f32 v[116:117], v[110:111], v[24:25]
    v_pk_fma_f32 v[56:57], v[56:57], v[108:109], v[116:117] neg_lo:[0,0,1] neg_hi:[0,0,1]
    v_pk_mul_f32 v[116:117], v[110:111], v[26:27]
    v_pk_fma_f32 v[58:59], v[58:59], v[108:109], v[116:117] neg_lo:[0,0,1] neg_hi:[0,0,1]
    v_pk_mul_f32 v[116:117], v[110:111], v[28:29]
    v_pk_fma_f32 v[60:61], v[60:61], v[108:109], v[116:117] neg_lo:[0,0,1] neg_hi:[0,0,1]
    v_pk_mul_f32 v[116:117], v[110:111], v[30:31]
    v_pk_fma_f32 v[62:63], v[62:63], v[108:109], v[116:117] neg_lo:[0,0,1] neg_hi:[0,0,1]
    v_pk_mul_f32 v[116:117], v[110:111], v[32:33]
    v_pk_fma_f32 v[64:65], v[64:65], v[108:109], v[116:117] neg_lo:[0,0,1] neg_hi:[0,0,1]
    v_pk_mul_f32 v[116:117], v[110:111], v[34:35]
    v_pk_fma_f32 v[66:67], v[66:67], v[108:109], v[116:117] neg_lo:[0,0,1] neg_hi:[0,0,1]
    v_pk_mul_f32 v[116:117], v[110:111], v[36:37]
    v_pk_fma_f32 v[68:69], v[68:69], v[108:109], v[116:117] neg_lo:[0,0,1] neg_hi:[0,0,1]
    v_pk_mul_f32 v[116:117], v[110:111], v[38:39]
    v_pk_fma_f32 v[70:71], v[70:71], v[108:109], v[116:117] neg_lo:[0,0,1] neg_hi:[0,0,1]
    v_pk_mul_f32 v[116:117], v[114:115], v[24:25]
    v_pk_fma_f32 v[88:89], v[88:89], v[112:113], v[116:117] neg_lo:[0,0,1] neg_hi:[0,0,1]
    v_pk_mul_f32 v[116:117], v[114:115], v[26:27]
    v_pk_fma_f32 v[90:91], v[90:91], v[112:113], v[116:117] neg_lo:[0,0,1] neg_hi:[0,0,1]
    v_pk_mul_f32 v[116:117], v[114:115], v[28:29]
    v_pk_fma_f32 v[92:93], v[92:93], v[112:113], v[116:117] neg_lo:[0,0,1] neg_hi:[0,0,1]
    v_pk_mul_f32 v[116:117], v[114:115], v[30:31]
    v_pk_fma_f32 v[94:95], v[94:95], v[112:113], v[116:117] neg_lo:[0,0,1] neg_hi:[0,0,1]
    v_pk_mul_f32 v[116:117], v[114:115], v[32:33]
    v_pk_fma_f32 v[96:97], v[96:97], v[112:113], v[116:117] neg_lo:[0,0,1] neg_hi:[0,0,1]
    v_pk_mul_f32 v[116:117], v[114:115], v[34:35]
    v_pk_fma_f32 v[98:99], v[98:99], v[112:113], v[116:117] neg_lo:[0,0,1] neg_hi:[0,0,1]
    v_pk_mul_f32 v[116:117], v[114:115], v[36:37]
    v_pk_fma_f32 v[100:101], v[100:101], v[112:113], v[116:117] neg_lo:[0,0,1] neg_hi:[0,0,1]
    v_pk_mul_f32 v[116:117], v[114:115], v[38:39]
    v_pk_fma_f32 v[102:103], v[102:103], v[112:113], v[116:117] neg_lo:[0,0,1] neg_hi:[0,0,1]
    v_cvt_pk_bf16_f32 v8, v40, v41
    v_cvt_pk_bf16_f32 v10, v42, v43
    v_cvt_pk_bf16_f32 v12, v44, v45
    v_cvt_pk_bf16_f32 v14, v46, v47
    v_cvt_pk_bf16_f32 v16, v48, v49
    v_cvt_pk_bf16_f32 v18, v50, v51
    v_cvt_pk_bf16_f32 v20, v52, v53
    v_cvt_pk_bf16_f32 v22, v54, v55
    v_cvt_pk_bf16_f32 v9, v72, v73
    v_cvt_pk_bf16_f32 v11, v74, v75
    v_cvt_pk_bf16_f32 v13, v76, v77
    v_cvt_pk_bf16_f32 v15, v78, v79
    v_cvt_pk_bf16_f32 v17, v80, v81
    v_cvt_pk_bf16_f32 v19, v82, v83
    v_cvt_pk_bf16_f32 v21, v84, v85
    v_cvt_pk_bf16_f32 v23, v86, v87
    v_cvt_pk_bf16_f32 v24, v56, v57
    v_cvt_pk_bf16_f32 v26, v58, v59
    v_cvt_pk_bf16_f32 v28, v60, v61
    v_cvt_pk_bf16_f32 v30, v62, v63
    v_cvt_pk_bf16_f32 v32, v64, v65
    v_cvt_pk_bf16_f32 v34, v66, v67
    v_cvt_pk_bf16_f32 v36, v68, v69
    v_cvt_pk_bf16_f32 v38, v70, v71
    v_cvt_pk_bf16_f32 v25, v88, v89
    v_cvt_pk_bf16_f32 v27, v90, v91
    v_cvt_pk_bf16_f32 v29, v92, v93
    v_cvt_pk_bf16_f32 v31, v94, v95
    v_cvt_pk_bf16_f32 v33, v96, v97
    v_cvt_pk_bf16_f32 v35, v98, v99
    v_cvt_pk_bf16_f32 v37, v100, v101
    v_cvt_pk_bf16_f32 v39, v102, v103
    s_mov_b32 s40, 151552
    s_cmp_eq_u32 s35, 1
    s_cselect_b32 s40, s40, 8192
    v_mul_lo_u32 v112, v106, s40
    v_lshlrev_b32 v112, 1, v112
    s_cbranch_scc1 L_qkv1_conv_kernel_exk
    v_lshl_add_u32 v112, v105, 3, v112
    s_lshl_b32 s38, s31, 7
    s_add_u32 s38, s38, 7340032
    s_branch L_qkv1_conv_kernel_exj
L_qkv1_conv_kernel_exk:
    v_lshl_add_u32 v112, v105, 4, v112
    s_lshr_b32 s38, s31, 2
    s_lshl_b32 s38, s38, 9
    s_and_b32 s39, s31, 3
    s_lshl_b32 s39, s39, 2
    s_add_u32 s38, s38, s39
    s_add_u32 s38, s38, 65536
L_qkv1_conv_kernel_exj:
    s_mul_i32 s42, s40, 0
    s_add_u32 s42, s42, s38
    buffer_store_dwordx2 v[8:9], v112, s[4:7], s42 offen
    s_mul_i32 s42, s40, 1
    s_add_u32 s42, s42, s38
    buffer_store_dwordx2 v[10:11], v112, s[4:7], s42 offen
    s_mul_i32 s42, s40, 4
    s_add_u32 s42, s42, s38
    buffer_store_dwordx2 v[12:13], v112, s[4:7], s42 offen
    s_mul_i32 s42, s40, 5
    s_add_u32 s42, s42, s38
    buffer_store_dwordx2 v[14:15], v112, s[4:7], s42 offen
    s_mul_i32 s42, s40, 8
    s_add_u32 s42, s42, s38
    buffer_store_dwordx2 v[16:17], v112, s[4:7], s42 offen
    s_mul_i32 s42, s40, 9
    s_add_u32 s42, s42, s38
    buffer_store_dwordx2 v[18:19], v112, s[4:7], s42 offen
    s_mul_i32 s42, s40, 12
    s_add_u32 s42, s42, s38
    buffer_store_dwordx2 v[20:21], v112, s[4:7], s42 offen
    s_mul_i32 s42, s40, 13
    s_add_u32 s42, s42, s38
    buffer_store_dwordx2 v[22:23], v112, s[4:7], s42 offen
    s_mul_i32 s42, s40, 16
    s_add_u32 s42, s42, s38
    buffer_store_dwordx2 v[24:25], v112, s[4:7], s42 offen
    s_mul_i32 s42, s40, 17
    s_add_u32 s42, s42, s38
    buffer_store_dwordx2 v[26:27], v112, s[4:7], s42 offen
    s_mul_i32 s42, s40, 20
    s_add_u32 s42, s42, s38
    buffer_store_dwordx2 v[28:29], v112, s[4:7], s42 offen
    s_mul_i32 s42, s40, 21
    s_add_u32 s42, s42, s38
    buffer_store_dwordx2 v[30:31], v112, s[4:7], s42 offen
    s_mul_i32 s42, s40, 24
    s_add_u32 s42, s42, s38
    buffer_store_dwordx2 v[32:33], v112, s[4:7], s42 offen
    s_mul_i32 s42, s40, 25
    s_add_u32 s42, s42, s38
    buffer_store_dwordx2 v[34:35], v112, s[4:7], s42 offen
    s_mul_i32 s42, s40, 28
    s_add_u32 s42, s42, s38
    buffer_store_dwordx2 v[36:37], v112, s[4:7], s42 offen
    s_mul_i32 s42, s40, 29
    s_add_u32 s42, s42, s38
    buffer_store_dwordx2 v[38:39], v112, s[4:7], s42 offen
    s_branch L_qkv1_conv_kernel_end
L_qkv1_conv_kernel_vt:
    s_barrier
    ds_read_b128 v[8:11], v3 offset:0
    ds_read_b128 v[24:27], v5 offset:0
    ds_read_b128 v[12:15], v3 offset:2048
    ds_read_b128 v[28:31], v5 offset:1024
    s_waitcnt lgkmcnt(2)
    v_mfma_f32_32x32x16_bf16 v[40:55], v[8:11], v[24:27], 0
    ds_read_b128 v[16:19], v4 offset:0
    ds_read_b128 v[32:35], v5 offset:4096
    s_waitcnt lgkmcnt(2)
    v_mfma_f32_32x32x16_bf16 v[56:71], v[8:11], v[28:31], 0
    ds_read_b128 v[20:23], v4 offset:2048
    ds_read_b128 v[36:39], v5 offset:5120
    v_mfma_f32_32x32x16_bf16 v[72:87], v[12:15], v[24:27], 0
    v_mfma_f32_32x32x16_bf16 v[88:103], v[12:15], v[28:31], 0
    s_waitcnt lgkmcnt(2)
    v_mfma_f32_32x32x16_bf16 v[40:55], v[16:19], v[32:35], v[40:55]
    ds_read_b128 v[8:11], v3 offset:8192
    ds_read_b128 v[24:27], v5 offset:8192
    s_waitcnt lgkmcnt(2)
    v_mfma_f32_32x32x16_bf16 v[56:71], v[16:19], v[36:39], v[56:71]
    ds_read_b128 v[12:15], v3 offset:10240
    ds_read_b128 v[28:31], v5 offset:9216
    v_mfma_f32_32x32x16_bf16 v[72:87], v[20:23], v[32:35], v[72:87]
    v_mfma_f32_32x32x16_bf16 v[88:103], v[20:23], v[36:39], v[88:103]
    s_barrier
    s_waitcnt lgkmcnt(2)
    v_mfma_f32_32x32x16_bf16 v[40:55], v[8:11], v[24:27], v[40:55]
    ds_read_b128 v[16:19], v4 offset:8192
    ds_read_b128 v[32:35], v5 offset:12288
    s_waitcnt lgkmcnt(2)
    v_mfma_f32_32x32x16_bf16 v[56:71], v[8:11], v[28:31], v[56:71]
    ds_read_b128 v[20:23], v4 offset:10240
    ds_read_b128 v[36:39], v5 offset:13312
    v_mfma_f32_32x32x16_bf16 v[72:87], v[12:15], v[24:27], v[72:87]
    v_mfma_f32_32x32x16_bf16 v[88:103], v[12:15], v[28:31], v[88:103]
    s_waitcnt lgkmcnt(2)
    v_mfma_f32_32x32x16_bf16 v[40:55], v[16:19], v[32:35], v[40:55]
    ds_read_b128 v[8:11], v3 offset:16384
    ds_read_b128 v[24:27], v5 offset:16384
    s_waitcnt lgkmcnt(2)
    v_mfma_f32_32x32x16_bf16 v[56:71], v[16:19], v[36:39], v[56:71]
    ds_read_b128 v[12:15], v3 offset:18432
    ds_read_b128 v[28:31], v5 offset:17408
    v_mfma_f32_32x32x16_bf16 v[72:87], v[20:23], v[32:35], v[72:87]
    v_mfma_f32_32x32x16_bf16 v[88:103], v[20:23], v[36:39], v[88:103]
    s_barrier
    s_waitcnt lgkmcnt(2)
    v_mfma_f32_32x32x16_bf16 v[40:55], v[8:11], v[24:27], v[40:55]
    ds_read_b128 v[16:19], v4 offset:16384
    ds_read_b128 v[32:35], v5 offset:20480
    s_waitcnt lgkmcnt(2)
    v_mfma_f32_32x32x16_bf16 v[56:71], v[8:11], v[28:31], v[56:71]
    ds_read_b128 v[20:23], v4 offset:18432
    ds_read_b128 v[36:39], v5 offset:21504
    v_mfma_f32_32x32x16_bf16 v[72:87], v[12:15], v[24:27], v[72:87]
    v_mfma_f32_32x32x16_bf16 v[88:103], v[12:15], v[28:31], v[88:103]
    s_waitcnt lgkmcnt(2)
    v_mfma_f32_32x32x16_bf16 v[40:55], v[16:19], v[32:35], v[40:55]
    ds_read_b128 v[8:11], v3 offset:24576
    ds_read_b128 v[24:27], v5 offset:24576
    s_waitcnt lgkmcnt(2)
    v_mfma_f32_32x32x16_bf16 v[56:71], v[16:19], v[36:39], v[56:71]
    ds_read_b128 v[12:15], v3 offset:26624
    ds_read_b128 v[28:31], v5 offset:25600
    v_mfma_f32_32x32x16_bf16 v[72:87], v[20:23], v[32:35], v[72:87]
    v_mfma_f32_32x32x16_bf16 v[88:103], v[20:23], v[36:39], v[88:103]
    s_barrier
    s_waitcnt lgkmcnt(2)
    v_mfma_f32_32x32x16_bf16 v[40:55], v[8:11], v[24:27], v[40:55]
    ds_read_b128 v[16:19], v4 offset:24576
    ds_read_b128 v[32:35], v5 offset:28672
    s_waitcnt lgkmcnt(2)
    v_mfma_f32_32x32x16_bf16 v[56:71], v[8:11], v[28:31], v[56:71]
    ds_read_b128 v[20:23], v4 offset:26624
    ds_read_b128 v[36:39], v5 offset:29696
    v_mfma_f32_32x32x16_bf16 v[72:87], v[12:15], v[24:27], v[72:87]
    v_mfma_f32_32x32x16_bf16 v[88:103], v[12:15], v[28:31], v[88:103]
    s_waitcnt lgkmcnt(2)
    v_mfma_f32_32x32x16_bf16 v[40:55], v[16:19], v[32:35], v[40:55]
    ds_read_b128 v[8:11], v3 offset:32768
    ds_read_b128 v[24:27], v5 offset:32768
    s_waitcnt lgkmcnt(2)
    v_mfma_f32_32x32x16_bf16 v[56:71], v[16:19], v[36:39], v[56:71]
    ds_read_b128 v[12:15], v3 offset:34816
    ds_read_b128 v[28:31], v5 offset:33792
    v_mfma_f32_32x32x16_bf16 v[72:87], v[20:23], v[32:35], v[72:87]
    v_mfma_f32_32x32x16_bf16 v[88:103], v[20:23], v[36:39], v[88:103]
    s_barrier
    s_waitcnt lgkmcnt(2)
    v_mfma_f32_32x32x16_bf16 v[40:55], v[8:11], v[24:27], v[40:55]
    ds_read_b128 v[16:19], v4 offset:32768
    ds_read_b128 v[32:35], v5 offset:36864
    s_waitcnt lgkmcnt(2)
    v_mfma_f32_32x32x16_bf16 v[56:71], v[8:11], v[28:31], v[56:71]
    ds_read_b128 v[20:23], v4 offset:34816
    ds_read_b128 v[36:39], v5 offset:37888
    v_mfma_f32_32x32x16_bf16 v[72:87], v[12:15], v[24:27], v[72:87]
    v_mfma_f32_32x32x16_bf16 v[88:103], v[12:15], v[28:31], v[88:103]
    s_waitcnt lgkmcnt(2)
    v_mfma_f32_32x32x16_bf16 v[40:55], v[16:19], v[32:35], v[40:55]
    ds_read_b128 v[8:11], v3 offset:0
    ds_read_b128 v[24:27], v5 offset:0
    s_waitcnt lgkmcnt(2)
    v_mfma_f32_32x32x16_bf16 v[56:71], v[16:19], v[36:39], v[56:71]
    ds_read_b128 v[12:15], v3 offset:2048
    ds_read_b128 v[28:31], v5 offset:1024
    v_mfma_f32_32x32x16_bf16 v[72:87], v[20:23], v[32:35], v[72:87]
    v_mfma_f32_32x32x16_bf16 v[88:103], v[20:23], v[36:39], v[88:103]
    s_barrier
    s_waitcnt lgkmcnt(2)
    v_mfma_f32_32x32x16_bf16 v[40:55], v[8:11], v[24:27], v[40:55]
    ds_read_b128 v[16:19], v4 offset:0
    ds_read_b128 v[32:35], v5 offset:4096
    s_waitcnt lgkmcnt(2)
    v_mfma_f32_32x32x16_bf16 v[56:71], v[8:11], v[28:31], v[56:71]
    ds_read_b128 v[20:23], v4 offset:2048
    ds_read_b128 v[36:39], v5 offset:5120
    v_mfma_f32_32x32x16_bf16 v[72:87], v[12:15], v[24:27], v[72:87]
    v_mfma_f32_32x32x16_bf16 v[88:103], v[12:15], v[28:31], v[88:103]
    s_waitcnt lgkmcnt(2)
    v_mfma_f32_32x32x16_bf16 v[40:55], v[16:19], v[32:35], v[40:55]
    ds_read_b128 v[8:11], v3 offset:8192
    ds_read_b128 v[24:27], v5 offset:8192
    s_waitcnt lgkmcnt(2)
    v_mfma_f32_32x32x16_bf16 v[56:71], v[16:19], v[36:39], v[56:71]
    ds_read_b128 v[12:15], v3 offset:10240
    ds_read_b128 v[28:31], v5 offset:9216
    v_mfma_f32_32x32x16_bf16 v[72:87], v[20:23], v[32:35], v[72:87]
    v_mfma_f32_32x32x16_bf16 v[88:103], v[20:23], v[36:39], v[88:103]
    s_barrier
    s_waitcnt lgkmcnt(2)
    v_mfma_f32_32x32x16_bf16 v[40:55], v[8:11], v[24:27], v[40:55]
    ds_read_b128 v[16:19], v4 offset:8192
    ds_read_b128 v[32:35], v5 offset:12288
    s_waitcnt lgkmcnt(2)
    v_mfma_f32_32x32x16_bf16 v[56:71], v[8:11], v[28:31], v[56:71]
    ds_read_b128 v[20:23], v4 offset:10240
    ds_read_b128 v[36:39], v5 offset:13312
    v_mfma_f32_32x32x16_bf16 v[72:87], v[12:15], v[24:27], v[72:87]
    v_mfma_f32_32x32x16_bf16 v[88:103], v[12:15], v[28:31], v[88:103]
    s_waitcnt lgkmcnt(2)
    v_mfma_f32_32x32x16_bf16 v[40:55], v[16:19], v[32:35], v[40:55]
    ds_read_b128 v[8:11], v3 offset:16384
    ds_read_b128 v[24:27], v5 offset:16384
    s_waitcnt lgkmcnt(2)
    v_mfma_f32_32x32x16_bf16 v[56:71], v[16:19], v[36:39], v[56:71]
    ds_read_b128 v[12:15], v3 offset:18432
    ds_read_b128 v[28:31], v5 offset:17408
    v_mfma_f32_32x32x16_bf16 v[72:87], v[20:23], v[32:35], v[72:87]
    v_mfma_f32_32x32x16_bf16 v[88:103], v[20:23], v[36:39], v[88:103]
    s_barrier
    s_waitcnt lgkmcnt(2)
    v_mfma_f32_32x32x16_bf16 v[40:55], v[8:11], v[24:27], v[40:55]
    ds_read_b128 v[16:19], v4 offset:16384
    ds_read_b128 v[32:35], v5 offset:20480
    s_waitcnt lgkmcnt(2)
    v_mfma_f32_32x32x16_bf16 v[56:71], v[8:11], v[28:31], v[56:71]
    ds_read_b128 v[20:23], v4 offset:18432
    ds_read_b128 v[36:39], v5 offset:21504
    v_mfma_f32_32x32x16_bf16 v[72:87], v[12:15], v[24:27], v[72:87]
    v_mfma_f32_32x32x16_bf16 v[88:103], v[12:15], v[28:31], v[88:103]
    s_waitcnt lgkmcnt(2)
    v_mfma_f32_32x32x16_bf16 v[40:55], v[16:19], v[32:35], v[40:55]
    ds_read_b128 v[8:11], v3 offset:24576
    ds_read_b128 v[24:27], v5 offset:24576
    s_waitcnt lgkmcnt(2)
    v_mfma_f32_32x32x16_bf16 v[56:71], v[16:19], v[36:39], v[56:71]
    ds_read_b128 v[12:15], v3 offset:26624
    ds_read_b128 v[28:31], v5 offset:25600
    v_mfma_f32_32x32x16_bf16 v[72:87], v[20:23], v[32:35], v[72:87]
    v_mfma_f32_32x32x16_bf16 v[88:103], v[20:23], v[36:39], v[88:103]
    s_barrier
    s_waitcnt lgkmcnt(2)
    v_mfma_f32_32x32x16_bf16 v[40:55], v[8:11], v[24:27], v[40:55]
    ds_read_b128 v[16:19], v4 offset:24576
    ds_read_b128 v[32:35], v5 offset:28672
    s_waitcnt lgkmcnt(2)
    v_mfma_f32_32x32x16_bf16 v[56:71], v[8:11], v[28:31], v[56:71]
    ds_read_b128 v[20:23], v4 offset:26624
    ds_read_b128 v[36:39], v5 offset:29696
    v_mfma_f32_32x32x16_bf16 v[72:87], v[12:15], v[24:27], v[72:87]
    v_mfma_f32_32x32x16_bf16 v[88:103], v[12:15], v[28:31], v[88:103]
    s_waitcnt lgkmcnt(2)
    v_mfma_f32_32x32x16_bf16 v[40:55], v[16:19], v[32:35], v[40:55]
    ds_read_b128 v[8:11], v3 offset:32768
    ds_read_b128 v[24:27], v5 offset:32768
    s_waitcnt lgkmcnt(2)
    v_mfma_f32_32x32x16_bf16 v[56:71], v[16:19], v[36:39], v[56:71]
    ds_read_b128 v[12:15], v3 offset:34816
    ds_read_b128 v[28:31], v5 offset:33792
    v_mfma_f32_32x32x16_bf16 v[72:87], v[20:23], v[32:35], v[72:87]
    v_mfma_f32_32x32x16_bf16 v[88:103], v[20:23], v[36:39], v[88:103]
    s_barrier
    s_waitcnt lgkmcnt(2)
    v_mfma_f32_32x32x16_bf16 v[40:55], v[8:11], v[24:27], v[40:55]
    ds_read_b128 v[16:19], v4 offset:32768
    ds_read_b128 v[32:35], v5 offset:36864
    s_waitcnt lgkmcnt(2)
    v_mfma_f32_32x32x16_bf16 v[56:71], v[8:11], v[28:31], v[56:71]
    ds_read_b128 v[20:23], v4 offset:34816
    ds_read_b128 v[36:39], v5 offset:37888
    v_mfma_f32_32x32x16_bf16 v[72:87], v[12:15], v[24:27], v[72:87]
    v_mfma_f32_32x32x16_bf16 v[88:103], v[12:15], v[28:31], v[88:103]
    s_waitcnt lgkmcnt(2)
    v_mfma_f32_32x32x16_bf16 v[40:55], v[16:19], v[32:35], v[40:55]
    ds_read_b128 v[8:11], v3 offset:0
    ds_read_b128 v[24:27], v5 offset:0
    s_waitcnt lgkmcnt(2)
    v_mfma_f32_32x32x16_bf16 v[56:71], v[16:19], v[36:39], v[56:71]
    ds_read_b128 v[12:15], v3 offset:2048
    ds_read_b128 v[28:31], v5 offset:1024
    v_mfma_f32_32x32x16_bf16 v[72:87], v[20:23], v[32:35], v[72:87]
    v_mfma_f32_32x32x16_bf16 v[88:103], v[20:23], v[36:39], v[88:103]
    s_barrier
    s_waitcnt lgkmcnt(2)
    v_mfma_f32_32x32x16_bf16 v[40:55], v[8:11], v[24:27], v[40:55]
    ds_read_b128 v[16:19], v4 offset:0
    ds_read_b128 v[32:35], v5 offset:4096
    s_waitcnt lgkmcnt(2)
    v_mfma_f32_32x32x16_bf16 v[56:71], v[8:11], v[28:31], v[56:71]
    ds_read_b128 v[20:23], v4 offset:2048
    ds_read_b128 v[36:39], v5 offset:5120
    v_mfma_f32_32x32x16_bf16 v[72:87], v[12:15], v[24:27], v[72:87]
    v_mfma_f32_32x32x16_bf16 v[88:103], v[12:15], v[28:31], v[88:103]
    s_waitcnt lgkmcnt(2)
    v_mfma_f32_32x32x16_bf16 v[40:55], v[16:19], v[32:35], v[40:55]
    ds_read_b128 v[8:11], v3 offset:8192
    ds_read_b128 v[24:27], v5 offset:8192
    s_waitcnt lgkmcnt(2)
    v_mfma_f32_32x32x16_bf16 v[56:71], v[16:19], v[36:39], v[56:71]
    ds_read_b128 v[12:15], v3 offset:10240
    ds_read_b128 v[28:31], v5 offset:9216
    v_mfma_f32_32x32x16_bf16 v[72:87], v[20:23], v[32:35], v[72:87]
    v_mfma_f32_32x32x16_bf16 v[88:103], v[20:23], v[36:39], v[88:103]
    s_barrier
    s_waitcnt lgkmcnt(2)
    v_mfma_f32_32x32x16_bf16 v[40:55], v[8:11], v[24:27], v[40:55]
    ds_read_b128 v[16:19], v4 offset:8192
    ds_read_b128 v[32:35], v5 offset:12288
    s_waitcnt lgkmcnt(2)
    v_mfma_f32_32x32x16_bf16 v[56:71], v[8:11], v[28:31], v[56:71]
    ds_read_b128 v[20:23], v4 offset:10240
    ds_read_b128 v[36:39], v5 offset:13312
    v_mfma_f32_32x32x16_bf16 v[72:87], v[12:15], v[24:27], v[72:87]
    v_mfma_f32_32x32x16_bf16 v[88:103], v[12:15], v[28:31], v[88:103]
    s_waitcnt lgkmcnt(2)
    v_mfma_f32_32x32x16_bf16 v[40:55], v[16:19], v[32:35], v[40:55]
    ds_read_b128 v[8:11], v3 offset:16384
    ds_read_b128 v[24:27], v5 offset:16384
    s_waitcnt lgkmcnt(2)
    v_mfma_f32_32x32x16_bf16 v[56:71], v[16:19], v[36:39], v[56:71]
    ds_read_b128 v[12:15], v3 offset:18432
    ds_read_b128 v[28:31], v5 offset:17408
    v_mfma_f32_32x32x16_bf16 v[72:87], v[20:23], v[32:35], v[72:87]
    v_mfma_f32_32x32x16_bf16 v[88:103], v[20:23], v[36:39], v[88:103]
    s_barrier
    s_waitcnt lgkmcnt(2)
    v_mfma_f32_32x32x16_bf16 v[40:55], v[8:11], v[24:27], v[40:55]
    ds_read_b128 v[16:19], v4 offset:16384
    ds_read_b128 v[32:35], v5 offset:20480
    s_waitcnt lgkmcnt(2)
    v_mfma_f32_32x32x16_bf16 v[56:71], v[8:11], v[28:31], v[56:71]
    ds_read_b128 v[20:23], v4 offset:18432
    ds_read_b128 v[36:39], v5 offset:21504
    v_mfma_f32_32x32x16_bf16 v[72:87], v[12:15], v[24:27], v[72:87]
    v_mfma_f32_32x32x16_bf16 v[88:103], v[12:15], v[28:31], v[88:103]
    s_waitcnt lgkmcnt(2)
    v_mfma_f32_32x32x16_bf16 v[40:55], v[16:19], v[32:35], v[40:55]
    ds_read_b128 v[8:11], v3 offset:24576
    ds_read_b128 v[24:27], v5 offset:24576
    s_waitcnt lgkmcnt(2)
    v_mfma_f32_32x32x16_bf16 v[56:71], v[16:19], v[36:39], v[56:71]
    ds_read_b128 v[12:15], v3 offset:26624
    ds_read_b128 v[28:31], v5 offset:25600
    v_mfma_f32_32x32x16_bf16 v[72:87], v[20:23], v[32:35], v[72:87]
    v_mfma_f32_32x32x16_bf16 v[88:103], v[20:23], v[36:39], v[88:103]
    s_barrier
    s_waitcnt lgkmcnt(2)
    v_mfma_f32_32x32x16_bf16 v[40:55], v[8:11], v[24:27], v[40:55]
    ds_read_b128 v[16:19], v4 offset:24576
    ds_read_b128 v[32:35], v5 offset:28672
    s_waitcnt lgkmcnt(2)
    v_mfma_f32_32x32x16_bf16 v[56:71], v[8:11], v[28:31], v[56:71]
    ds_read_b128 v[20:23], v4 offset:26624
    ds_read_b128 v[36:39], v5 offset:29696
    v_mfma_f32_32x32x16_bf16 v[72:87], v[12:15], v[24:27], v[72:87]
    v_mfma_f32_32x32x16_bf16 v[88:103], v[12:15], v[28:31], v[88:103]
    s_waitcnt lgkmcnt(2)
    v_mfma_f32_32x32x16_bf16 v[40:55], v[16:19], v[32:35], v[40:55]
    ds_read_b128 v[8:11], v3 offset:32768
    ds_read_b128 v[24:27], v5 offset:32768
    s_waitcnt lgkmcnt(2)
    v_mfma_f32_32x32x16_bf16 v[56:71], v[16:19], v[36:39], v[56:71]
    ds_read_b128 v[12:15], v3 offset:34816
    ds_read_b128 v[28:31], v5 offset:33792
    v_mfma_f32_32x32x16_bf16 v[72:87], v[20:23], v[32:35], v[72:87]
    v_mfma_f32_32x32x16_bf16 v[88:103], v[20:23], v[36:39], v[88:103]
    s_barrier
    s_waitcnt lgkmcnt(2)
    v_mfma_f32_32x32x16_bf16 v[40:55], v[8:11], v[24:27], v[40:55]
    ds_read_b128 v[16:19], v4 offset:32768
    ds_read_b128 v[32:35], v5 offset:36864
    s_waitcnt lgkmcnt(2)
    v_mfma_f32_32x32x16_bf16 v[56:71], v[8:11], v[28:31], v[56:71]
    ds_read_b128 v[20:23], v4 offset:34816
    ds_read_b128 v[36:39], v5 offset:37888
    v_mfma_f32_32x32x16_bf16 v[72:87], v[12:15], v[24:27], v[72:87]
    v_mfma_f32_32x32x16_bf16 v[88:103], v[12:15], v[28:31], v[88:103]
    s_waitcnt lgkmcnt(2)
    v_mfma_f32_32x32x16_bf16 v[40:55], v[16:19], v[32:35], v[40:55]
    ds_read_b128 v[8:11], v3 offset:0
    ds_read_b128 v[24:27], v5 offset:0
    s_waitcnt lgkmcnt(2)
    v_mfma_f32_32x32x16_bf16 v[56:71], v[16:19], v[36:39], v[56:71]
    ds_read_b128 v[12:15], v3 offset:2048
    ds_read_b128 v[28:31], v5 offset:1024
    v_mfma_f32_32x32x16_bf16 v[72:87], v[20:23], v[32:35], v[72:87]
    v_mfma_f32_32x32x16_bf16 v[88:103], v[20:23], v[36:39], v[88:103]
    s_barrier
    s_waitcnt lgkmcnt(2)
    v_mfma_f32_32x32x16_bf16 v[40:55], v[8:11], v[24:27], v[40:55]
    ds_read_b128 v[16:19], v4 offset:0
    ds_read_b128 v[32:35], v5 offset:4096
    s_waitcnt lgkmcnt(2)
    v_mfma_f32_32x32x16_bf16 v[56:71], v[8:11], v[28:31], v[56:71]
    ds_read_b128 v[20:23], v4 offset:2048
    ds_read_b128 v[36:39], v5 offset:5120
    v_mfma_f32_32x32x16_bf16 v[72:87], v[12:15], v[24:27], v[72:87]
    v_mfma_f32_32x32x16_bf16 v[88:103], v[12:15], v[28:31], v[88:103]
    s_waitcnt lgkmcnt(2)
    v_mfma_f32_32x32x16_bf16 v[40:55], v[16:19], v[32:35], v[40:55]
    ds_read_b128 v[8:11], v3 offset:8192
    ds_read_b128 v[24:27], v5 offset:8192
    s_waitcnt lgkmcnt(2)
    v_mfma_f32_32x32x16_bf16 v[56:71], v[16:19], v[36:39], v[56:71]
    ds_read_b128 v[12:15], v3 offset:10240
    ds_read_b128 v[28:31], v5 offset:9216
    v_mfma_f32_32x32x16_bf16 v[72:87], v[20:23], v[32:35], v[72:87]
    v_mfma_f32_32x32x16_bf16 v[88:103], v[20:23], v[36:39], v[88:103]
    s_barrier
    s_waitcnt lgkmcnt(2)
    v_mfma_f32_32x32x16_bf16 v[40:55], v[8:11], v[24:27], v[40:55]
    ds_read_b128 v[16:19], v4 offset:8192
    ds_read_b128 v[32:35], v5 offset:12288
    s_waitcnt lgkmcnt(2)
    v_mfma_f32_32x32x16_bf16 v[56:71], v[8:11], v[28:31], v[56:71]
    ds_read_b128 v[20:23], v4 offset:10240
    ds_read_b128 v[36:39], v5 offset:13312
    v_mfma_f32_32x32x16_bf16 v[72:87], v[12:15], v[24:27], v[72:87]
    v_mfma_f32_32x32x16_bf16 v[88:103], v[12:15], v[28:31], v[88:103]
    s_waitcnt lgkmcnt(2)
    v_mfma_f32_32x32x16_bf16 v[40:55], v[16:19], v[32:35], v[40:55]
    ds_read_b128 v[8:11], v3 offset:16384
    ds_read_b128 v[24:27], v5 offset:16384
    s_waitcnt lgkmcnt(2)
    v_mfma_f32_32x32x16_bf16 v[56:71], v[16:19], v[36:39], v[56:71]
    ds_read_b128 v[12:15], v3 offset:18432
    ds_read_b128 v[28:31], v5 offset:17408
    v_mfma_f32_32x32x16_bf16 v[72:87], v[20:23], v[32:35], v[72:87]
    v_mfma_f32_32x32x16_bf16 v[88:103], v[20:23], v[36:39], v[88:103]
    s_barrier
    s_waitcnt lgkmcnt(2)
    v_mfma_f32_32x32x16_bf16 v[40:55], v[8:11], v[24:27], v[40:55]
    ds_read_b128 v[16:19], v4 offset:16384
    ds_read_b128 v[32:35], v5 offset:20480
    s_waitcnt lgkmcnt(2)
    v_mfma_f32_32x32x16_bf16 v[56:71], v[8:11], v[28:31], v[56:71]
    ds_read_b128 v[20:23], v4 offset:18432
    ds_read_b128 v[36:39], v5 offset:21504
    v_mfma_f32_32x32x16_bf16 v[72:87], v[12:15], v[24:27], v[72:87]
    v_mfma_f32_32x32x16_bf16 v[88:103], v[12:15], v[28:31], v[88:103]
    s_waitcnt lgkmcnt(2)
    v_mfma_f32_32x32x16_bf16 v[40:55], v[16:19], v[32:35], v[40:55]
    s_waitcnt lgkmcnt(0)
    v_mfma_f32_32x32x16_bf16 v[56:71], v[16:19], v[36:39], v[56:71]
    v_mfma_f32_32x32x16_bf16 v[72:87], v[20:23], v[32:35], v[72:87]
    v_mfma_f32_32x32x16_bf16 v[88:103], v[20:23], v[36:39], v[88:103]
    s_lshl_b32 s30, s29, 8
    v_lshlrev_b32 v109, 2, v105
    v_add_u32 v109, s30, v109
    ds_read_b32 v112, v109 offset:26624
    ds_read_b32 v114, v109 offset:26752
    s_lshl_b32 s30, s28, 8
    v_lshlrev_b32 v110, 4, v106
    v_add_u32 v110, s30, v110
    ds_read_b128 v[8:11], v110 offset:24576
    ds_read_b128 v[24:27], v110 offset:25088
    ds_read_b128 v[12:15], v110 offset:24608
    ds_read_b128 v[28:31], v110 offset:25120
    ds_read_b128 v[16:19], v110 offset:24640
    ds_read_b128 v[32:35], v110 offset:25152
    ds_read_b128 v[20:23], v110 offset:24672
    ds_read_b128 v[36:39], v110 offset:25184
    s_sub_u32 s34, s9, 8
    s_lshl_b32 s37, s34, 2
    s_lshl_b32 s38, s29, 1
    s_add_u32 s37, s37, s38
    s_lshl_b32 s37, s37, 5
    v_add_u32 v118, s37, v105
    v_add_u32 v118, 0, v118
    v_mul_u32_u24 v119, 3641, v118
    v_lshrrev_b32 v119, 16, v119
    v_mul_u32_u24 v120, 18, v119
    v_sub_u32 v120, v118, v120
    s_mov_b32 s40, 151552
    v_mul_lo_u32 v119, v119, s40
    v_lshl_add_u32 v119, v120, 4, v119
    v_mul_u32_u24 v121, 304, v106
    v_add_u32 v3, v119, v121
    v_cmp_gt_u32 vcc, 576, v118
    s_mov_b64 s[44:45], vcc
    v_cmp_eq_u32 vcc, 17, v120
    s_and_b64 s[46:47], vcc, s[44:45]
    v_add_u32 v118, s37, v105
    v_add_u32 v118, 32, v118
    v_mul_u32_u24 v119, 3641, v118
    v_lshrrev_b32 v119, 16, v119
    v_mul_u32_u24 v120, 18, v119
    v_sub_u32 v120, v118, v120
    s_mov_b32 s40, 151552
    v_mul_lo_u32 v119, v119, s40
    v_lshl_add_u32 v119, v120, 4, v119
    v_mul_u32_u24 v121, 304, v106
    v_add_u32 v4, v119, v121
    v_cmp_gt_u32 vcc, 576, v118
    s_mov_b64 s[48:49], vcc
    v_cmp_eq_u32 vcc, 17, v120
    s_and_b64 s[50:51], vcc, s[48:49]
    s_mul_i32 s38, s31, 1216
    s_add_u32 s38, s38, 73728
    v_mov_b32 v120, 0x3f803f80
    v_mov_b32 v121, 0x3f803f80
    v_mov_b32 v122, 0x3f803f80
    v_mov_b32 v123, 0x3f803f80
    s_waitcnt lgkmcnt(0)
    v_mov_b32 v113, v112
    v_mov_b32 v115, v114
    v_pk_mul_f32 v[116:117], v[24:25], v[112:113]
    v_pk_fma_f32 v[40:41], v[40:41], v[8:9], v[116:117] neg_lo:[0,0,1] neg_hi:[0,0,1]
    v_pk_mul_f32 v[116:117], v[26:27], v[112:113]
    v_pk_fma_f32 v[42:43], v[42:43], v[10:11], v[116:117] neg_lo:[0,0,1] neg_hi:[0,0,1]
    v_pk_mul_f32 v[116:117], v[28:29], v[112:113]
    v_pk_fma_f32 v[44:45], v[44:45], v[12:13], v[116:117] neg_lo:[0,0,1] neg_hi:[0,0,1]
    v_pk_mul_f32 v[116:117], v[30:31], v[112:113]
    v_pk_fma_f32 v[46:47], v[46:47], v[14:15], v[116:117] neg_lo:[0,0,1] neg_hi:[0,0,1]
    v_pk_mul_f32 v[116:117], v[32:33], v[112:113]
    v_pk_fma_f32 v[48:49], v[48:49], v[16:17], v[116:117] neg_lo:[0,0,1] neg_hi:[0,0,1]
    v_pk_mul_f32 v[116:117], v[34:35], v[112:113]
    v_pk_fma_f32 v[50:51], v[50:51], v[18:19], v[116:117] neg_lo:[0,0,1] neg_hi:[0,0,1]
    v_pk_mul_f32 v[116:117], v[36:37], v[112:113]
    v_pk_fma_f32 v[52:53], v[52:53], v[20:21], v[116:117] neg_lo:[0,0,1] neg_hi:[0,0,1]
    v_pk_mul_f32 v[116:117], v[38:39], v[112:113]
    v_pk_fma_f32 v[54:55], v[54:55], v[22:23], v[116:117] neg_lo:[0,0,1] neg_hi:[0,0,1]
    v_cvt_pk_bf16_f32 v40, v40, v41
    v_cvt_pk_bf16_f32 v41, v42, v43
    v_cvt_pk_bf16_f32 v42, v44, v45
    v_cvt_pk_bf16_f32 v43, v46, v47
    v_cvt_pk_bf16_f32 v44, v48, v49
    v_cvt_pk_bf16_f32 v45, v50, v51
    v_cvt_pk_bf16_f32 v46, v52, v53
    v_cvt_pk_bf16_f32 v47, v54, v55
    s_mov_b64 exec, s[44:45]
    buffer_store_dwordx4 v[40:43], v3, s[4:7], s38 offen offset:0 nt
    buffer_store_dwordx4 v[44:47], v3, s[4:7], s38 offen offset:608 nt
    s_mov_b64 exec, -1
    v_pk_mul_f32 v[116:117], v[24:25], v[114:115]
    v_pk_fma_f32 v[56:57], v[56:57], v[8:9], v[116:117] neg_lo:[0,0,1] neg_hi:[0,0,1]
    v_pk_mul_f32 v[116:117], v[26:27], v[114:115]
    v_pk_fma_f32 v[58:59], v[58:59], v[10:11], v[116:117] neg_lo:[0,0,1] neg_hi:[0,0,1]
    v_pk_mul_f32 v[116:117], v[28:29], v[114:115]
    v_pk_fma_f32 v[60:61], v[60:61], v[12:13], v[116:117] neg_lo:[0,0,1] neg_hi:[0,0,1]
    v_pk_mul_f32 v[116:117], v[30:31], v[114:115]
    v_pk_fma_f32 v[62:63], v[62:63], v[14:15], v[116:117] neg_lo:[0,0,1] neg_hi:[0,0,1]
    v_pk_mul_f32 v[116:117], v[32:33], v[114:115]
    v_pk_fma_f32 v[64:65], v[64:65], v[16:17], v[116:117] neg_lo:[0,0,1] neg_hi:[0,0,1]
    v_pk_mul_f32 v[116:117], v[34:35], v[114:115]
    v_pk_fma_f32 v[66:67], v[66:67], v[18:19], v[116:117] neg_lo:[0,0,1] neg_hi:[0,0,1]
    v_pk_mul_f32 v[116:117], v[36:37], v[114:115]
    v_pk_fma_f32 v[68:69], v[68:69], v[20:21], v[116:117] neg_lo:[0,0,1] neg_hi:[0,0,1]
    v_pk_mul_f32 v[116:117], v[38:39], v[114:115]
    v_pk_fma_f32 v[70:71], v[70:71], v[22:23], v[116:117] neg_lo:[0,0,1] neg_hi:[0,0,1]
    v_cvt_pk_bf16_f32 v56, v56, v57
    v_cvt_pk_bf16_f32 v57, v58, v59
    v_cvt_pk_bf16_f32 v58, v60, v61
    v_cvt_pk_bf16_f32 v59, v62, v63
    v_cvt_pk_bf16_f32 v60, v64, v65
    v_cvt_pk_bf16_f32 v61, v66, v67
    v_cvt_pk_bf16_f32 v62, v68, v69
    v_cvt_pk_bf16_f32 v63, v70, v71
    s_mov_b64 exec, s[48:49]
    buffer_store_dwordx4 v[56:59], v4, s[4:7], s38 offen offset:0 nt
    buffer_store_dwordx4 v[60:63], v4, s[4:7], s38 offen offset:608 nt
    s_mov_b64 exec, -1
    ds_read_b128 v[8:11], v110 offset:24704
    ds_read_b128 v[24:27], v110 offset:25216
    ds_read_b128 v[12:15], v110 offset:24736
    ds_read_b128 v[28:31], v110 offset:25248
    ds_read_b128 v[16:19], v110 offset:24768
    ds_read_b128 v[32:35], v110 offset:25280
    ds_read_b128 v[20:23], v110 offset:24800
    ds_read_b128 v[36:39], v110 offset:25312
    s_waitcnt lgkmcnt(0)
    v_pk_mul_f32 v[116:117], v[24:25], v[112:113]
    v_pk_fma_f32 v[72:73], v[72:73], v[8:9], v[116:117] neg_lo:[0,0,1] neg_hi:[0,0,1]
    v_pk_mul_f32 v[116:117], v[26:27], v[112:113]
    v_pk_fma_f32 v[74:75], v[74:75], v[10:11], v[116:117] neg_lo:[0,0,1] neg_hi:[0,0,1]
    v_pk_mul_f32 v[116:117], v[28:29], v[112:113]
    v_pk_fma_f32 v[76:77], v[76:77], v[12:13], v[116:117] neg_lo:[0,0,1] neg_hi:[0,0,1]
    v_pk_mul_f32 v[116:117], v[30:31], v[112:113]
    v_pk_fma_f32 v[78:79], v[78:79], v[14:15], v[116:117] neg_lo:[0,0,1] neg_hi:[0,0,1]
    v_pk_mul_f32 v[116:117], v[32:33], v[112:113]
    v_pk_fma_f32 v[80:81], v[80:81], v[16:17], v[116:117] neg_lo:[0,0,1] neg_hi:[0,0,1]
    v_pk_mul_f32 v[116:117], v[34:35], v[112:113]
    v_pk_fma_f32 v[82:83], v[82:83], v[18:19], v[116:117] neg_lo:[0,0,1] neg_hi:[0,0,1]
    v_pk_mul_f32 v[116:117], v[36:37], v[112:113]
    v_pk_fma_f32 v[84:85], v[84:85], v[20:21], v[116:117] neg_lo:[0,0,1] neg_hi:[0,0,1]
    v_pk_mul_f32 v[116:117], v[38:39], v[112:113]
    v_pk_fma_f32 v[86:87], v[86:87], v[22:23], v[116:117] neg_lo:[0,0,1] neg_hi:[0,0,1]
    v_cvt_pk_bf16_f32 v72, v72, v73
    v_cvt_pk_bf16_f32 v73, v74, v75
    v_cvt_pk_bf16_f32 v74, v76, v77
    v_cvt_pk_bf16_f32 v75, v78, v79
    v_cvt_pk_bf16_f32 v76, v80, v81
    v_cvt_pk_bf16_f32 v77, v82, v83
    v_cvt_pk_bf16_f32 v78, v84, v85
    v_cvt_pk_bf16_f32 v79, v86, v87
    s_mov_b64 exec, s[44:45]
    buffer_store_dwordx4 v[72:75], v3, s[4:7], s38 offen offset:1216 nt
    buffer_store_dwordx4 v[76:79], v3, s[4:7], s38 offen offset:1824 nt
    s_mov_b64 exec, -1
    v_pk_mul_f32 v[116:117], v[24:25], v[114:115]
    v_pk_fma_f32 v[88:89], v[88:89], v[8:9], v[116:117] neg_lo:[0,0,1] neg_hi:[0,0,1]
    v_pk_mul_f32 v[116:117], v[26:27], v[114:115]
    v_pk_fma_f32 v[90:91], v[90:91], v[10:11], v[116:117] neg_lo:[0,0,1] neg_hi:[0,0,1]
    v_pk_mul_f32 v[116:117], v[28:29], v[114:115]
    v_pk_fma_f32 v[92:93], v[92:93], v[12:13], v[116:117] neg_lo:[0,0,1] neg_hi:[0,0,1]
    v_pk_mul_f32 v[116:117], v[30:31], v[114:115]
    v_pk_fma_f32 v[94:95], v[94:95], v[14:15], v[116:117] neg_lo:[0,0,1] neg_hi:[0,0,1]
    v_pk_mul_f32 v[116:117], v[32:33], v[114:115]
    v_pk_fma_f32 v[96:97], v[96:97], v[16:17], v[116:117] neg_lo:[0,0,1] neg_hi:[0,0,1]
    v_pk_mul_f32 v[116:117], v[34:35], v[114:115]
    v_pk_fma_f32 v[98:99], v[98:99], v[18:19], v[116:117] neg_lo:[0,0,1] neg_hi:[0,0,1]
    v_pk_mul_f32 v[116:117], v[36:37], v[114:115]
    v_pk_fma_f32 v[100:101], v[100:101], v[20:21], v[116:117] neg_lo:[0,0,1] neg_hi:[0,0,1]
    v_pk_mul_f32 v[116:117], v[38:39], v[114:115]
    v_pk_fma_f32 v[102:103], v[102:103], v[22:23], v[116:117] neg_lo:[0,0,1] neg_hi:[0,0,1]
    v_cvt_pk_bf16_f32 v88, v88, v89
    v_cvt_pk_bf16_f32 v89, v90, v91
    v_cvt_pk_bf16_f32 v90, v92, v93
    v_cvt_pk_bf16_f32 v91, v94, v95
    v_cvt_pk_bf16_f32 v92, v96, v97
    v_cvt_pk_bf16_f32 v93, v98, v99
    v_cvt_pk_bf16_f32 v94, v100, v101
    v_cvt_pk_bf16_f32 v95, v102, v103
    s_mov_b64 exec, s[48:49]
    buffer_store_dwordx4 v[88:91], v4, s[4:7], s38 offen offset:1216 nt
    buffer_store_dwordx4 v[92:95], v4, s[4:7], s38 offen offset:1824 nt
    s_mov_b64 exec, -1
L_qkv1_conv_kernel_end:
L_qkv1_conv_kernel_exit:
    s_endpgm
L_qkv1_conv_kernel_conv:
    s_sub_u32 s3, s2, 224
    s_load_dwordx2 s[12:13], s[0:1], 88
    s_load_dwordx2 s[14:15], s[0:1], 56
    s_load_dwordx2 s[16:17], s[0:1], 64
    v_lshrrev_b32 v1, 6, v0
    v_and_b32 v2, 63, v0
    v_readfirstlane_b32 s10, v1
    v_lshlrev_b32 v7, 4, v2
    s_lshr_b32 s28, s10, 2
    s_and_b32 s29, s10, 3
    s_lshl_b32 s8, s3, 1
    s_waitcnt lgkmcnt(0)
    s_lshl_b32 s9, s3, 2
    s_add_u32 s16, s16, s9
    s_addc_u32 s17, s17, 0
    s_load_dword s33, s[16:17], 0
    s_mov_b32 s4, s12
    s_and_b32 s5, s13, 0xffff
    s_mov_b32 s6, 0x10000000
    s_mov_b32 s7, 0x00020000
    s_mov_b32 s20, s14
    s_and_b32 s21, s15, 0xffff
    s_mov_b32 s22, 0x240000
    s_mov_b32 s23, 0x00020000
    s_add_u32 s30, s8, s28
    s_lshl_b32 s30, s30, 12
    s_lshl_b32 s31, s29, 10
    s_add_u32 s30, s30, s31
    buffer_load_dwordx4 v[16:19], v7, s[20:23], s30 offen
    buffer_load_dword v20, v7, s[20:23], s30 offen offset:16
    s_add_u32 s38, s30, 17825792
    s_mul_i32 s32, s28, 4608
    s_add_u32 s39, s32, s31
    s_add_u32 s39, s39, 66048
    v_mov_b32 v8, 0
    s_mov_b32 m0, s39
    s_nop 0
    buffer_load_dwordx4 v7, s[4:7], s38 offen  lds
    v_mov_b32 v9, 0
    v_mov_b32 v10, 0
    v_mov_b32 v11, 0
    s_mul_i32 s37, s28, 8320
    s_add_u32 s32, s37, s31
    v_add_u32 v21, s32, v7
    s_cmp_eq_u32 s29, 0
    s_cbranch_scc0 L_qkv1_conv_kernelc_nz
    s_mul_i32 s32, s28, 4608
    s_add_u32 s32, s32, 65536
    v_add_u32 v12, s32, v7
    v_add_u32 v13, s37, v7
    s_mov_b32 exec_hi, 0
    ds_write_b128 v12, v[8:11]
    s_mov_b32 exec_lo, 3
    ds_write_b128 v13, v[8:11]
    ds_write_b128 v13, v[8:11] offset:4160
    s_mov_b64 exec, -1
L_qkv1_conv_kernelc_nz:
    s_waitcnt vmcnt(1)
    v_alignbit_b32 v24, v17, v16, 16
    v_alignbit_b32 v25, v18, v17, 16
    v_alignbit_b32 v26, v19, v18, 16
    v_alignbit_b32 v27, v20, v19, 16
    ds_write_b128 v21, v[16:19] offset:32
    ds_write_b128 v21, v[24:27] offset:4192
    s_cmp_eq_u32 s29, 0
    s_cbranch_scc0 L_qkv1_conv_kernelc_nz2
    v_lshlrev_b32 v22, 16, v16
    v_mov_b32 v23, s37
    s_waitcnt lgkmcnt(0)
    s_mov_b64 exec, 1
    ds_write_b32 v23, v22 offset:4188
    s_mov_b64 exec, -1
L_qkv1_conv_kernelc_nz2:
    v_and_b32 v12, 15, v2
    v_lshrrev_b32 v13, 5, v2
    v_bfe_u32 v14, v2, 4, 1
    v_add_u32 v15, 1, v12
    v_lshrrev_b32 v15, 1, v15
    v_lshlrev_b32 v3, 2, v15
    v_lshl_add_u32 v3, v13, 5, v3
    v_lshl_add_u32 v3, v14, 4, v3
    v_and_b32 v15, 1, v12
    v_sub_u32 v15, 1, v15
    v_mul_u32_u24 v15, 4160, v15
    v_add_u32 v3, v3, v15
    s_lshl_b32 s34, s29, 7
    s_add_u32 s32, s37, s34
    v_add_u32 v3, s32, v3
    v_add_u32 v112, 1024, v3
    v_add_u32 v113, 2048, v3
    v_add_u32 v114, 3072, v3
    v_sub_u32 v4, v12, v13
    v_lshlrev_b32 v4, 5, v4
    v_lshl_add_u32 v4, v14, 4, v4
    s_mul_i32 s32, s28, 4608
    s_add_u32 s32, s32, 66048
    s_sub_u32 s32, s32, s34
    v_add_u32 v4, s32, v4
    v_mov_b32 v80, 0
    v_mov_b32 v81, 0
    v_mov_b32 v82, 0
    v_mov_b32 v83, 0
    v_mov_b32 v84, 0
    v_mov_b32 v85, 0
    v_mov_b32 v86, 0
    v_mov_b32 v87, 0
    v_mov_b32 v88, 0
    v_mov_b32 v89, 0
    v_mov_b32 v90, 0
    v_mov_b32 v91, 0
    v_mov_b32 v92, 0
    v_mov_b32 v93, 0
    v_mov_b32 v94, 0
    v_mov_b32 v95, 0
    v_mov_b32 v96, 0
    v_mov_b32 v97, 0
    v_mov_b32 v98, 0
    v_mov_b32 v99, 0
    v_mov_b32 v100, 0
    v_mov_b32 v101, 0
    v_mov_b32 v102, 0
    v_mov_b32 v103, 0
    v_mov_b32 v104, 0
    v_mov_b32 v105, 0
    v_mov_b32 v106, 0
    v_mov_b32 v107, 0
    v_mov_b32 v108, 0
    v_mov_b32 v109, 0
    v_mov_b32 v110, 0
    v_mov_b32 v111, 0
    s_waitcnt vmcnt(0) lgkmcnt(0)
    s_barrier
    ds_read2_b32 v[16:17], v3 offset0:0 offset1:1
    ds_read2_b32 v[18:19], v3 offset0:2 offset1:3
    ds_read_b128 v[48:51], v4 offset:0
    ds_read2_b32 v[20:21], v3 offset0:128 offset1:129
    ds_read2_b32 v[22:23], v3 offset0:130 offset1:131
    ds_read_b128 v[52:55], v4 offset:512
    ds_read2_b32 v[24:25], v112 offset0:0 offset1:1
    ds_read2_b32 v[26:27], v112 offset0:2 offset1:3
    ds_read_b128 v[56:59], v4 offset:1024
    ds_read2_b32 v[28:29], v112 offset0:128 offset1:129
    ds_read2_b32 v[30:31], v112 offset0:130 offset1:131
    ds_read_b128 v[60:63], v4 offset:1536
    ds_read2_b32 v[32:33], v113 offset0:0 offset1:1
    ds_read2_b32 v[34:35], v113 offset0:2 offset1:3
    ds_read_b128 v[64:67], v4 offset:2048
    ds_read2_b32 v[36:37], v113 offset0:128 offset1:129
    ds_read2_b32 v[38:39], v113 offset0:130 offset1:131
    ds_read_b128 v[68:71], v4 offset:2560
    ds_read2_b32 v[40:41], v114 offset0:0 offset1:1
    ds_read2_b32 v[42:43], v114 offset0:2 offset1:3
    ds_read_b128 v[72:75], v4 offset:3072
    ds_read2_b32 v[44:45], v114 offset0:128 offset1:129
    ds_read2_b32 v[46:47], v114 offset0:130 offset1:131
    ds_read_b128 v[76:79], v4 offset:3584
    v_subrev_u32 v4, 64, v4
    s_waitcnt lgkmcnt(15)
    v_mfma_f32_16x16x32_bf16 v[80:83], v[16:19], v[48:51], v[80:83]
    s_waitcnt lgkmcnt(15)
    v_mfma_f32_16x16x32_bf16 v[84:87], v[16:19], v[52:55], v[84:87]
    v_mfma_f32_16x16x32_bf16 v[84:87], v[20:23], v[48:51], v[84:87]
    s_waitcnt lgkmcnt(15)
    v_mfma_f32_16x16x32_bf16 v[88:91], v[16:19], v[56:59], v[88:91]
    v_mfma_f32_16x16x32_bf16 v[88:91], v[20:23], v[52:55], v[88:91]
    v_mfma_f32_16x16x32_bf16 v[88:91], v[24:27], v[48:51], v[88:91]
    s_waitcnt lgkmcnt(12)
    v_mfma_f32_16x16x32_bf16 v[92:95], v[16:19], v[60:63], v[92:95]
    v_mfma_f32_16x16x32_bf16 v[92:95], v[20:23], v[56:59], v[92:95]
    v_mfma_f32_16x16x32_bf16 v[92:95], v[24:27], v[52:55], v[92:95]
    v_mfma_f32_16x16x32_bf16 v[92:95], v[28:31], v[48:51], v[92:95]
    s_waitcnt lgkmcnt(9)
    v_mfma_f32_16x16x32_bf16 v[96:99], v[16:19], v[64:67], v[96:99]
    v_mfma_f32_16x16x32_bf16 v[96:99], v[20:23], v[60:63], v[96:99]
    v_mfma_f32_16x16x32_bf16 v[96:99], v[24:27], v[56:59], v[96:99]
    v_mfma_f32_16x16x32_bf16 v[96:99], v[28:31], v[52:55], v[96:99]
    v_mfma_f32_16x16x32_bf16 v[96:99], v[32:35], v[48:51], v[96:99]
    s_waitcnt lgkmcnt(6)
    v_mfma_f32_16x16x32_bf16 v[100:103], v[16:19], v[68:71], v[100:103]
    v_mfma_f32_16x16x32_bf16 v[100:103], v[20:23], v[64:67], v[100:103]
    v_mfma_f32_16x16x32_bf16 v[100:103], v[24:27], v[60:63], v[100:103]
    v_mfma_f32_16x16x32_bf16 v[100:103], v[28:31], v[56:59], v[100:103]
    v_mfma_f32_16x16x32_bf16 v[100:103], v[32:35], v[52:55], v[100:103]
    v_mfma_f32_16x16x32_bf16 v[100:103], v[36:39], v[48:51], v[100:103]
    s_waitcnt lgkmcnt(3)
    v_mfma_f32_16x16x32_bf16 v[104:107], v[16:19], v[72:75], v[104:107]
    v_mfma_f32_16x16x32_bf16 v[104:107], v[20:23], v[68:71], v[104:107]
    v_mfma_f32_16x16x32_bf16 v[104:107], v[24:27], v[64:67], v[104:107]
    v_mfma_f32_16x16x32_bf16 v[104:107], v[28:31], v[60:63], v[104:107]
    v_mfma_f32_16x16x32_bf16 v[104:107], v[32:35], v[56:59], v[104:107]
    v_mfma_f32_16x16x32_bf16 v[104:107], v[36:39], v[52:55], v[104:107]
    v_mfma_f32_16x16x32_bf16 v[104:107], v[40:43], v[48:51], v[104:107]
    s_waitcnt lgkmcnt(0)
    v_mfma_f32_16x16x32_bf16 v[108:111], v[16:19], v[76:79], v[108:111]
    v_mfma_f32_16x16x32_bf16 v[108:111], v[20:23], v[72:75], v[108:111]
    v_mfma_f32_16x16x32_bf16 v[108:111], v[24:27], v[68:71], v[108:111]
    v_mfma_f32_16x16x32_bf16 v[108:111], v[28:31], v[64:67], v[108:111]
    v_mfma_f32_16x16x32_bf16 v[108:111], v[32:35], v[60:63], v[108:111]
    v_mfma_f32_16x16x32_bf16 v[108:111], v[36:39], v[56:59], v[108:111]
    v_mfma_f32_16x16x32_bf16 v[108:111], v[40:43], v[52:55], v[108:111]
    v_mfma_f32_16x16x32_bf16 v[108:111], v[44:47], v[48:51], v[108:111]
    ds_read2_b32 v[16:17], v3 offset0:16 offset1:17
    ds_read2_b32 v[18:19], v3 offset0:18 offset1:19
    ds_read_b128 v[48:51], v4 offset:0
    ds_read2_b32 v[20:21], v3 offset0:144 offset1:145
    ds_read2_b32 v[22:23], v3 offset0:146 offset1:147
    ds_read_b128 v[52:55], v4 offset:512
    ds_read2_b32 v[24:25], v112 offset0:16 offset1:17
    ds_read2_b32 v[26:27], v112 offset0:18 offset1:19
    ds_read_b128 v[56:59], v4 offset:1024
    ds_read2_b32 v[28:29], v112 offset0:144 offset1:145
    ds_read2_b32 v[30:31], v112 offset0:146 offset1:147
    ds_read_b128 v[60:63], v4 offset:1536
    ds_read2_b32 v[32:33], v113 offset0:16 offset1:17
    ds_read2_b32 v[34:35], v113 offset0:18 offset1:19
    ds_read_b128 v[64:67], v4 offset:2048
    ds_read2_b32 v[36:37], v113 offset0:144 offset1:145
    ds_read2_b32 v[38:39], v113 offset0:146 offset1:147
    ds_read_b128 v[68:71], v4 offset:2560
    ds_read2_b32 v[40:41], v114 offset0:16 offset1:17
    ds_read2_b32 v[42:43], v114 offset0:18 offset1:19
    ds_read_b128 v[72:75], v4 offset:3072
    ds_read2_b32 v[44:45], v114 offset0:144 offset1:145
    ds_read2_b32 v[46:47], v114 offset0:146 offset1:147
    ds_read_b128 v[76:79], v4 offset:3584
    s_waitcnt lgkmcnt(15)
    v_mfma_f32_16x16x32_bf16 v[80:83], v[16:19], v[48:51], v[80:83]
    s_waitcnt lgkmcnt(15)
    v_mfma_f32_16x16x32_bf16 v[84:87], v[16:19], v[52:55], v[84:87]
    v_mfma_f32_16x16x32_bf16 v[84:87], v[20:23], v[48:51], v[84:87]
    s_waitcnt lgkmcnt(15)
    v_mfma_f32_16x16x32_bf16 v[88:91], v[16:19], v[56:59], v[88:91]
    v_mfma_f32_16x16x32_bf16 v[88:91], v[20:23], v[52:55], v[88:91]
    v_mfma_f32_16x16x32_bf16 v[88:91], v[24:27], v[48:51], v[88:91]
    s_waitcnt lgkmcnt(12)
    v_mfma_f32_16x16x32_bf16 v[92:95], v[16:19], v[60:63], v[92:95]
    v_mfma_f32_16x16x32_bf16 v[92:95], v[20:23], v[56:59], v[92:95]
    v_mfma_f32_16x16x32_bf16 v[92:95], v[24:27], v[52:55], v[92:95]
    v_mfma_f32_16x16x32_bf16 v[92:95], v[28:31], v[48:51], v[92:95]
    s_waitcnt lgkmcnt(9)
    v_mfma_f32_16x16x32_bf16 v[96:99], v[16:19], v[64:67], v[96:99]
    v_mfma_f32_16x16x32_bf16 v[96:99], v[20:23], v[60:63], v[96:99]
    v_mfma_f32_16x16x32_bf16 v[96:99], v[24:27], v[56:59], v[96:99]
    v_mfma_f32_16x16x32_bf16 v[96:99], v[28:31], v[52:55], v[96:99]
    v_mfma_f32_16x16x32_bf16 v[96:99], v[32:35], v[48:51], v[96:99]
    s_waitcnt lgkmcnt(6)
    v_mfma_f32_16x16x32_bf16 v[100:103], v[16:19], v[68:71], v[100:103]
    v_mfma_f32_16x16x32_bf16 v[100:103], v[20:23], v[64:67], v[100:103]
    v_mfma_f32_16x16x32_bf16 v[100:103], v[24:27], v[60:63], v[100:103]
    v_mfma_f32_16x16x32_bf16 v[100:103], v[28:31], v[56:59], v[100:103]
    v_mfma_f32_16x16x32_bf16 v[100:103], v[32:35], v[52:55], v[100:103]
    v_mfma_f32_16x16x32_bf16 v[100:103], v[36:39], v[48:51], v[100:103]
    s_waitcnt lgkmcnt(3)
    v_mfma_f32_16x16x32_bf16 v[104:107], v[16:19], v[72:75], v[104:107]
    v_mfma_f32_16x16x32_bf16 v[104:107], v[20:23], v[68:71], v[104:107]
    v_mfma_f32_16x16x32_bf16 v[104:107], v[24:27], v[64:67], v[104:107]
    v_mfma_f32_16x16x32_bf16 v[104:107], v[28:31], v[60:63], v[104:107]
    v_mfma_f32_16x16x32_bf16 v[104:107], v[32:35], v[56:59], v[104:107]
    v_mfma_f32_16x16x32_bf16 v[104:107], v[36:39], v[52:55], v[104:107]
    v_mfma_f32_16x16x32_bf16 v[104:107], v[40:43], v[48:51], v[104:107]
    s_waitcnt lgkmcnt(0)
    v_mfma_f32_16x16x32_bf16 v[108:111], v[16:19], v[76:79], v[108:111]
    v_mfma_f32_16x16x32_bf16 v[108:111], v[20:23], v[72:75], v[108:111]
    v_mfma_f32_16x16x32_bf16 v[108:111], v[24:27], v[68:71], v[108:111]
    v_mfma_f32_16x16x32_bf16 v[108:111], v[28:31], v[64:67], v[108:111]
    v_mfma_f32_16x16x32_bf16 v[108:111], v[32:35], v[60:63], v[108:111]
    v_mfma_f32_16x16x32_bf16 v[108:111], v[36:39], v[56:59], v[108:111]
    v_mfma_f32_16x16x32_bf16 v[108:111], v[40:43], v[52:55], v[108:111]
    v_mfma_f32_16x16x32_bf16 v[108:111], v[44:47], v[48:51], v[108:111]
    s_barrier
    s_lshl_b32 s32, s10, 13
    v_add_u32 v12, s32, v7
    s_nop 7
    ds_write_b128 v12, v[80:83] offset:0
    ds_write_b128 v12, v[84:87] offset:1024
    ds_write_b128 v12, v[88:91] offset:2048
    ds_write_b128 v12, v[92:95] offset:3072
    ds_write_b128 v12, v[96:99] offset:4096
    ds_write_b128 v12, v[100:103] offset:5120
    ds_write_b128 v12, v[104:107] offset:6144
    ds_write_b128 v12, v[108:111] offset:7168
    s_waitcnt lgkmcnt(0)
    s_barrier
    s_lshl_b32 s32, s10, 10
    v_add_u32 v12, s32, v7
    ds_read_b128 v[16:19], v12 offset:0
    ds_read_b128 v[20:23], v12 offset:8192
    ds_read_b128 v[24:27], v12 offset:16384
    ds_read_b128 v[28:31], v12 offset:24576
    ds_read_b128 v[32:35], v12 offset:32768
    ds_read_b128 v[36:39], v12 offset:40960
    ds_read_b128 v[40:43], v12 offset:49152
    ds_read_b128 v[44:47], v12 offset:57344
    v_and_b32 v13, 15, v2
    v_lshrrev_b32 v14, 4, v2
    v_lshlrev_b32 v15, 5, v13
    v_lshlrev_b32 v5, 3, v14
    v_sub_u32 v15, v15, v5
    s_lshl_b32 s32, s10, 9
    s_add_u32 s32, s32, 66072
    v_add_u32 v15, s32, v15
    ds_read_b64 v[48:49], v15
    ds_read_b64 v[50:51], v15 offset:4608
    v_lshlrev_b32 v6, 6, v13
    v_lshl_add_u32 v6, v14, 4, v6
    s_mul_i32 s34, s3, 8448
    s_lshl_b32 s32, s10, 10
    s_add_u32 s34, s34, s32
    s_add_u32 s34, s34, 14680064
    s_lshl_b32 s35, s33, 16
    s_and_b32 s36, s33, 0xffff0000
    s_waitcnt lgkmcnt(0)
    v_add_f32 v16, v16, v20
    v_add_f32 v24, v24, v28
    v_add_f32 v16, v16, v24
    v_add_f32 v17, v17, v21
    v_add_f32 v25, v25, v29
    v_add_f32 v17, v17, v25
    v_add_f32 v18, v18, v22
    v_add_f32 v26, v26, v30
    v_add_f32 v18, v18, v26
    v_add_f32 v19, v19, v23
    v_add_f32 v27, v27, v31
    v_add_f32 v19, v19, v27
    v_and_b32 v52, 0xffff0000, v49
    v_lshlrev_b32 v53, 16, v49
    v_and_b32 v54, 0xffff0000, v48
    v_lshlrev_b32 v55, 16, v48
    v_fma_f32 v16, v52, s35, v16
    v_fma_f32 v17, v53, s35, v17
    v_fma_f32 v18, v54, s35, v18
    v_fma_f32 v19, v55, s35, v19
    v_add_f32 v32, v32, v36
    v_add_f32 v40, v40, v44
    v_add_f32 v32, v32, v40
    v_add_f32 v33, v33, v37
    v_add_f32 v41, v41, v45
    v_add_f32 v33, v33, v41
    v_add_f32 v34, v34, v38
    v_add_f32 v42, v42, v46
    v_add_f32 v34, v34, v42
    v_add_f32 v35, v35, v39
    v_add_f32 v43, v43, v47
    v_add_f32 v35, v35, v43
    v_and_b32 v52, 0xffff0000, v51
    v_lshlrev_b32 v53, 16, v51
    v_and_b32 v54, 0xffff0000, v50
    v_lshlrev_b32 v55, 16, v50
    v_fma_f32 v32, v52, s36, v32
    v_fma_f32 v33, v53, s36, v33
    v_fma_f32 v34, v54, s36, v34
    v_fma_f32 v35, v55, s36, v35
    v_cvt_pk_bf16_f32 v56, v16, v32
    v_cvt_pk_bf16_f32 v57, v17, v33
    v_cvt_pk_bf16_f32 v58, v18, v34
    v_cvt_pk_bf16_f32 v59, v19, v35
    buffer_store_dwordx4 v[56:59], v6, s[4:7], s34 offen
    s_endpgm
.section .rodata,"a"
.p2align 6
.amdhsa_kernel qkv1_conv_kernel
.amdhsa_next_free_vgpr 124
.amdhsa_next_free_sgpr 102
.amdhsa_accum_offset 124
.amdhsa_group_segment_fixed_size 0
.amdhsa_kernarg_size 96
.amdhsa_user_sgpr_count 2
.amdhsa_user_sgpr_kernarg_segment_ptr 1
.amdhsa_system_sgpr_workgroup_id_x 1
.amdhsa_float_denorm_mode_32 3
.end_amdhsa_kernel
.text
.text
.globl attn_proj2_kernel
.p2align 8
.type attn_proj2_kernel,@function
attn_proj2_kernel:
    s_mov_b32 s99, 1
    s_branch L_ap_body
.section .rodata,"a"
.p2align 6
.amdhsa_kernel attn_proj2_kernel
.amdhsa_next_free_vgpr 244
.amdhsa_next_free_sgpr 102
.amdhsa_accum_offset 244
.amdhsa_group_segment_fixed_size 0
.amdhsa_kernarg_size 96
.amdhsa_user_sgpr_count 2
.amdhsa_user_sgpr_kernarg_segment_ptr 1
.amdhsa_system_sgpr_workgroup_id_x 1
.amdhsa_float_denorm_mode_32 3
.end_amdhsa_kernel
.text
.text
.globl attn_proj1_qkv2_kernel
.p2align 8
.type attn_proj1_qkv2_kernel,@function
attn_proj1_qkv2_kernel:
    s_mov_b32 s99, 0
L_ap_body:
    s_cmp_ge_u32 s2, 256
    s_cbranch_scc1 L_ap_quit
    s_load_dwordx2 s[12:13], s[0:1], 88
    s_lshr_b32 s8, s2, 6
    s_lshl_b32 s8, s8, 3
    s_and_b32 s9, s2, 7
    s_or_b32 s8, s8, s9
    s_lshr_b32 s9, s2, 3
    s_and_b32 s9, s9, 7
    v_lshrrev_b32 v1, 6, v0
    v_and_b32 v2, 63, v0
    v_readfirstlane_b32 s10, v1
    v_lshlrev_b32 v3, 4, v2
    s_mul_i32 s14, s8, 151552
    s_and_b32 s23, s10, 3
    s_lshr_b32 s28, s10, 2
    s_lshl_b32 s11, s9, 3
    s_lshl_b32 s15, s23, 1
    s_add_u32 s11, s11, s15
    s_cmp_eq_u32 s28, 1
    s_cselect_b64 s[32:33], -1, 0
    s_lshl_b32 s15, s23, 10
    s_lshl_b32 s16, s8, 16
    s_lshl_b32 s17, s11, 10
    s_add_u32 s16, s16, s17
    s_add_u32 s16, s16, 5242880
    s_lshl_b32 s29, s28, 10
    s_add_u32 s30, s16, s29
    s_xor_b32 s29, s29, 1024
    s_add_u32 s31, s16, s29
    s_lshl_b32 s17, s8, 13
    s_lshl_b32 s19, s11, 7
    s_add_u32 s17, s17, s19
    s_add_u32 s17, s17, 7340032
    v_lshlrev_b32 v112, 3, v2
    v_mov_b32 v118, 0
    v_mov_b32 v119, 0
    s_waitcnt lgkmcnt(0)
    s_mov_b32 s4, s12
    s_and_b32 s5, s13, 0xffff
    s_mov_b32 s6, 0x10000000
    s_mov_b32 s7, 0x00020000
    s_getreg_b32 s97, hwreg(HW_REG_XCC_ID, 0, 4)
    s_add_u32 s97, s97, 1
    s_lshl_b32 s39, s2, 6
    s_add_u32 s39, s39, 23166976
    s_lshl_b32 s40, s99, 14
    s_add_u32 s39, s39, s40
    v_mov_b32 v114, s97
    s_cmp_eq_u32 s10, 0
    s_cselect_b32 s40, 0, 0x80000000
    v_mov_b32 v115, s40
    s_mov_b64 exec, 1
    buffer_store_dword v114, v115, s[4:7], s39 offen sc0 sc1
    s_mov_b64 exec, -1
    buffer_load_dwordx4 v[4:7], v3, s[4:7], s30 offen
    buffer_load_dwordx4 v[8:11], v3, s[4:7], s31 offen
    s_mov_b32 exec_hi, 0
    buffer_load_dwordx2 v[118:119], v112, s[4:7], s17 offen
    s_mov_b32 exec_hi, -1
    s_lshl_b32 s34, s28, 15
    s_add_u32 s34, s34, s15
    s_lshl_b32 s35, s28, 12
    s_add_u32 s35, s35, s15
    s_add_u32 s35, s35, 65536
    s_mul_i32 s36, s28, 38912
    s_add_u32 s36, s36, s15
    s_add_u32 s36, s36, 73728
    s_add_u32 s14, s14, 0
    s_add_u32 m0, s34, 0
    s_add_u32 s19, m0, s14
    buffer_load_dwordx4 v3, s[4:7], s19 offen lds
    s_add_u32 m0, s35, 0
    s_add_u32 s19, m0, s14
    buffer_load_dwordx4 v3, s[4:7], s19 offen lds
    s_add_u32 m0, s36, 0
    s_add_u32 s19, m0, s14
    buffer_load_dwordx4 v3, s[4:7], s19 offen lds
    s_lshl_b32 s19, s28, 15
    v_add_u32 v108, s19, v3
    v_and_b32 v113, 31, v2
    s_lshl_b32 s19, s28, 12
    s_add_u32 s19, s19, 65536
    v_lshlrev_b32 v109, 4, v113
    v_add_u32 v109, s19, v109
    v_subrev_u32 v114, 20, v113
    v_cmp_gt_u32 vcc, 20, v113
    v_lshrrev_b32 v115, 5, v2
    s_mul_i32 s19, s28, 38912
    v_cndmask_b32 v114, v114, v113, vcc
    v_cmp_eq_u32 vcc, 19, v113
    v_mul_u32_u24 v115, 304, v115
    v_mov_b32 v112, 16
    v_cndmask_b32 v114, v114, v112, vcc
    s_add_u32 s19, s19, 73728
    v_lshl_add_u32 v110, v114, 4, v115
    v_add_u32 v110, s19, v110
    v_cmp_lt_u32 vcc, 18, v113
    v_add_u32 v112, 0x40000, v110
    s_nop 1
    v_cndmask_b32 v110, v110, v112, vcc
    v_mov_b32 v13, 0
    v_mov_b32 v14, 0
    v_mov_b32 v44, 0
    v_mov_b32 v45, 0
    v_mov_b32 v46, 0
    v_mov_b32 v47, 0
    v_mov_b32 v48, 0
    v_mov_b32 v49, 0
    v_mov_b32 v50, 0
    v_mov_b32 v51, 0
    v_mov_b32 v52, 0
    v_mov_b32 v53, 0
    v_mov_b32 v54, 0
    v_mov_b32 v55, 0
    v_mov_b32 v56, 0
    v_mov_b32 v57, 0
    v_mov_b32 v58, 0
    v_mov_b32 v59, 0
    v_mov_b32 v17, 0
    v_mov_b32 v18, 0
    v_mov_b32 v60, 0
    v_mov_b32 v61, 0
    v_mov_b32 v62, 0
    v_mov_b32 v63, 0
    v_mov_b32 v64, 0
    v_mov_b32 v65, 0
    v_mov_b32 v66, 0
    v_mov_b32 v67, 0
    v_mov_b32 v68, 0
    v_mov_b32 v69, 0
    v_mov_b32 v70, 0
    v_mov_b32 v71, 0
    v_mov_b32 v72, 0
    v_mov_b32 v73, 0
    v_mov_b32 v74, 0
    v_mov_b32 v75, 0
    v_mov_b32 v128, 0
    v_mov_b32 v129, 0
    v_mov_b32 v130, 0
    v_mov_b32 v131, 0
    v_mov_b32 v40, 0
    v_mov_b32 v41, 0
    v_mov_b32 v42, 0
    v_mov_b32 v43, 0
    v_mov_b32 v104, 0
    v_mov_b32 v105, 0
    v_mov_b32 v106, 0
    v_mov_b32 v107, 0
    s_waitcnt vmcnt(0)
    s_barrier
    v_cndmask_b32 v12, v118, v119, s[32:33]
    v_cndmask_b32 v16, v119, v118, s[32:33]
    v_cndmask_b32 v15, v118, v119, s[32:33]
    v_cndmask_b32 v19, v119, v118, s[32:33]
    v_lshrrev_b32 v117, 5, v2
    v_and_b32 v118, 31, v2
    v_lshlrev_b32 v118, 4, v118
    v_mul_u32_u24 v117, 33024, v117
    v_add_u32 v117, v117, v118
    s_add_u32 s54, s11, s28
    s_mul_i32 s52, s8, 66048
    s_lshl_b32 s55, s54, 9
    s_add_u32 s52, s52, s55
    s_add_u32 s52, s52, 8388608
    s_lshr_b32 s53, s8, 2
    s_mul_i32 s53, s53, 33024
    s_add_u32 s53, s53, s55
    s_and_b32 s55, s8, 3
    s_lshl_b32 s55, s55, 2
    s_add_u32 s53, s53, s55
    s_add_u32 s53, s53, 10502144
    s_lshr_b32 s50, s54, 1
    s_mul_i32 s50, s50, 6144
    s_and_b32 s51, s54, 1
    s_lshl_b32 s51, s51, 5
    s_add_u32 s51, s51, s8
    s_mul_i32 s51, s51, 16
    s_add_u32 s50, s50, s51
    s_add_u32 s50, s50, 22773760
    s_mul_i32 s51, s99, 196608
    s_add_u32 s50, s50, s51
    ds_read_b128 v[20:23], v108 offset:0
    ds_read_b128 v[24:27], v109 offset:0
    ds_read_b128 v[28:31], v110 offset:0
    ds_read_b128 v[120:123], v108 offset:1024
    ds_read_b128 v[32:35], v110 offset:608
    s_add_u32 m0, s34, 4096
    s_add_u32 s19, m0, s14
    buffer_load_dwordx4 v3, s[4:7], s19 offen lds
    s_add_u32 m0, s36, 4096
    s_add_u32 s19, m0, s14
    buffer_load_dwordx4 v3, s[4:7], s19 offen lds
    s_add_u32 m0, s36, 8192
    s_add_u32 s19, m0, s14
    buffer_load_dwordx4 v3, s[4:7], s19 offen lds
    s_add_u32 m0, s34, 8192
    s_add_u32 s19, m0, s14
    buffer_load_dwordx4 v3, s[4:7], s19 offen lds
    s_waitcnt lgkmcnt(3)
    v_mfma_f32_32x32x16_bf16 v[76:91], v[20:23], v[4:7], 0
    v_mfma_f32_32x32x8bf16_1k v[76:91], v[24:25], v[12:13], v[76:91]
    s_waitcnt lgkmcnt(0)
    s_nop 11
    v_exp_f32 v76, v76
    v_exp_f32 v77, v77
    v_exp_f32 v78, v78
    v_exp_f32 v79, v79
    v_cvt_pk_bf16_f32 v42, v104, v105
    v_cvt_pk_bf16_f32 v43, v106, v107
    v_mfma_f32_32x32x16_bf16 v[92:107], v[20:23], v[8:11], 0
    ds_read_b128 v[124:127], v110 offset:1216
    v_exp_f32 v80, v80
    v_exp_f32 v81, v81
    v_exp_f32 v82, v82
    v_exp_f32 v83, v83
    v_cvt_pk_bf16_f32 v36, v76, v77
    v_cvt_pk_bf16_f32 v37, v78, v79
    v_mfma_f32_32x32x8bf16_1k v[92:107], v[24:25], v[16:17], v[92:107]
    v_exp_f32 v84, v84
    v_exp_f32 v85, v85
    v_exp_f32 v86, v86
    v_exp_f32 v87, v87
    v_cvt_pk_bf16_f32 v38, v80, v81
    v_cvt_pk_bf16_f32 v39, v82, v83
    v_mfma_f32_32x32x16_bf16 v[60:75], v[128:131], v[40:43], v[60:75]
    v_exp_f32 v88, v88
    v_exp_f32 v89, v89
    v_exp_f32 v90, v90
    v_exp_f32 v91, v91
    v_cvt_pk_bf16_f32 v40, v84, v85
    v_cvt_pk_bf16_f32 v41, v86, v87
    v_mfma_f32_32x32x16_bf16 v[44:59], v[28:31], v[36:39], v[44:59]
    s_add_u32 m0, s36, 12288
    s_add_u32 s19, m0, s14
    buffer_load_dwordx4 v3, s[4:7], s19 offen lds
    v_exp_f32 v92, v92
    v_exp_f32 v93, v93
    v_exp_f32 v94, v94
    v_exp_f32 v95, v95
    v_cvt_pk_bf16_f32 v42, v88, v89
    v_cvt_pk_bf16_f32 v43, v90, v91
    v_mfma_f32_32x32x16_bf16 v[76:91], v[120:123], v[4:7], 0
    ds_read_b128 v[20:23], v108 offset:2048
    v_exp_f32 v96, v96
    v_exp_f32 v97, v97
    v_exp_f32 v98, v98
    v_exp_f32 v99, v99
    v_cvt_pk_bf16_f32 v36, v92, v93
    v_cvt_pk_bf16_f32 v37, v94, v95
    v_mfma_f32_32x32x8bf16_1k v[76:91], v[24:25], v[14:15], v[76:91]
    v_exp_f32 v100, v100
    v_exp_f32 v101, v101
    v_exp_f32 v102, v102
    v_exp_f32 v103, v103
    v_cvt_pk_bf16_f32 v38, v96, v97
    v_cvt_pk_bf16_f32 v39, v98, v99
    v_mfma_f32_32x32x16_bf16 v[44:59], v[32:35], v[40:43], v[44:59]
    ds_read_b128 v[128:131], v110 offset:1824
    v_exp_f32 v104, v104
    v_exp_f32 v105, v105
    v_exp_f32 v106, v106
    v_exp_f32 v107, v107
    v_cvt_pk_bf16_f32 v40, v100, v101
    v_cvt_pk_bf16_f32 v41, v102, v103
    v_mfma_f32_32x32x16_bf16 v[60:75], v[28:31], v[36:39], v[60:75]
    s_waitcnt lgkmcnt(2)
    v_exp_f32 v76, v76
    v_exp_f32 v77, v77
    v_exp_f32 v78, v78
    v_exp_f32 v79, v79
    v_cvt_pk_bf16_f32 v42, v104, v105
    v_cvt_pk_bf16_f32 v43, v106, v107
    v_mfma_f32_32x32x16_bf16 v[92:107], v[120:123], v[8:11], 0
    ds_read_b128 v[28:31], v110 offset:2432
    v_exp_f32 v80, v80
    v_exp_f32 v81, v81
    v_exp_f32 v82, v82
    v_exp_f32 v83, v83
    v_cvt_pk_bf16_f32 v36, v76, v77
    v_cvt_pk_bf16_f32 v37, v78, v79
    v_mfma_f32_32x32x8bf16_1k v[92:107], v[24:25], v[18:19], v[92:107]
    v_exp_f32 v84, v84
    v_exp_f32 v85, v85
    v_exp_f32 v86, v86
    v_exp_f32 v87, v87
    v_cvt_pk_bf16_f32 v38, v80, v81
    v_cvt_pk_bf16_f32 v39, v82, v83
    v_mfma_f32_32x32x16_bf16 v[60:75], v[32:35], v[40:43], v[60:75]
    ds_read_b128 v[132:135], v109 offset:512
    v_exp_f32 v88, v88
    v_exp_f32 v89, v89
    v_exp_f32 v90, v90
    v_exp_f32 v91, v91
    v_cvt_pk_bf16_f32 v40, v84, v85
    v_cvt_pk_bf16_f32 v41, v86, v87
    v_mfma_f32_32x32x16_bf16 v[44:59], v[124:127], v[36:39], v[44:59]
    s_waitcnt lgkmcnt(2)
    s_add_u32 m0, s34, 12288
    s_add_u32 s19, m0, s14
    buffer_load_dwordx4 v3, s[4:7], s19 offen lds
    v_exp_f32 v92, v92
    v_exp_f32 v93, v93
    v_exp_f32 v94, v94
    v_exp_f32 v95, v95
    v_cvt_pk_bf16_f32 v42, v88, v89
    v_cvt_pk_bf16_f32 v43, v90, v91
    v_mfma_f32_32x32x16_bf16 v[76:91], v[20:23], v[4:7], 0
    ds_read_b128 v[120:123], v108 offset:3072
    v_exp_f32 v96, v96
    v_exp_f32 v97, v97
    v_exp_f32 v98, v98
    v_exp_f32 v99, v99
    v_cvt_pk_bf16_f32 v36, v92, v93
    v_cvt_pk_bf16_f32 v37, v94, v95
    v_mfma_f32_32x32x8bf16_1k v[76:91], v[26:27], v[12:13], v[76:91]
    v_exp_f32 v100, v100
    v_exp_f32 v101, v101
    v_exp_f32 v102, v102
    v_exp_f32 v103, v103
    v_cvt_pk_bf16_f32 v38, v96, v97
    v_cvt_pk_bf16_f32 v39, v98, v99
    v_mfma_f32_32x32x16_bf16 v[44:59], v[128:131], v[40:43], v[44:59]
    ds_read_b128 v[32:35], v110 offset:3040
    v_exp_f32 v104, v104
    v_exp_f32 v105, v105
    v_exp_f32 v106, v106
    v_exp_f32 v107, v107
    v_cvt_pk_bf16_f32 v40, v100, v101
    v_cvt_pk_bf16_f32 v41, v102, v103
    v_mfma_f32_32x32x16_bf16 v[60:75], v[124:127], v[36:39], v[60:75]
    s_waitcnt lgkmcnt(2)
    s_waitcnt vmcnt(4)
    s_barrier
    v_exp_f32 v76, v76
    v_exp_f32 v77, v77
    v_exp_f32 v78, v78
    v_exp_f32 v79, v79
    v_cvt_pk_bf16_f32 v42, v104, v105
    v_cvt_pk_bf16_f32 v43, v106, v107
    v_mfma_f32_32x32x16_bf16 v[92:107], v[20:23], v[8:11], 0
    ds_read_b128 v[124:127], v110 offset:3648
    v_exp_f32 v80, v80
    v_exp_f32 v81, v81
    v_exp_f32 v82, v82
    v_exp_f32 v83, v83
    v_cvt_pk_bf16_f32 v36, v76, v77
    v_cvt_pk_bf16_f32 v37, v78, v79
    v_mfma_f32_32x32x8bf16_1k v[92:107], v[26:27], v[16:17], v[92:107]
    v_exp_f32 v84, v84
    v_exp_f32 v85, v85
    v_exp_f32 v86, v86
    v_exp_f32 v87, v87
    v_cvt_pk_bf16_f32 v38, v80, v81
    v_cvt_pk_bf16_f32 v39, v82, v83
    v_mfma_f32_32x32x16_bf16 v[60:75], v[128:131], v[40:43], v[60:75]
    v_exp_f32 v88, v88
    v_exp_f32 v89, v89
    v_exp_f32 v90, v90
    v_exp_f32 v91, v91
    v_cvt_pk_bf16_f32 v40, v84, v85
    v_cvt_pk_bf16_f32 v41, v86, v87
    v_mfma_f32_32x32x16_bf16 v[44:59], v[28:31], v[36:39], v[44:59]
    s_waitcnt lgkmcnt(1)
    s_add_u32 m0, s36, 16384
    s_add_u32 s19, m0, s14
    buffer_load_dwordx4 v3, s[4:7], s19 offen lds
    v_exp_f32 v92, v92
    v_exp_f32 v93, v93
    v_exp_f32 v94, v94
    v_exp_f32 v95, v95
    v_cvt_pk_bf16_f32 v42, v88, v89
    v_cvt_pk_bf16_f32 v43, v90, v91
    v_mfma_f32_32x32x16_bf16 v[76:91], v[120:123], v[4:7], 0
    ds_read_b128 v[20:23], v108 offset:4096
    v_exp_f32 v96, v96
    v_exp_f32 v97, v97
    v_exp_f32 v98, v98
    v_exp_f32 v99, v99
    v_cvt_pk_bf16_f32 v36, v92, v93
    v_cvt_pk_bf16_f32 v37, v94, v95
    v_mfma_f32_32x32x8bf16_1k v[76:91], v[26:27], v[14:15], v[76:91]
    v_exp_f32 v100, v100
    v_exp_f32 v101, v101
    v_exp_f32 v102, v102
    v_exp_f32 v103, v103
    v_cvt_pk_bf16_f32 v38, v96, v97
    v_cvt_pk_bf16_f32 v39, v98, v99
    v_mfma_f32_32x32x16_bf16 v[44:59], v[32:35], v[40:43], v[44:59]
    ds_read_b128 v[128:131], v110 offset:4256
    v_exp_f32 v104, v104
    v_exp_f32 v105, v105
    v_exp_f32 v106, v106
    v_exp_f32 v107, v107
    v_cvt_pk_bf16_f32 v40, v100, v101
    v_cvt_pk_bf16_f32 v41, v102, v103
    v_mfma_f32_32x32x16_bf16 v[60:75], v[28:31], v[36:39], v[60:75]
    s_waitcnt lgkmcnt(2)
    v_exp_f32 v76, v76
    v_exp_f32 v77, v77
    v_exp_f32 v78, v78
    v_exp_f32 v79, v79
    v_cvt_pk_bf16_f32 v42, v104, v105
    v_cvt_pk_bf16_f32 v43, v106, v107
    v_mfma_f32_32x32x16_bf16 v[92:107], v[120:123], v[8:11], 0
    ds_read_b128 v[28:31], v110 offset:4864
    v_exp_f32 v80, v80
    v_exp_f32 v81, v81
    v_exp_f32 v82, v82
    v_exp_f32 v83, v83
    v_cvt_pk_bf16_f32 v36, v76, v77
    v_cvt_pk_bf16_f32 v37, v78, v79
    v_mfma_f32_32x32x8bf16_1k v[92:107], v[26:27], v[18:19], v[92:107]
    v_exp_f32 v84, v84
    v_exp_f32 v85, v85
    v_exp_f32 v86, v86
    v_exp_f32 v87, v87
    v_cvt_pk_bf16_f32 v38, v80, v81
    v_cvt_pk_bf16_f32 v39, v82, v83
    v_mfma_f32_32x32x16_bf16 v[60:75], v[32:35], v[40:43], v[60:75]
    v_exp_f32 v88, v88
    v_exp_f32 v89, v89
    v_exp_f32 v90, v90
    v_exp_f32 v91, v91
    v_cvt_pk_bf16_f32 v40, v84, v85
    v_cvt_pk_bf16_f32 v41, v86, v87
    v_mfma_f32_32x32x16_bf16 v[44:59], v[124:127], v[36:39], v[44:59]
    s_waitcnt lgkmcnt(1)
    s_add_u32 m0, s34, 16384
    s_add_u32 s19, m0, s14
    buffer_load_dwordx4 v3, s[4:7], s19 offen lds
    v_exp_f32 v92, v92
    v_exp_f32 v93, v93
    v_exp_f32 v94, v94
    v_exp_f32 v95, v95
    v_cvt_pk_bf16_f32 v42, v88, v89
    v_cvt_pk_bf16_f32 v43, v90, v91
    v_mfma_f32_32x32x16_bf16 v[76:91], v[20:23], v[4:7], 0
    ds_read_b128 v[120:123], v108 offset:5120
    v_exp_f32 v96, v96
    v_exp_f32 v97, v97
    v_exp_f32 v98, v98
    v_exp_f32 v99, v99
    v_cvt_pk_bf16_f32 v36, v92, v93
    v_cvt_pk_bf16_f32 v37, v94, v95
    v_mfma_f32_32x32x8bf16_1k v[76:91], v[132:133], v[12:13], v[76:91]
    v_exp_f32 v100, v100
    v_exp_f32 v101, v101
    v_exp_f32 v102, v102
    v_exp_f32 v103, v103
    v_cvt_pk_bf16_f32 v38, v96, v97
    v_cvt_pk_bf16_f32 v39, v98, v99
    v_mfma_f32_32x32x16_bf16 v[44:59], v[128:131], v[40:43], v[44:59]
    ds_read_b128 v[32:35], v110 offset:5472
    v_exp_f32 v104, v104
    v_exp_f32 v105, v105
    v_exp_f32 v106, v106
    v_exp_f32 v107, v107
    v_cvt_pk_bf16_f32 v40, v100, v101
    v_cvt_pk_bf16_f32 v41, v102, v103
    v_mfma_f32_32x32x16_bf16 v[60:75], v[124:127], v[36:39], v[60:75]
    s_waitcnt lgkmcnt(2)
    v_exp_f32 v76, v76
    v_exp_f32 v77, v77
    v_exp_f32 v78, v78
    v_exp_f32 v79, v79
    v_cvt_pk_bf16_f32 v42, v104, v105
    v_cvt_pk_bf16_f32 v43, v106, v107
    v_mfma_f32_32x32x16_bf16 v[92:107], v[20:23], v[8:11], 0
    ds_read_b128 v[124:127], v110 offset:6080
    v_exp_f32 v80, v80
    v_exp_f32 v81, v81
    v_exp_f32 v82, v82
    v_exp_f32 v83, v83
    v_cvt_pk_bf16_f32 v36, v76, v77
    v_cvt_pk_bf16_f32 v37, v78, v79
    v_mfma_f32_32x32x8bf16_1k v[92:107], v[132:133], v[16:17], v[92:107]
    v_exp_f32 v84, v84
    v_exp_f32 v85, v85
    v_exp_f32 v86, v86
    v_exp_f32 v87, v87
    v_cvt_pk_bf16_f32 v38, v80, v81
    v_cvt_pk_bf16_f32 v39, v82, v83
    v_mfma_f32_32x32x16_bf16 v[60:75], v[128:131], v[40:43], v[60:75]
    v_exp_f32 v88, v88
    v_exp_f32 v89, v89
    v_exp_f32 v90, v90
    v_exp_f32 v91, v91
    v_cvt_pk_bf16_f32 v40, v84, v85
    v_cvt_pk_bf16_f32 v41, v86, v87
    v_mfma_f32_32x32x16_bf16 v[44:59], v[28:31], v[36:39], v[44:59]
    s_waitcnt lgkmcnt(1)
    s_add_u32 m0, s36, 20480
    s_add_u32 s19, m0, s14
    buffer_load_dwordx4 v3, s[4:7], s19 offen lds
    v_exp_f32 v92, v92
    v_exp_f32 v93, v93
    v_exp_f32 v94, v94
    v_exp_f32 v95, v95
    v_cvt_pk_bf16_f32 v42, v88, v89
    v_cvt_pk_bf16_f32 v43, v90, v91
    v_mfma_f32_32x32x16_bf16 v[76:91], v[120:123], v[4:7], 0
    ds_read_b128 v[20:23], v108 offset:6144
    v_exp_f32 v96, v96
    v_exp_f32 v97, v97
    v_exp_f32 v98, v98
    v_exp_f32 v99, v99
    v_cvt_pk_bf16_f32 v36, v92, v93
    v_cvt_pk_bf16_f32 v37, v94, v95
    v_mfma_f32_32x32x8bf16_1k v[76:91], v[132:133], v[14:15], v[76:91]
    v_exp_f32 v100, v100
    v_exp_f32 v101, v101
    v_exp_f32 v102, v102
    v_exp_f32 v103, v103
    v_cvt_pk_bf16_f32 v38, v96, v97
    v_cvt_pk_bf16_f32 v39, v98, v99
    v_mfma_f32_32x32x16_bf16 v[44:59], v[32:35], v[40:43], v[44:59]
    ds_read_b128 v[128:131], v110 offset:6688
    v_exp_f32 v104, v104
    v_exp_f32 v105, v105
    v_exp_f32 v106, v106
    v_exp_f32 v107, v107
    v_cvt_pk_bf16_f32 v40, v100, v101
    v_cvt_pk_bf16_f32 v41, v102, v103
    v_mfma_f32_32x32x16_bf16 v[60:75], v[28:31], v[36:39], v[60:75]
    s_waitcnt lgkmcnt(2)
    s_waitcnt vmcnt(5)
    s_barrier
    v_exp_f32 v76, v76
    v_exp_f32 v77, v77
    v_exp_f32 v78, v78
    v_exp_f32 v79, v79
    v_cvt_pk_bf16_f32 v42, v104, v105
    v_cvt_pk_bf16_f32 v43, v106, v107
    v_mfma_f32_32x32x16_bf16 v[92:107], v[120:123], v[8:11], 0
    ds_read_b128 v[28:31], v110 offset:7296
    v_exp_f32 v80, v80
    v_exp_f32 v81, v81
    v_exp_f32 v82, v82
    v_exp_f32 v83, v83
    v_cvt_pk_bf16_f32 v36, v76, v77
    v_cvt_pk_bf16_f32 v37, v78, v79
    v_mfma_f32_32x32x8bf16_1k v[92:107], v[132:133], v[18:19], v[92:107]
    v_exp_f32 v84, v84
    v_exp_f32 v85, v85
    v_exp_f32 v86, v86
    v_exp_f32 v87, v87
    v_cvt_pk_bf16_f32 v38, v80, v81
    v_cvt_pk_bf16_f32 v39, v82, v83
    v_mfma_f32_32x32x16_bf16 v[60:75], v[32:35], v[40:43], v[60:75]
    ds_read_b128 v[24:27], v109 offset:1024
    v_exp_f32 v88, v88
    v_exp_f32 v89, v89
    v_exp_f32 v90, v90
    v_exp_f32 v91, v91
    v_cvt_pk_bf16_f32 v40, v84, v85
    v_cvt_pk_bf16_f32 v41, v86, v87
    v_mfma_f32_32x32x16_bf16 v[44:59], v[124:127], v[36:39], v[44:59]
    s_waitcnt lgkmcnt(2)
    s_add_u32 m0, s34, 20480
    s_add_u32 s19, m0, s14
    buffer_load_dwordx4 v3, s[4:7], s19 offen lds
    v_exp_f32 v92, v92
    v_exp_f32 v93, v93
    v_exp_f32 v94, v94
    v_exp_f32 v95, v95
    v_cvt_pk_bf16_f32 v42, v88, v89
    v_cvt_pk_bf16_f32 v43, v90, v91
    v_mfma_f32_32x32x16_bf16 v[76:91], v[20:23], v[4:7], 0
    ds_read_b128 v[120:123], v108 offset:7168
    v_exp_f32 v96, v96
    v_exp_f32 v97, v97
    v_exp_f32 v98, v98
    v_exp_f32 v99, v99
    v_cvt_pk_bf16_f32 v36, v92, v93
    v_cvt_pk_bf16_f32 v37, v94, v95
    v_mfma_f32_32x32x8bf16_1k v[76:91], v[134:135], v[12:13], v[76:91]
    v_exp_f32 v100, v100
    v_exp_f32 v101, v101
    v_exp_f32 v102, v102
    v_exp_f32 v103, v103
    v_cvt_pk_bf16_f32 v38, v96, v97
    v_cvt_pk_bf16_f32 v39, v98, v99
    v_mfma_f32_32x32x16_bf16 v[44:59], v[128:131], v[40:43], v[44:59]
    ds_read_b128 v[32:35], v110 offset:7904
    v_exp_f32 v104, v104
    v_exp_f32 v105, v105
    v_exp_f32 v106, v106
    v_exp_f32 v107, v107
    v_cvt_pk_bf16_f32 v40, v100, v101
    v_cvt_pk_bf16_f32 v41, v102, v103
    v_mfma_f32_32x32x16_bf16 v[60:75], v[124:127], v[36:39], v[60:75]
    s_waitcnt lgkmcnt(2)
    v_exp_f32 v76, v76
    v_exp_f32 v77, v77
    v_exp_f32 v78, v78
    v_exp_f32 v79, v79
    v_cvt_pk_bf16_f32 v42, v104, v105
    v_cvt_pk_bf16_f32 v43, v106, v107
    v_mfma_f32_32x32x16_bf16 v[92:107], v[20:23], v[8:11], 0
    ds_read_b128 v[124:127], v110 offset:8512
    v_exp_f32 v80, v80
    v_exp_f32 v81, v81
    v_exp_f32 v82, v82
    v_exp_f32 v83, v83
    v_cvt_pk_bf16_f32 v36, v76, v77
    v_cvt_pk_bf16_f32 v37, v78, v79
    v_mfma_f32_32x32x8bf16_1k v[92:107], v[134:135], v[16:17], v[92:107]
    v_exp_f32 v84, v84
    v_exp_f32 v85, v85
    v_exp_f32 v86, v86
    v_exp_f32 v87, v87
    v_cvt_pk_bf16_f32 v38, v80, v81
    v_cvt_pk_bf16_f32 v39, v82, v83
    v_mfma_f32_32x32x16_bf16 v[60:75], v[128:131], v[40:43], v[60:75]
    v_exp_f32 v88, v88
    v_exp_f32 v89, v89
    v_exp_f32 v90, v90
    v_exp_f32 v91, v91
    v_cvt_pk_bf16_f32 v40, v84, v85
    v_cvt_pk_bf16_f32 v41, v86, v87
    v_mfma_f32_32x32x16_bf16 v[44:59], v[28:31], v[36:39], v[44:59]
    s_waitcnt lgkmcnt(1)
    s_add_u32 m0, s36, 24576
    s_add_u32 s19, m0, s14
    buffer_load_dwordx4 v3, s[4:7], s19 offen lds
    v_exp_f32 v92, v92
    v_exp_f32 v93, v93
    v_exp_f32 v94, v94
    v_exp_f32 v95, v95
    v_cvt_pk_bf16_f32 v42, v88, v89
    v_cvt_pk_bf16_f32 v43, v90, v91
    v_mfma_f32_32x32x16_bf16 v[76:91], v[120:123], v[4:7], 0
    ds_read_b128 v[20:23], v108 offset:8192
    v_exp_f32 v96, v96
    v_exp_f32 v97, v97
    v_exp_f32 v98, v98
    v_exp_f32 v99, v99
    v_cvt_pk_bf16_f32 v36, v92, v93
    v_cvt_pk_bf16_f32 v37, v94, v95
    v_mfma_f32_32x32x8bf16_1k v[76:91], v[134:135], v[14:15], v[76:91]
    v_exp_f32 v100, v100
    v_exp_f32 v101, v101
    v_exp_f32 v102, v102
    v_exp_f32 v103, v103
    v_cvt_pk_bf16_f32 v38, v96, v97
    v_cvt_pk_bf16_f32 v39, v98, v99
    v_mfma_f32_32x32x16_bf16 v[44:59], v[32:35], v[40:43], v[44:59]
    ds_read_b128 v[128:131], v110 offset:9120
    v_exp_f32 v104, v104
    v_exp_f32 v105, v105
    v_exp_f32 v106, v106
    v_exp_f32 v107, v107
    v_cvt_pk_bf16_f32 v40, v100, v101
    v_cvt_pk_bf16_f32 v41, v102, v103
    v_mfma_f32_32x32x16_bf16 v[60:75], v[28:31], v[36:39], v[60:75]
    s_waitcnt lgkmcnt(2)
    v_exp_f32 v76, v76
    v_exp_f32 v77, v77
    v_exp_f32 v78, v78
    v_exp_f32 v79, v79
    v_cvt_pk_bf16_f32 v42, v104, v105
    v_cvt_pk_bf16_f32 v43, v106, v107
    v_mfma_f32_32x32x16_bf16 v[92:107], v[120:123], v[8:11], 0
    ds_read_b128 v[28:31], v110 offset:9728
    v_exp_f32 v80, v80
    v_exp_f32 v81, v81
    v_exp_f32 v82, v82
    v_exp_f32 v83, v83
    v_cvt_pk_bf16_f32 v36, v76, v77
    v_cvt_pk_bf16_f32 v37, v78, v79
    v_mfma_f32_32x32x8bf16_1k v[92:107], v[134:135], v[18:19], v[92:107]
    v_exp_f32 v84, v84
    v_exp_f32 v85, v85
    v_exp_f32 v86, v86
    v_exp_f32 v87, v87
    v_cvt_pk_bf16_f32 v38, v80, v81
    v_cvt_pk_bf16_f32 v39, v82, v83
    v_mfma_f32_32x32x16_bf16 v[60:75], v[32:35], v[40:43], v[60:75]
    v_exp_f32 v88, v88
    v_exp_f32 v89, v89
    v_exp_f32 v90, v90
    v_exp_f32 v91, v91
    v_cvt_pk_bf16_f32 v40, v84, v85
    v_cvt_pk_bf16_f32 v41, v86, v87
    v_mfma_f32_32x32x16_bf16 v[44:59], v[124:127], v[36:39], v[44:59]
    s_waitcnt lgkmcnt(1)
    s_add_u32 m0, s34, 24576
    s_add_u32 s19, m0, s14
    buffer_load_dwordx4 v3, s[4:7], s19 offen lds
    v_exp_f32 v92, v92
    v_exp_f32 v93, v93
    v_exp_f32 v94, v94
    v_exp_f32 v95, v95
    v_cvt_pk_bf16_f32 v42, v88, v89
    v_cvt_pk_bf16_f32 v43, v90, v91
    v_mfma_f32_32x32x16_bf16 v[76:91], v[20:23], v[4:7], 0
    ds_read_b128 v[120:123], v108 offset:9216
    v_exp_f32 v96, v96
    v_exp_f32 v97, v97
    v_exp_f32 v98, v98
    v_exp_f32 v99, v99
    v_cvt_pk_bf16_f32 v36, v92, v93
    v_cvt_pk_bf16_f32 v37, v94, v95
    v_mfma_f32_32x32x8bf16_1k v[76:91], v[24:25], v[12:13], v[76:91]
    v_exp_f32 v100, v100
    v_exp_f32 v101, v101
    v_exp_f32 v102, v102
    v_exp_f32 v103, v103
    v_cvt_pk_bf16_f32 v38, v96, v97
    v_cvt_pk_bf16_f32 v39, v98, v99
    v_mfma_f32_32x32x16_bf16 v[44:59], v[128:131], v[40:43], v[44:59]
    ds_read_b128 v[32:35], v110 offset:10336
    v_exp_f32 v104, v104
    v_exp_f32 v105, v105
    v_exp_f32 v106, v106
    v_exp_f32 v107, v107
    v_cvt_pk_bf16_f32 v40, v100, v101
    v_cvt_pk_bf16_f32 v41, v102, v103
    v_mfma_f32_32x32x16_bf16 v[60:75], v[124:127], v[36:39], v[60:75]
    s_waitcnt lgkmcnt(2)
    v_exp_f32 v76, v76
    v_exp_f32 v77, v77
    v_exp_f32 v78, v78
    v_exp_f32 v79, v79
    v_cvt_pk_bf16_f32 v42, v104, v105
    v_cvt_pk_bf16_f32 v43, v106, v107
    v_mfma_f32_32x32x16_bf16 v[92:107], v[20:23], v[8:11], 0
    ds_read_b128 v[124:127], v110 offset:10944
    v_exp_f32 v80, v80
    v_exp_f32 v81, v81
    v_exp_f32 v82, v82
    v_exp_f32 v83, v83
    v_cvt_pk_bf16_f32 v36, v76, v77
    v_cvt_pk_bf16_f32 v37, v78, v79
    v_mfma_f32_32x32x8bf16_1k v[92:107], v[24:25], v[16:17], v[92:107]
    v_exp_f32 v84, v84
    v_exp_f32 v85, v85
    v_exp_f32 v86, v86
    v_exp_f32 v87, v87
    v_cvt_pk_bf16_f32 v38, v80, v81
    v_cvt_pk_bf16_f32 v39, v82, v83
    v_mfma_f32_32x32x16_bf16 v[60:75], v[128:131], v[40:43], v[60:75]
    v_exp_f32 v88, v88
    v_exp_f32 v89, v89
    v_exp_f32 v90, v90
    v_exp_f32 v91, v91
    v_cvt_pk_bf16_f32 v40, v84, v85
    v_cvt_pk_bf16_f32 v41, v86, v87
    v_mfma_f32_32x32x16_bf16 v[44:59], v[28:31], v[36:39], v[44:59]
    s_waitcnt lgkmcnt(1)
    s_add_u32 m0, s36, 28672
    s_add_u32 s19, m0, s14
    buffer_load_dwordx4 v3, s[4:7], s19 offen lds
    v_exp_f32 v92, v92
    v_exp_f32 v93, v93
    v_exp_f32 v94, v94
    v_exp_f32 v95, v95
    v_cvt_pk_bf16_f32 v42, v88, v89
    v_cvt_pk_bf16_f32 v43, v90, v91
    v_mfma_f32_32x32x16_bf16 v[76:91], v[120:123], v[4:7], 0
    ds_read_b128 v[20:23], v108 offset:10240
    v_exp_f32 v96, v96
    v_exp_f32 v97, v97
    v_exp_f32 v98, v98
    v_exp_f32 v99, v99
    v_cvt_pk_bf16_f32 v36, v92, v93
    v_cvt_pk_bf16_f32 v37, v94, v95
    v_mfma_f32_32x32x8bf16_1k v[76:91], v[24:25], v[14:15], v[76:91]
    v_exp_f32 v100, v100
    v_exp_f32 v101, v101
    v_exp_f32 v102, v102
    v_exp_f32 v103, v103
    v_cvt_pk_bf16_f32 v38, v96, v97
    v_cvt_pk_bf16_f32 v39, v98, v99
    v_mfma_f32_32x32x16_bf16 v[44:59], v[32:35], v[40:43], v[44:59]
    ds_read_b128 v[128:131], v110 offset:11552
    v_exp_f32 v104, v104
    v_exp_f32 v105, v105
    v_exp_f32 v106, v106
    v_exp_f32 v107, v107
    v_cvt_pk_bf16_f32 v40, v100, v101
    v_cvt_pk_bf16_f32 v41, v102, v103
    v_mfma_f32_32x32x16_bf16 v[60:75], v[28:31], v[36:39], v[60:75]
    s_waitcnt lgkmcnt(2)
    s_waitcnt vmcnt(5)
    s_barrier
    v_exp_f32 v76, v76
    v_exp_f32 v77, v77
    v_exp_f32 v78, v78
    v_exp_f32 v79, v79
    v_cvt_pk_bf16_f32 v42, v104, v105
    v_cvt_pk_bf16_f32 v43, v106, v107
    v_mfma_f32_32x32x16_bf16 v[92:107], v[120:123], v[8:11], 0
    ds_read_b128 v[28:31], v110 offset:12160
    v_exp_f32 v80, v80
    v_exp_f32 v81, v81
    v_exp_f32 v82, v82
    v_exp_f32 v83, v83
    v_cvt_pk_bf16_f32 v36, v76, v77
    v_cvt_pk_bf16_f32 v37, v78, v79
    v_mfma_f32_32x32x8bf16_1k v[92:107], v[24:25], v[18:19], v[92:107]
    v_exp_f32 v84, v84
    v_exp_f32 v85, v85
    v_exp_f32 v86, v86
    v_exp_f32 v87, v87
    v_cvt_pk_bf16_f32 v38, v80, v81
    v_cvt_pk_bf16_f32 v39, v82, v83
    v_mfma_f32_32x32x16_bf16 v[60:75], v[32:35], v[40:43], v[60:75]
    ds_read_b128 v[132:135], v109 offset:1536
    v_exp_f32 v88, v88
    v_exp_f32 v89, v89
    v_exp_f32 v90, v90
    v_exp_f32 v91, v91
    v_cvt_pk_bf16_f32 v40, v84, v85
    v_cvt_pk_bf16_f32 v41, v86, v87
    v_mfma_f32_32x32x16_bf16 v[44:59], v[124:127], v[36:39], v[44:59]
    s_waitcnt lgkmcnt(2)
    s_add_u32 m0, s34, 28672
    s_add_u32 s19, m0, s14
    buffer_load_dwordx4 v3, s[4:7], s19 offen lds
    v_exp_f32 v92, v92
    v_exp_f32 v93, v93
    v_exp_f32 v94, v94
    v_exp_f32 v95, v95
    v_cvt_pk_bf16_f32 v42, v88, v89
    v_cvt_pk_bf16_f32 v43, v90, v91
    v_mfma_f32_32x32x16_bf16 v[76:91], v[20:23], v[4:7], 0
    ds_read_b128 v[120:123], v108 offset:11264
    v_exp_f32 v96, v96
    v_exp_f32 v97, v97
    v_exp_f32 v98, v98
    v_exp_f32 v99, v99
    v_cvt_pk_bf16_f32 v36, v92, v93
    v_cvt_pk_bf16_f32 v37, v94, v95
    v_mfma_f32_32x32x8bf16_1k v[76:91], v[26:27], v[12:13], v[76:91]
    v_exp_f32 v100, v100
    v_exp_f32 v101, v101
    v_exp_f32 v102, v102
    v_exp_f32 v103, v103
    v_cvt_pk_bf16_f32 v38, v96, v97
    v_cvt_pk_bf16_f32 v39, v98, v99
    v_mfma_f32_32x32x16_bf16 v[44:59], v[128:131], v[40:43], v[44:59]
    ds_read_b128 v[32:35], v110 offset:12768
    v_exp_f32 v104, v104
    v_exp_f32 v105, v105
    v_exp_f32 v106, v106
    v_exp_f32 v107, v107
    v_cvt_pk_bf16_f32 v40, v100, v101
    v_cvt_pk_bf16_f32 v41, v102, v103
    v_mfma_f32_32x32x16_bf16 v[60:75], v[124:127], v[36:39], v[60:75]
    s_waitcnt lgkmcnt(2)
    v_exp_f32 v76, v76
    v_exp_f32 v77, v77
    v_exp_f32 v78, v78
    v_exp_f32 v79, v79
    v_cvt_pk_bf16_f32 v42, v104, v105
    v_cvt_pk_bf16_f32 v43, v106, v107
    v_mfma_f32_32x32x16_bf16 v[92:107], v[20:23], v[8:11], 0
    ds_read_b128 v[124:127], v110 offset:13376
    v_exp_f32 v80, v80
    v_exp_f32 v81, v81
    v_exp_f32 v82, v82
    v_exp_f32 v83, v83
    v_cvt_pk_bf16_f32 v36, v76, v77
    v_cvt_pk_bf16_f32 v37, v78, v79
    v_mfma_f32_32x32x8bf16_1k v[92:107], v[26:27], v[16:17], v[92:107]
    v_exp_f32 v84, v84
    v_exp_f32 v85, v85
    v_exp_f32 v86, v86
    v_exp_f32 v87, v87
    v_cvt_pk_bf16_f32 v38, v80, v81
    v_cvt_pk_bf16_f32 v39, v82, v83
    v_mfma_f32_32x32x16_bf16 v[60:75], v[128:131], v[40:43], v[60:75]
    v_exp_f32 v88, v88
    v_exp_f32 v89, v89
    v_exp_f32 v90, v90
    v_exp_f32 v91, v91
    v_cvt_pk_bf16_f32 v40, v84, v85
    v_cvt_pk_bf16_f32 v41, v86, v87
    v_mfma_f32_32x32x16_bf16 v[44:59], v[28:31], v[36:39], v[44:59]
    s_waitcnt lgkmcnt(1)
    s_add_u32 m0, s36, 32768
    s_add_u32 s19, m0, s14
    buffer_load_dwordx4 v3, s[4:7], s19 offen lds
    v_exp_f32 v92, v92
    v_exp_f32 v93, v93
    v_exp_f32 v94, v94
    v_exp_f32 v95, v95
    v_cvt_pk_bf16_f32 v42, v88, v89
    v_cvt_pk_bf16_f32 v43, v90, v91
    v_mfma_f32_32x32x16_bf16 v[76:91], v[120:123], v[4:7], 0
    ds_read_b128 v[20:23], v108 offset:12288
    v_exp_f32 v96, v96
    v_exp_f32 v97, v97
    v_exp_f32 v98, v98
    v_exp_f32 v99, v99
    v_cvt_pk_bf16_f32 v36, v92, v93
    v_cvt_pk_bf16_f32 v37, v94, v95
    v_mfma_f32_32x32x8bf16_1k v[76:91], v[26:27], v[14:15], v[76:91]
    v_exp_f32 v100, v100
    v_exp_f32 v101, v101
    v_exp_f32 v102, v102
    v_exp_f32 v103, v103
    v_cvt_pk_bf16_f32 v38, v96, v97
    v_cvt_pk_bf16_f32 v39, v98, v99
    v_mfma_f32_32x32x16_bf16 v[44:59], v[32:35], v[40:43], v[44:59]
    ds_read_b128 v[128:131], v110 offset:13984
    v_exp_f32 v104, v104
    v_exp_f32 v105, v105
    v_exp_f32 v106, v106
    v_exp_f32 v107, v107
    v_cvt_pk_bf16_f32 v40, v100, v101
    v_cvt_pk_bf16_f32 v41, v102, v103
    v_mfma_f32_32x32x16_bf16 v[60:75], v[28:31], v[36:39], v[60:75]
    s_waitcnt lgkmcnt(2)
    v_exp_f32 v76, v76
    v_exp_f32 v77, v77
    v_exp_f32 v78, v78
    v_exp_f32 v79, v79
    v_cvt_pk_bf16_f32 v42, v104, v105
    v_cvt_pk_bf16_f32 v43, v106, v107
    v_mfma_f32_32x32x16_bf16 v[92:107], v[120:123], v[8:11], 0
    ds_read_b128 v[28:31], v110 offset:14592
    v_exp_f32 v80, v80
    v_exp_f32 v81, v81
    v_exp_f32 v82, v82
    v_exp_f32 v83, v83
    v_cvt_pk_bf16_f32 v36, v76, v77
    v_cvt_pk_bf16_f32 v37, v78, v79
    v_mfma_f32_32x32x8bf16_1k v[92:107], v[26:27], v[18:19], v[92:107]
    v_exp_f32 v84, v84
    v_exp_f32 v85, v85
    v_exp_f32 v86, v86
    v_exp_f32 v87, v87
    v_cvt_pk_bf16_f32 v38, v80, v81
    v_cvt_pk_bf16_f32 v39, v82, v83
    v_mfma_f32_32x32x16_bf16 v[60:75], v[32:35], v[40:43], v[60:75]
    v_exp_f32 v88, v88
    v_exp_f32 v89, v89
    v_exp_f32 v90, v90
    v_exp_f32 v91, v91
    v_cvt_pk_bf16_f32 v40, v84, v85
    v_cvt_pk_bf16_f32 v41, v86, v87
    v_mfma_f32_32x32x16_bf16 v[44:59], v[124:127], v[36:39], v[44:59]
    s_waitcnt lgkmcnt(1)
    s_add_u32 m0, s36, 36864
    s_add_u32 s19, m0, s14
    buffer_load_dwordx4 v3, s[4:7], s19 offen lds
    v_exp_f32 v92, v92
    v_exp_f32 v93, v93
    v_exp_f32 v94, v94
    v_exp_f32 v95, v95
    v_cvt_pk_bf16_f32 v42, v88, v89
    v_cvt_pk_bf16_f32 v43, v90, v91
    v_mfma_f32_32x32x16_bf16 v[76:91], v[20:23], v[4:7], 0
    ds_read_b128 v[120:123], v108 offset:13312
    v_exp_f32 v96, v96
    v_exp_f32 v97, v97
    v_exp_f32 v98, v98
    v_exp_f32 v99, v99
    v_cvt_pk_bf16_f32 v36, v92, v93
    v_cvt_pk_bf16_f32 v37, v94, v95
    v_mfma_f32_32x32x8bf16_1k v[76:91], v[132:133], v[12:13], v[76:91]
    v_exp_f32 v100, v100
    v_exp_f32 v101, v101
    v_exp_f32 v102, v102
    v_exp_f32 v103, v103
    v_cvt_pk_bf16_f32 v38, v96, v97
    v_cvt_pk_bf16_f32 v39, v98, v99
    v_mfma_f32_32x32x16_bf16 v[44:59], v[128:131], v[40:43], v[44:59]
    ds_read_b128 v[32:35], v110 offset:15200
    v_exp_f32 v104, v104
    v_exp_f32 v105, v105
    v_exp_f32 v106, v106
    v_exp_f32 v107, v107
    v_cvt_pk_bf16_f32 v40, v100, v101
    v_cvt_pk_bf16_f32 v41, v102, v103
    v_mfma_f32_32x32x16_bf16 v[60:75], v[124:127], v[36:39], v[60:75]
    s_waitcnt lgkmcnt(2)
    v_exp_f32 v76, v76
    v_exp_f32 v77, v77
    v_exp_f32 v78, v78
    v_exp_f32 v79, v79
    v_cvt_pk_bf16_f32 v42, v104, v105
    v_cvt_pk_bf16_f32 v43, v106, v107
    v_mfma_f32_32x32x16_bf16 v[92:107], v[20:23], v[8:11], 0
    ds_read_b128 v[124:127], v110 offset:15808
    v_exp_f32 v80, v80
    v_exp_f32 v81, v81
    v_exp_f32 v82, v82
    v_exp_f32 v83, v83
    v_cvt_pk_bf16_f32 v36, v76, v77
    v_cvt_pk_bf16_f32 v37, v78, v79
    v_mfma_f32_32x32x8bf16_1k v[92:107], v[132:133], v[16:17], v[92:107]
    v_exp_f32 v84, v84
    v_exp_f32 v85, v85
    v_exp_f32 v86, v86
    v_exp_f32 v87, v87
    v_cvt_pk_bf16_f32 v38, v80, v81
    v_cvt_pk_bf16_f32 v39, v82, v83
    v_mfma_f32_32x32x16_bf16 v[60:75], v[128:131], v[40:43], v[60:75]
    v_exp_f32 v88, v88
    v_exp_f32 v89, v89
    v_exp_f32 v90, v90
    v_exp_f32 v91, v91
    v_cvt_pk_bf16_f32 v40, v84, v85
    v_cvt_pk_bf16_f32 v41, v86, v87
    v_mfma_f32_32x32x16_bf16 v[44:59], v[28:31], v[36:39], v[44:59]
    s_waitcnt lgkmcnt(1)
    v_exp_f32 v92, v92
    v_exp_f32 v93, v93
    v_exp_f32 v94, v94
    v_exp_f32 v95, v95
    v_cvt_pk_bf16_f32 v42, v88, v89
    v_cvt_pk_bf16_f32 v43, v90, v91
    v_mfma_f32_32x32x16_bf16 v[76:91], v[120:123], v[4:7], 0
    ds_read_b128 v[20:23], v108 offset:14336
    v_exp_f32 v96, v96
    v_exp_f32 v97, v97
    v_exp_f32 v98, v98
    v_exp_f32 v99, v99
    v_cvt_pk_bf16_f32 v36, v92, v93
    v_cvt_pk_bf16_f32 v37, v94, v95
    v_mfma_f32_32x32x8bf16_1k v[76:91], v[132:133], v[14:15], v[76:91]
    v_exp_f32 v100, v100
    v_exp_f32 v101, v101
    v_exp_f32 v102, v102
    v_exp_f32 v103, v103
    v_cvt_pk_bf16_f32 v38, v96, v97
    v_cvt_pk_bf16_f32 v39, v98, v99
    v_mfma_f32_32x32x16_bf16 v[44:59], v[32:35], v[40:43], v[44:59]
    ds_read_b128 v[128:131], v110 offset:16416
    v_exp_f32 v104, v104
    v_exp_f32 v105, v105
    v_exp_f32 v106, v106
    v_exp_f32 v107, v107
    v_cvt_pk_bf16_f32 v40, v100, v101
    v_cvt_pk_bf16_f32 v41, v102, v103
    v_mfma_f32_32x32x16_bf16 v[60:75], v[28:31], v[36:39], v[60:75]
    s_waitcnt lgkmcnt(2)
    v_exp_f32 v76, v76
    v_exp_f32 v77, v77
    v_exp_f32 v78, v78
    v_exp_f32 v79, v79
    v_cvt_pk_bf16_f32 v42, v104, v105
    v_cvt_pk_bf16_f32 v43, v106, v107
    v_mfma_f32_32x32x16_bf16 v[92:107], v[120:123], v[8:11], 0
    ds_read_b128 v[28:31], v110 offset:17024
    v_exp_f32 v80, v80
    v_exp_f32 v81, v81
    v_exp_f32 v82, v82
    v_exp_f32 v83, v83
    v_cvt_pk_bf16_f32 v36, v76, v77
    v_cvt_pk_bf16_f32 v37, v78, v79
    v_mfma_f32_32x32x8bf16_1k v[92:107], v[132:133], v[18:19], v[92:107]
    v_exp_f32 v84, v84
    v_exp_f32 v85, v85
    v_exp_f32 v86, v86
    v_exp_f32 v87, v87
    v_cvt_pk_bf16_f32 v38, v80, v81
    v_cvt_pk_bf16_f32 v39, v82, v83
    v_mfma_f32_32x32x16_bf16 v[60:75], v[32:35], v[40:43], v[60:75]
    ds_read_b128 v[24:27], v109 offset:2048
    v_exp_f32 v88, v88
    v_exp_f32 v89, v89
    v_exp_f32 v90, v90
    v_exp_f32 v91, v91
    v_cvt_pk_bf16_f32 v40, v84, v85
    v_cvt_pk_bf16_f32 v41, v86, v87
    v_mfma_f32_32x32x16_bf16 v[44:59], v[124:127], v[36:39], v[44:59]
    s_waitcnt lgkmcnt(2)
    v_exp_f32 v92, v92
    v_exp_f32 v93, v93
    v_exp_f32 v94, v94
    v_exp_f32 v95, v95
    v_cvt_pk_bf16_f32 v42, v88, v89
    v_cvt_pk_bf16_f32 v43, v90, v91
    v_mfma_f32_32x32x16_bf16 v[76:91], v[20:23], v[4:7], 0
    ds_read_b128 v[120:123], v108 offset:15360
    v_exp_f32 v96, v96
    v_exp_f32 v97, v97
    v_exp_f32 v98, v98
    v_exp_f32 v99, v99
    v_cvt_pk_bf16_f32 v36, v92, v93
    v_cvt_pk_bf16_f32 v37, v94, v95
    v_mfma_f32_32x32x8bf16_1k v[76:91], v[134:135], v[12:13], v[76:91]
    v_exp_f32 v100, v100
    v_exp_f32 v101, v101
    v_exp_f32 v102, v102
    v_exp_f32 v103, v103
    v_cvt_pk_bf16_f32 v38, v96, v97
    v_cvt_pk_bf16_f32 v39, v98, v99
    v_mfma_f32_32x32x16_bf16 v[44:59], v[128:131], v[40:43], v[44:59]
    ds_read_b128 v[32:35], v110 offset:17632
    v_exp_f32 v104, v104
    v_exp_f32 v105, v105
    v_exp_f32 v106, v106
    v_exp_f32 v107, v107
    v_cvt_pk_bf16_f32 v40, v100, v101
    v_cvt_pk_bf16_f32 v41, v102, v103
    v_mfma_f32_32x32x16_bf16 v[60:75], v[124:127], v[36:39], v[60:75]
    s_waitcnt lgkmcnt(2)
    v_exp_f32 v76, v76
    v_exp_f32 v77, v77
    v_exp_f32 v78, v78
    v_exp_f32 v79, v79
    v_cvt_pk_bf16_f32 v42, v104, v105
    v_cvt_pk_bf16_f32 v43, v106, v107
    v_mfma_f32_32x32x16_bf16 v[92:107], v[20:23], v[8:11], 0
    ds_read_b128 v[124:127], v110 offset:18240
    v_exp_f32 v80, v80
    v_exp_f32 v81, v81
    v_exp_f32 v82, v82
    v_exp_f32 v83, v83
    v_cvt_pk_bf16_f32 v36, v76, v77
    v_cvt_pk_bf16_f32 v37, v78, v79
    v_mfma_f32_32x32x8bf16_1k v[92:107], v[134:135], v[16:17], v[92:107]
    v_exp_f32 v84, v84
    v_exp_f32 v85, v85
    v_exp_f32 v86, v86
    v_exp_f32 v87, v87
    v_cvt_pk_bf16_f32 v38, v80, v81
    v_cvt_pk_bf16_f32 v39, v82, v83
    v_mfma_f32_32x32x16_bf16 v[60:75], v[128:131], v[40:43], v[60:75]
    v_exp_f32 v88, v88
    v_exp_f32 v89, v89
    v_exp_f32 v90, v90
    v_exp_f32 v91, v91
    v_cvt_pk_bf16_f32 v40, v84, v85
    v_cvt_pk_bf16_f32 v41, v86, v87
    v_mfma_f32_32x32x16_bf16 v[44:59], v[28:31], v[36:39], v[44:59]
    s_waitcnt lgkmcnt(1)
    v_exp_f32 v92, v92
    v_exp_f32 v93, v93
    v_exp_f32 v94, v94
    v_exp_f32 v95, v95
    v_cvt_pk_bf16_f32 v42, v88, v89
    v_cvt_pk_bf16_f32 v43, v90, v91
    v_mfma_f32_32x32x16_bf16 v[76:91], v[120:123], v[4:7], 0
    ds_read_b128 v[20:23], v108 offset:16384
    v_exp_f32 v96, v96
    v_exp_f32 v97, v97
    v_exp_f32 v98, v98
    v_exp_f32 v99, v99
    v_cvt_pk_bf16_f32 v36, v92, v93
    v_cvt_pk_bf16_f32 v37, v94, v95
    v_mfma_f32_32x32x8bf16_1k v[76:91], v[134:135], v[14:15], v[76:91]
    v_exp_f32 v100, v100
    v_exp_f32 v101, v101
    v_exp_f32 v102, v102
    v_exp_f32 v103, v103
    v_cvt_pk_bf16_f32 v38, v96, v97
    v_cvt_pk_bf16_f32 v39, v98, v99
    v_mfma_f32_32x32x16_bf16 v[44:59], v[32:35], v[40:43], v[44:59]
    ds_read_b128 v[128:131], v110 offset:18848
    v_exp_f32 v104, v104
    v_exp_f32 v105, v105
    v_exp_f32 v106, v106
    v_exp_f32 v107, v107
    v_cvt_pk_bf16_f32 v40, v100, v101
    v_cvt_pk_bf16_f32 v41, v102, v103
    v_mfma_f32_32x32x16_bf16 v[60:75], v[28:31], v[36:39], v[60:75]
    s_waitcnt lgkmcnt(2)
    s_waitcnt vmcnt(0)
    s_barrier
    v_exp_f32 v76, v76
    v_exp_f32 v77, v77
    v_exp_f32 v78, v78
    v_exp_f32 v79, v79
    v_cvt_pk_bf16_f32 v42, v104, v105
    v_cvt_pk_bf16_f32 v43, v106, v107
    v_mfma_f32_32x32x16_bf16 v[92:107], v[120:123], v[8:11], 0
    ds_read_b128 v[28:31], v110 offset:19456
    v_exp_f32 v80, v80
    v_exp_f32 v81, v81
    v_exp_f32 v82, v82
    v_exp_f32 v83, v83
    v_cvt_pk_bf16_f32 v36, v76, v77
    v_cvt_pk_bf16_f32 v37, v78, v79
    v_mfma_f32_32x32x8bf16_1k v[92:107], v[134:135], v[18:19], v[92:107]
    v_exp_f32 v84, v84
    v_exp_f32 v85, v85
    v_exp_f32 v86, v86
    v_exp_f32 v87, v87
    v_cvt_pk_bf16_f32 v38, v80, v81
    v_cvt_pk_bf16_f32 v39, v82, v83
    v_mfma_f32_32x32x16_bf16 v[60:75], v[32:35], v[40:43], v[60:75]
    v_exp_f32 v88, v88
    v_exp_f32 v89, v89
    v_exp_f32 v90, v90
    v_exp_f32 v91, v91
    v_cvt_pk_bf16_f32 v40, v84, v85
    v_cvt_pk_bf16_f32 v41, v86, v87
    v_mfma_f32_32x32x16_bf16 v[44:59], v[124:127], v[36:39], v[44:59]
    s_waitcnt lgkmcnt(1)
    v_exp_f32 v92, v92
    v_exp_f32 v93, v93
    v_exp_f32 v94, v94
    v_exp_f32 v95, v95
    v_cvt_pk_bf16_f32 v42, v88, v89
    v_cvt_pk_bf16_f32 v43, v90, v91
    v_mfma_f32_32x32x16_bf16 v[76:91], v[20:23], v[4:7], 0
    ds_read_b128 v[120:123], v108 offset:17408
    v_exp_f32 v96, v96
    v_exp_f32 v97, v97
    v_exp_f32 v98, v98
    v_exp_f32 v99, v99
    v_cvt_pk_bf16_f32 v36, v92, v93
    v_cvt_pk_bf16_f32 v37, v94, v95
    v_mfma_f32_32x32x8bf16_1k v[76:91], v[24:25], v[12:13], v[76:91]
    v_exp_f32 v100, v100
    v_exp_f32 v101, v101
    v_exp_f32 v102, v102
    v_exp_f32 v103, v103
    v_cvt_pk_bf16_f32 v38, v96, v97
    v_cvt_pk_bf16_f32 v39, v98, v99
    v_mfma_f32_32x32x16_bf16 v[44:59], v[128:131], v[40:43], v[44:59]
    ds_read_b128 v[32:35], v110 offset:20064
    v_exp_f32 v104, v104
    v_exp_f32 v105, v105
    v_exp_f32 v106, v106
    v_exp_f32 v107, v107
    v_cvt_pk_bf16_f32 v40, v100, v101
    v_cvt_pk_bf16_f32 v41, v102, v103
    v_mfma_f32_32x32x16_bf16 v[60:75], v[124:127], v[36:39], v[60:75]
    s_waitcnt lgkmcnt(2)
    v_exp_f32 v76, v76
    v_exp_f32 v77, v77
    v_exp_f32 v78, v78
    v_exp_f32 v79, v79
    v_cvt_pk_bf16_f32 v42, v104, v105
    v_cvt_pk_bf16_f32 v43, v106, v107
    v_mfma_f32_32x32x16_bf16 v[92:107], v[20:23], v[8:11], 0
    ds_read_b128 v[124:127], v110 offset:20672
    v_exp_f32 v80, v80
    v_exp_f32 v81, v81
    v_exp_f32 v82, v82
    v_exp_f32 v83, v83
    v_cvt_pk_bf16_f32 v36, v76, v77
    v_cvt_pk_bf16_f32 v37, v78, v79
    v_mfma_f32_32x32x8bf16_1k v[92:107], v[24:25], v[16:17], v[92:107]
    v_exp_f32 v84, v84
    v_exp_f32 v85, v85
    v_exp_f32 v86, v86
    v_exp_f32 v87, v87
    v_cvt_pk_bf16_f32 v38, v80, v81
    v_cvt_pk_bf16_f32 v39, v82, v83
    v_mfma_f32_32x32x16_bf16 v[60:75], v[128:131], v[40:43], v[60:75]
    v_exp_f32 v88, v88
    v_exp_f32 v89, v89
    v_exp_f32 v90, v90
    v_exp_f32 v91, v91
    v_cvt_pk_bf16_f32 v40, v84, v85
    v_cvt_pk_bf16_f32 v41, v86, v87
    v_mfma_f32_32x32x16_bf16 v[44:59], v[28:31], v[36:39], v[44:59]
    s_waitcnt lgkmcnt(1)
    v_exp_f32 v92, v92
    v_exp_f32 v93, v93
    v_exp_f32 v94, v94
    v_exp_f32 v95, v95
    v_cvt_pk_bf16_f32 v42, v88, v89
    v_cvt_pk_bf16_f32 v43, v90, v91
    v_mfma_f32_32x32x16_bf16 v[76:91], v[120:123], v[4:7], 0
    ds_read_b128 v[20:23], v108 offset:18432
    v_exp_f32 v96, v96
    v_exp_f32 v97, v97
    v_exp_f32 v98, v98
    v_exp_f32 v99, v99
    v_cvt_pk_bf16_f32 v36, v92, v93
    v_cvt_pk_bf16_f32 v37, v94, v95
    v_mfma_f32_32x32x8bf16_1k v[76:91], v[24:25], v[14:15], v[76:91]
    v_exp_f32 v100, v100
    v_exp_f32 v101, v101
    v_exp_f32 v102, v102
    v_exp_f32 v103, v103
    v_cvt_pk_bf16_f32 v38, v96, v97
    v_cvt_pk_bf16_f32 v39, v98, v99
    v_mfma_f32_32x32x16_bf16 v[44:59], v[32:35], v[40:43], v[44:59]
    ds_read_b128 v[128:131], v110 offset:21280
    v_exp_f32 v104, v104
    v_exp_f32 v105, v105
    v_exp_f32 v106, v106
    v_exp_f32 v107, v107
    v_cvt_pk_bf16_f32 v40, v100, v101
    v_cvt_pk_bf16_f32 v41, v102, v103
    v_mfma_f32_32x32x16_bf16 v[60:75], v[28:31], v[36:39], v[60:75]
    s_waitcnt lgkmcnt(2)
    v_exp_f32 v76, v76
    v_exp_f32 v77, v77
    v_exp_f32 v78, v78
    v_exp_f32 v79, v79
    v_cvt_pk_bf16_f32 v42, v104, v105
    v_cvt_pk_bf16_f32 v43, v106, v107
    v_mfma_f32_32x32x16_bf16 v[92:107], v[120:123], v[8:11], 0
    ds_read_b128 v[28:31], v110 offset:21888
    v_exp_f32 v80, v80
    v_exp_f32 v81, v81
    v_exp_f32 v82, v82
    v_exp_f32 v83, v83
    v_cvt_pk_bf16_f32 v36, v76, v77
    v_cvt_pk_bf16_f32 v37, v78, v79
    v_mfma_f32_32x32x8bf16_1k v[92:107], v[24:25], v[18:19], v[92:107]
    v_exp_f32 v84, v84
    v_exp_f32 v85, v85
    v_exp_f32 v86, v86
    v_exp_f32 v87, v87
    v_cvt_pk_bf16_f32 v38, v80, v81
    v_cvt_pk_bf16_f32 v39, v82, v83
    v_mfma_f32_32x32x16_bf16 v[60:75], v[32:35], v[40:43], v[60:75]
    ds_read_b128 v[132:135], v109 offset:2560
    v_exp_f32 v88, v88
    v_exp_f32 v89, v89
    v_exp_f32 v90, v90
    v_exp_f32 v91, v91
    v_cvt_pk_bf16_f32 v40, v84, v85
    v_cvt_pk_bf16_f32 v41, v86, v87
    v_mfma_f32_32x32x16_bf16 v[44:59], v[124:127], v[36:39], v[44:59]
    s_waitcnt lgkmcnt(2)
    v_exp_f32 v92, v92
    v_exp_f32 v93, v93
    v_exp_f32 v94, v94
    v_exp_f32 v95, v95
    v_cvt_pk_bf16_f32 v42, v88, v89
    v_cvt_pk_bf16_f32 v43, v90, v91
    v_mfma_f32_32x32x16_bf16 v[76:91], v[20:23], v[4:7], 0
    ds_read_b128 v[120:123], v108 offset:19456
    v_exp_f32 v96, v96
    v_exp_f32 v97, v97
    v_exp_f32 v98, v98
    v_exp_f32 v99, v99
    v_cvt_pk_bf16_f32 v36, v92, v93
    v_cvt_pk_bf16_f32 v37, v94, v95
    v_mfma_f32_32x32x8bf16_1k v[76:91], v[26:27], v[12:13], v[76:91]
    v_exp_f32 v100, v100
    v_exp_f32 v101, v101
    v_exp_f32 v102, v102
    v_exp_f32 v103, v103
    v_cvt_pk_bf16_f32 v38, v96, v97
    v_cvt_pk_bf16_f32 v39, v98, v99
    v_mfma_f32_32x32x16_bf16 v[44:59], v[128:131], v[40:43], v[44:59]
    ds_read_b128 v[32:35], v110 offset:22496
    v_exp_f32 v104, v104
    v_exp_f32 v105, v105
    v_exp_f32 v106, v106
    v_exp_f32 v107, v107
    v_cvt_pk_bf16_f32 v40, v100, v101
    v_cvt_pk_bf16_f32 v41, v102, v103
    v_mfma_f32_32x32x16_bf16 v[60:75], v[124:127], v[36:39], v[60:75]
    s_waitcnt lgkmcnt(2)
    v_exp_f32 v76, v76
    v_exp_f32 v77, v77
    v_exp_f32 v78, v78
    v_exp_f32 v79, v79
    v_cvt_pk_bf16_f32 v42, v104, v105
    v_cvt_pk_bf16_f32 v43, v106, v107
    v_mfma_f32_32x32x16_bf16 v[92:107], v[20:23], v[8:11], 0
    ds_read_b128 v[124:127], v110 offset:23104
    v_exp_f32 v80, v80
    v_exp_f32 v81, v81
    v_exp_f32 v82, v82
    v_exp_f32 v83, v83
    v_cvt_pk_bf16_f32 v36, v76, v77
    v_cvt_pk_bf16_f32 v37, v78, v79
    v_mfma_f32_32x32x8bf16_1k v[92:107], v[26:27], v[16:17], v[92:107]
    v_exp_f32 v84, v84
    v_exp_f32 v85, v85
    v_exp_f32 v86, v86
    v_exp_f32 v87, v87
    v_cvt_pk_bf16_f32 v38, v80, v81
    v_cvt_pk_bf16_f32 v39, v82, v83
    v_mfma_f32_32x32x16_bf16 v[60:75], v[128:131], v[40:43], v[60:75]
    v_exp_f32 v88, v88
    v_exp_f32 v89, v89
    v_exp_f32 v90, v90
    v_exp_f32 v91, v91
    v_cvt_pk_bf16_f32 v40, v84, v85
    v_cvt_pk_bf16_f32 v41, v86, v87
    v_mfma_f32_32x32x16_bf16 v[44:59], v[28:31], v[36:39], v[44:59]
    s_waitcnt lgkmcnt(1)
    v_exp_f32 v92, v92
    v_exp_f32 v93, v93
    v_exp_f32 v94, v94
    v_exp_f32 v95, v95
    v_cvt_pk_bf16_f32 v42, v88, v89
    v_cvt_pk_bf16_f32 v43, v90, v91
    v_mfma_f32_32x32x16_bf16 v[76:91], v[120:123], v[4:7], 0
    ds_read_b128 v[20:23], v108 offset:20480
    v_exp_f32 v96, v96
    v_exp_f32 v97, v97
    v_exp_f32 v98, v98
    v_exp_f32 v99, v99
    v_cvt_pk_bf16_f32 v36, v92, v93
    v_cvt_pk_bf16_f32 v37, v94, v95
    v_mfma_f32_32x32x8bf16_1k v[76:91], v[26:27], v[14:15], v[76:91]
    v_exp_f32 v100, v100
    v_exp_f32 v101, v101
    v_exp_f32 v102, v102
    v_exp_f32 v103, v103
    v_cvt_pk_bf16_f32 v38, v96, v97
    v_cvt_pk_bf16_f32 v39, v98, v99
    v_mfma_f32_32x32x16_bf16 v[44:59], v[32:35], v[40:43], v[44:59]
    ds_read_b128 v[128:131], v110 offset:23712
    v_exp_f32 v104, v104
    v_exp_f32 v105, v105
    v_exp_f32 v106, v106
    v_exp_f32 v107, v107
    v_cvt_pk_bf16_f32 v40, v100, v101
    v_cvt_pk_bf16_f32 v41, v102, v103
    v_mfma_f32_32x32x16_bf16 v[60:75], v[28:31], v[36:39], v[60:75]
    s_waitcnt lgkmcnt(2)
    v_exp_f32 v76, v76
    v_exp_f32 v77, v77
    v_exp_f32 v78, v78
    v_exp_f32 v79, v79
    v_cvt_pk_bf16_f32 v42, v104, v105
    v_cvt_pk_bf16_f32 v43, v106, v107
    v_mfma_f32_32x32x16_bf16 v[92:107], v[120:123], v[8:11], 0
    ds_read_b128 v[28:31], v110 offset:24320
    v_exp_f32 v80, v80
    v_exp_f32 v81, v81
    v_exp_f32 v82, v82
    v_exp_f32 v83, v83
    v_cvt_pk_bf16_f32 v36, v76, v77
    v_cvt_pk_bf16_f32 v37, v78, v79
    v_mfma_f32_32x32x8bf16_1k v[92:107], v[26:27], v[18:19], v[92:107]
    v_exp_f32 v84, v84
    v_exp_f32 v85, v85
    v_exp_f32 v86, v86
    v_exp_f32 v87, v87
    v_cvt_pk_bf16_f32 v38, v80, v81
    v_cvt_pk_bf16_f32 v39, v82, v83
    v_mfma_f32_32x32x16_bf16 v[60:75], v[32:35], v[40:43], v[60:75]
    v_exp_f32 v88, v88
    v_exp_f32 v89, v89
    v_exp_f32 v90, v90
    v_exp_f32 v91, v91
    v_cvt_pk_bf16_f32 v40, v84, v85
    v_cvt_pk_bf16_f32 v41, v86, v87
    v_mfma_f32_32x32x16_bf16 v[44:59], v[124:127], v[36:39], v[44:59]
    s_waitcnt lgkmcnt(1)
    v_exp_f32 v92, v92
    v_exp_f32 v93, v93
    v_exp_f32 v94, v94
    v_exp_f32 v95, v95
    v_cvt_pk_bf16_f32 v42, v88, v89
    v_cvt_pk_bf16_f32 v43, v90, v91
    v_mfma_f32_32x32x16_bf16 v[76:91], v[20:23], v[4:7], 0
    ds_read_b128 v[120:123], v108 offset:21504
    v_exp_f32 v96, v96
    v_exp_f32 v97, v97
    v_exp_f32 v98, v98
    v_exp_f32 v99, v99
    v_cvt_pk_bf16_f32 v36, v92, v93
    v_cvt_pk_bf16_f32 v37, v94, v95
    v_mfma_f32_32x32x8bf16_1k v[76:91], v[132:133], v[12:13], v[76:91]
    v_exp_f32 v100, v100
    v_exp_f32 v101, v101
    v_exp_f32 v102, v102
    v_exp_f32 v103, v103
    v_cvt_pk_bf16_f32 v38, v96, v97
    v_cvt_pk_bf16_f32 v39, v98, v99
    v_mfma_f32_32x32x16_bf16 v[44:59], v[128:131], v[40:43], v[44:59]
    ds_read_b128 v[32:35], v110 offset:24928
    v_exp_f32 v104, v104
    v_exp_f32 v105, v105
    v_exp_f32 v106, v106
    v_exp_f32 v107, v107
    v_cvt_pk_bf16_f32 v40, v100, v101
    v_cvt_pk_bf16_f32 v41, v102, v103
    v_mfma_f32_32x32x16_bf16 v[60:75], v[124:127], v[36:39], v[60:75]
    s_waitcnt lgkmcnt(2)
    v_exp_f32 v76, v76
    v_exp_f32 v77, v77
    v_exp_f32 v78, v78
    v_exp_f32 v79, v79
    v_cvt_pk_bf16_f32 v42, v104, v105
    v_cvt_pk_bf16_f32 v43, v106, v107
    v_mfma_f32_32x32x16_bf16 v[92:107], v[20:23], v[8:11], 0
    ds_read_b128 v[124:127], v110 offset:25536
    v_exp_f32 v80, v80
    v_exp_f32 v81, v81
    v_exp_f32 v82, v82
    v_exp_f32 v83, v83
    v_cvt_pk_bf16_f32 v36, v76, v77
    v_cvt_pk_bf16_f32 v37, v78, v79
    v_mfma_f32_32x32x8bf16_1k v[92:107], v[132:133], v[16:17], v[92:107]
    v_exp_f32 v84, v84
    v_exp_f32 v85, v85
    v_exp_f32 v86, v86
    v_exp_f32 v87, v87
    v_cvt_pk_bf16_f32 v38, v80, v81
    v_cvt_pk_bf16_f32 v39, v82, v83
    v_mfma_f32_32x32x16_bf16 v[60:75], v[128:131], v[40:43], v[60:75]
    v_exp_f32 v88, v88
    v_exp_f32 v89, v89
    v_exp_f32 v90, v90
    v_exp_f32 v91, v91
    v_cvt_pk_bf16_f32 v40, v84, v85
    v_cvt_pk_bf16_f32 v41, v86, v87
    v_mfma_f32_32x32x16_bf16 v[44:59], v[28:31], v[36:39], v[44:59]
    s_waitcnt lgkmcnt(1)
    v_exp_f32 v92, v92
    v_exp_f32 v93, v93
    v_exp_f32 v94, v94
    v_exp_f32 v95, v95
    v_cvt_pk_bf16_f32 v42, v88, v89
    v_cvt_pk_bf16_f32 v43, v90, v91
    v_mfma_f32_32x32x16_bf16 v[76:91], v[120:123], v[4:7], 0
    ds_read_b128 v[20:23], v108 offset:22528
    v_exp_f32 v96, v96
    v_exp_f32 v97, v97
    v_exp_f32 v98, v98
    v_exp_f32 v99, v99
    v_cvt_pk_bf16_f32 v36, v92, v93
    v_cvt_pk_bf16_f32 v37, v94, v95
    v_mfma_f32_32x32x8bf16_1k v[76:91], v[132:133], v[14:15], v[76:91]
    v_exp_f32 v100, v100
    v_exp_f32 v101, v101
    v_exp_f32 v102, v102
    v_exp_f32 v103, v103
    v_cvt_pk_bf16_f32 v38, v96, v97
    v_cvt_pk_bf16_f32 v39, v98, v99
    v_mfma_f32_32x32x16_bf16 v[44:59], v[32:35], v[40:43], v[44:59]
    ds_read_b128 v[128:131], v110 offset:26144
    v_exp_f32 v104, v104
    v_exp_f32 v105, v105
    v_exp_f32 v106, v106
    v_exp_f32 v107, v107
    v_cvt_pk_bf16_f32 v40, v100, v101
    v_cvt_pk_bf16_f32 v41, v102, v103
    v_mfma_f32_32x32x16_bf16 v[60:75], v[28:31], v[36:39], v[60:75]
    s_waitcnt lgkmcnt(2)
    v_exp_f32 v76, v76
    v_exp_f32 v77, v77
    v_exp_f32 v78, v78
    v_exp_f32 v79, v79
    v_cvt_pk_bf16_f32 v42, v104, v105
    v_cvt_pk_bf16_f32 v43, v106, v107
    v_mfma_f32_32x32x16_bf16 v[92:107], v[120:123], v[8:11], 0
    ds_read_b128 v[28:31], v110 offset:26752
    v_exp_f32 v80, v80
    v_exp_f32 v81, v81
    v_exp_f32 v82, v82
    v_exp_f32 v83, v83
    v_cvt_pk_bf16_f32 v36, v76, v77
    v_cvt_pk_bf16_f32 v37, v78, v79
    v_mfma_f32_32x32x8bf16_1k v[92:107], v[132:133], v[18:19], v[92:107]
    v_exp_f32 v84, v84
    v_exp_f32 v85, v85
    v_exp_f32 v86, v86
    v_exp_f32 v87, v87
    v_cvt_pk_bf16_f32 v38, v80, v81
    v_cvt_pk_bf16_f32 v39, v82, v83
    v_mfma_f32_32x32x16_bf16 v[60:75], v[32:35], v[40:43], v[60:75]
    ds_read_b128 v[24:27], v109 offset:3072
    v_exp_f32 v88, v88
    v_exp_f32 v89, v89
    v_exp_f32 v90, v90
    v_exp_f32 v91, v91
    v_cvt_pk_bf16_f32 v40, v84, v85
    v_cvt_pk_bf16_f32 v41, v86, v87
    v_mfma_f32_32x32x16_bf16 v[44:59], v[124:127], v[36:39], v[44:59]
    s_waitcnt lgkmcnt(2)
    v_exp_f32 v92, v92
    v_exp_f32 v93, v93
    v_exp_f32 v94, v94
    v_exp_f32 v95, v95
    v_cvt_pk_bf16_f32 v42, v88, v89
    v_cvt_pk_bf16_f32 v43, v90, v91
    v_mfma_f32_32x32x16_bf16 v[76:91], v[20:23], v[4:7], 0
    ds_read_b128 v[120:123], v108 offset:23552
    v_exp_f32 v96, v96
    v_exp_f32 v97, v97
    v_exp_f32 v98, v98
    v_exp_f32 v99, v99
    v_cvt_pk_bf16_f32 v36, v92, v93
    v_cvt_pk_bf16_f32 v37, v94, v95
    v_mfma_f32_32x32x8bf16_1k v[76:91], v[134:135], v[12:13], v[76:91]
    v_exp_f32 v100, v100
    v_exp_f32 v101, v101
    v_exp_f32 v102, v102
    v_exp_f32 v103, v103
    v_cvt_pk_bf16_f32 v38, v96, v97
    v_cvt_pk_bf16_f32 v39, v98, v99
    v_mfma_f32_32x32x16_bf16 v[44:59], v[128:131], v[40:43], v[44:59]
    ds_read_b128 v[32:35], v110 offset:27360
    v_exp_f32 v104, v104
    v_exp_f32 v105, v105
    v_exp_f32 v106, v106
    v_exp_f32 v107, v107
    v_cvt_pk_bf16_f32 v40, v100, v101
    v_cvt_pk_bf16_f32 v41, v102, v103
    v_mfma_f32_32x32x16_bf16 v[60:75], v[124:127], v[36:39], v[60:75]
    s_waitcnt lgkmcnt(2)
    v_exp_f32 v76, v76
    v_exp_f32 v77, v77
    v_exp_f32 v78, v78
    v_exp_f32 v79, v79
    v_cvt_pk_bf16_f32 v42, v104, v105
    v_cvt_pk_bf16_f32 v43, v106, v107
    v_mfma_f32_32x32x16_bf16 v[92:107], v[20:23], v[8:11], 0
    ds_read_b128 v[124:127], v110 offset:27968
    v_exp_f32 v80, v80
    v_exp_f32 v81, v81
    v_exp_f32 v82, v82
    v_exp_f32 v83, v83
    v_cvt_pk_bf16_f32 v36, v76, v77
    v_cvt_pk_bf16_f32 v37, v78, v79
    v_mfma_f32_32x32x8bf16_1k v[92:107], v[134:135], v[16:17], v[92:107]
    v_exp_f32 v84, v84
    v_exp_f32 v85, v85
    v_exp_f32 v86, v86
    v_exp_f32 v87, v87
    v_cvt_pk_bf16_f32 v38, v80, v81
    v_cvt_pk_bf16_f32 v39, v82, v83
    v_mfma_f32_32x32x16_bf16 v[60:75], v[128:131], v[40:43], v[60:75]
    v_exp_f32 v88, v88
    v_exp_f32 v89, v89
    v_exp_f32 v90, v90
    v_exp_f32 v91, v91
    v_cvt_pk_bf16_f32 v40, v84, v85
    v_cvt_pk_bf16_f32 v41, v86, v87
    v_mfma_f32_32x32x16_bf16 v[44:59], v[28:31], v[36:39], v[44:59]
    s_waitcnt lgkmcnt(1)
    v_exp_f32 v92, v92
    v_exp_f32 v93, v93
    v_exp_f32 v94, v94
    v_exp_f32 v95, v95
    v_cvt_pk_bf16_f32 v42, v88, v89
    v_cvt_pk_bf16_f32 v43, v90, v91
    v_mfma_f32_32x32x16_bf16 v[76:91], v[120:123], v[4:7], 0
    ds_read_b128 v[20:23], v108 offset:24576
    v_exp_f32 v96, v96
    v_exp_f32 v97, v97
    v_exp_f32 v98, v98
    v_exp_f32 v99, v99
    v_cvt_pk_bf16_f32 v36, v92, v93
    v_cvt_pk_bf16_f32 v37, v94, v95
    v_mfma_f32_32x32x8bf16_1k v[76:91], v[134:135], v[14:15], v[76:91]
    v_exp_f32 v100, v100
    v_exp_f32 v101, v101
    v_exp_f32 v102, v102
    v_exp_f32 v103, v103
    v_cvt_pk_bf16_f32 v38, v96, v97
    v_cvt_pk_bf16_f32 v39, v98, v99
    v_mfma_f32_32x32x16_bf16 v[44:59], v[32:35], v[40:43], v[44:59]
    ds_read_b128 v[128:131], v110 offset:28576
    v_exp_f32 v104, v104
    v_exp_f32 v105, v105
    v_exp_f32 v106, v106
    v_exp_f32 v107, v107
    v_cvt_pk_bf16_f32 v40, v100, v101
    v_cvt_pk_bf16_f32 v41, v102, v103
    v_mfma_f32_32x32x16_bf16 v[60:75], v[28:31], v[36:39], v[60:75]
    s_waitcnt lgkmcnt(2)
    v_exp_f32 v76, v76
    v_exp_f32 v77, v77
    v_exp_f32 v78, v78
    v_exp_f32 v79, v79
    v_cvt_pk_bf16_f32 v42, v104, v105
    v_cvt_pk_bf16_f32 v43, v106, v107
    v_mfma_f32_32x32x16_bf16 v[92:107], v[120:123], v[8:11], 0
    ds_read_b128 v[28:31], v110 offset:29184
    v_exp_f32 v80, v80
    v_exp_f32 v81, v81
    v_exp_f32 v82, v82
    v_exp_f32 v83, v83
    v_cvt_pk_bf16_f32 v36, v76, v77
    v_cvt_pk_bf16_f32 v37, v78, v79
    v_mfma_f32_32x32x8bf16_1k v[92:107], v[134:135], v[18:19], v[92:107]
    v_exp_f32 v84, v84
    v_exp_f32 v85, v85
    v_exp_f32 v86, v86
    v_exp_f32 v87, v87
    v_cvt_pk_bf16_f32 v38, v80, v81
    v_cvt_pk_bf16_f32 v39, v82, v83
    v_mfma_f32_32x32x16_bf16 v[60:75], v[32:35], v[40:43], v[60:75]
    v_exp_f32 v88, v88
    v_exp_f32 v89, v89
    v_exp_f32 v90, v90
    v_exp_f32 v91, v91
    v_cvt_pk_bf16_f32 v40, v84, v85
    v_cvt_pk_bf16_f32 v41, v86, v87
    v_mfma_f32_32x32x16_bf16 v[44:59], v[124:127], v[36:39], v[44:59]
    s_waitcnt lgkmcnt(1)
    v_exp_f32 v92, v92
    v_exp_f32 v93, v93
    v_exp_f32 v94, v94
    v_exp_f32 v95, v95
    v_cvt_pk_bf16_f32 v42, v88, v89
    v_cvt_pk_bf16_f32 v43, v90, v91
    v_mfma_f32_32x32x16_bf16 v[76:91], v[20:23], v[4:7], 0
    ds_read_b128 v[120:123], v108 offset:25600
    v_exp_f32 v96, v96
    v_exp_f32 v97, v97
    v_exp_f32 v98, v98
    v_exp_f32 v99, v99
    v_cvt_pk_bf16_f32 v36, v92, v93
    v_cvt_pk_bf16_f32 v37, v94, v95
    v_mfma_f32_32x32x8bf16_1k v[76:91], v[24:25], v[12:13], v[76:91]
    v_exp_f32 v100, v100
    v_exp_f32 v101, v101
    v_exp_f32 v102, v102
    v_exp_f32 v103, v103
    v_cvt_pk_bf16_f32 v38, v96, v97
    v_cvt_pk_bf16_f32 v39, v98, v99
    v_mfma_f32_32x32x16_bf16 v[44:59], v[128:131], v[40:43], v[44:59]
    ds_read_b128 v[32:35], v110 offset:29792
    v_exp_f32 v104, v104
    v_exp_f32 v105, v105
    v_exp_f32 v106, v106
    v_exp_f32 v107, v107
    v_cvt_pk_bf16_f32 v40, v100, v101
    v_cvt_pk_bf16_f32 v41, v102, v103
    v_mfma_f32_32x32x16_bf16 v[60:75], v[124:127], v[36:39], v[60:75]
    s_waitcnt lgkmcnt(2)
    v_exp_f32 v76, v76
    v_exp_f32 v77, v77
    v_exp_f32 v78, v78
    v_exp_f32 v79, v79
    v_cvt_pk_bf16_f32 v42, v104, v105
    v_cvt_pk_bf16_f32 v43, v106, v107
    v_mfma_f32_32x32x16_bf16 v[92:107], v[20:23], v[8:11], 0
    ds_read_b128 v[124:127], v110 offset:30400
    v_exp_f32 v80, v80
    v_exp_f32 v81, v81
    v_exp_f32 v82, v82
    v_exp_f32 v83, v83
    v_cvt_pk_bf16_f32 v36, v76, v77
    v_cvt_pk_bf16_f32 v37, v78, v79
    v_mfma_f32_32x32x8bf16_1k v[92:107], v[24:25], v[16:17], v[92:107]
    v_exp_f32 v84, v84
    v_exp_f32 v85, v85
    v_exp_f32 v86, v86
    v_exp_f32 v87, v87
    v_cvt_pk_bf16_f32 v38, v80, v81
    v_cvt_pk_bf16_f32 v39, v82, v83
    v_mfma_f32_32x32x16_bf16 v[60:75], v[128:131], v[40:43], v[60:75]
    v_exp_f32 v88, v88
    v_exp_f32 v89, v89
    v_exp_f32 v90, v90
    v_exp_f32 v91, v91
    v_cvt_pk_bf16_f32 v40, v84, v85
    v_cvt_pk_bf16_f32 v41, v86, v87
    v_mfma_f32_32x32x16_bf16 v[44:59], v[28:31], v[36:39], v[44:59]
    s_waitcnt lgkmcnt(1)
    v_exp_f32 v92, v92
    v_exp_f32 v93, v93
    v_exp_f32 v94, v94
    v_exp_f32 v95, v95
    v_cvt_pk_bf16_f32 v42, v88, v89
    v_cvt_pk_bf16_f32 v43, v90, v91
    v_mfma_f32_32x32x16_bf16 v[76:91], v[120:123], v[4:7], 0
    ds_read_b128 v[20:23], v108 offset:26624
    v_exp_f32 v96, v96
    v_exp_f32 v97, v97
    v_exp_f32 v98, v98
    v_exp_f32 v99, v99
    v_cvt_pk_bf16_f32 v36, v92, v93
    v_cvt_pk_bf16_f32 v37, v94, v95
    v_mfma_f32_32x32x8bf16_1k v[76:91], v[24:25], v[14:15], v[76:91]
    v_exp_f32 v100, v100
    v_exp_f32 v101, v101
    v_exp_f32 v102, v102
    v_exp_f32 v103, v103
    v_cvt_pk_bf16_f32 v38, v96, v97
    v_cvt_pk_bf16_f32 v39, v98, v99
    v_mfma_f32_32x32x16_bf16 v[44:59], v[32:35], v[40:43], v[44:59]
    ds_read_b128 v[128:131], v110 offset:31008
    v_exp_f32 v104, v104
    v_exp_f32 v105, v105
    v_exp_f32 v106, v106
    v_exp_f32 v107, v107
    v_cvt_pk_bf16_f32 v40, v100, v101
    v_cvt_pk_bf16_f32 v41, v102, v103
    v_mfma_f32_32x32x16_bf16 v[60:75], v[28:31], v[36:39], v[60:75]
    s_waitcnt lgkmcnt(2)
    v_exp_f32 v76, v76
    v_exp_f32 v77, v77
    v_exp_f32 v78, v78
    v_exp_f32 v79, v79
    v_cvt_pk_bf16_f32 v42, v104, v105
    v_cvt_pk_bf16_f32 v43, v106, v107
    v_mfma_f32_32x32x16_bf16 v[92:107], v[120:123], v[8:11], 0
    ds_read_b128 v[28:31], v110 offset:31616
    v_exp_f32 v80, v80
    v_exp_f32 v81, v81
    v_exp_f32 v82, v82
    v_exp_f32 v83, v83
    v_cvt_pk_bf16_f32 v36, v76, v77
    v_cvt_pk_bf16_f32 v37, v78, v79
    v_mfma_f32_32x32x8bf16_1k v[92:107], v[24:25], v[18:19], v[92:107]
    v_exp_f32 v84, v84
    v_exp_f32 v85, v85
    v_exp_f32 v86, v86
    v_exp_f32 v87, v87
    v_cvt_pk_bf16_f32 v38, v80, v81
    v_cvt_pk_bf16_f32 v39, v82, v83
    v_mfma_f32_32x32x16_bf16 v[60:75], v[32:35], v[40:43], v[60:75]
    ds_read_b128 v[132:135], v109 offset:3584
    v_exp_f32 v88, v88
    v_exp_f32 v89, v89
    v_exp_f32 v90, v90
    v_exp_f32 v91, v91
    v_cvt_pk_bf16_f32 v40, v84, v85
    v_cvt_pk_bf16_f32 v41, v86, v87
    v_mfma_f32_32x32x16_bf16 v[44:59], v[124:127], v[36:39], v[44:59]
    s_waitcnt lgkmcnt(2)
    v_exp_f32 v92, v92
    v_exp_f32 v93, v93
    v_exp_f32 v94, v94
    v_exp_f32 v95, v95
    v_cvt_pk_bf16_f32 v42, v88, v89
    v_cvt_pk_bf16_f32 v43, v90, v91
    v_mfma_f32_32x32x16_bf16 v[76:91], v[20:23], v[4:7], 0
    ds_read_b128 v[120:123], v108 offset:27648
    v_exp_f32 v96, v96
    v_exp_f32 v97, v97
    v_exp_f32 v98, v98
    v_exp_f32 v99, v99
    v_cvt_pk_bf16_f32 v36, v92, v93
    v_cvt_pk_bf16_f32 v37, v94, v95
    v_mfma_f32_32x32x8bf16_1k v[76:91], v[26:27], v[12:13], v[76:91]
    v_exp_f32 v100, v100
    v_exp_f32 v101, v101
    v_exp_f32 v102, v102
    v_exp_f32 v103, v103
    v_cvt_pk_bf16_f32 v38, v96, v97
    v_cvt_pk_bf16_f32 v39, v98, v99
    v_mfma_f32_32x32x16_bf16 v[44:59], v[128:131], v[40:43], v[44:59]
    ds_read_b128 v[32:35], v110 offset:32224
    v_exp_f32 v104, v104
    v_exp_f32 v105, v105
    v_exp_f32 v106, v106
    v_exp_f32 v107, v107
    v_cvt_pk_bf16_f32 v40, v100, v101
    v_cvt_pk_bf16_f32 v41, v102, v103
    v_mfma_f32_32x32x16_bf16 v[60:75], v[124:127], v[36:39], v[60:75]
    s_waitcnt lgkmcnt(2)
    v_exp_f32 v76, v76
    v_exp_f32 v77, v77
    v_exp_f32 v78, v78
    v_exp_f32 v79, v79
    v_cvt_pk_bf16_f32 v42, v104, v105
    v_cvt_pk_bf16_f32 v43, v106, v107
    v_mfma_f32_32x32x16_bf16 v[92:107], v[20:23], v[8:11], 0
    ds_read_b128 v[124:127], v110 offset:32832
    v_exp_f32 v80, v80
    v_exp_f32 v81, v81
    v_exp_f32 v82, v82
    v_exp_f32 v83, v83
    v_cvt_pk_bf16_f32 v36, v76, v77
    v_cvt_pk_bf16_f32 v37, v78, v79
    v_mfma_f32_32x32x8bf16_1k v[92:107], v[26:27], v[16:17], v[92:107]
    v_exp_f32 v84, v84
    v_exp_f32 v85, v85
    v_exp_f32 v86, v86
    v_exp_f32 v87, v87
    v_cvt_pk_bf16_f32 v38, v80, v81
    v_cvt_pk_bf16_f32 v39, v82, v83
    v_mfma_f32_32x32x16_bf16 v[60:75], v[128:131], v[40:43], v[60:75]
    v_exp_f32 v88, v88
    v_exp_f32 v89, v89
    v_exp_f32 v90, v90
    v_exp_f32 v91, v91
    v_cvt_pk_bf16_f32 v40, v84, v85
    v_cvt_pk_bf16_f32 v41, v86, v87
    v_mfma_f32_32x32x16_bf16 v[44:59], v[28:31], v[36:39], v[44:59]
    s_waitcnt lgkmcnt(1)
    v_exp_f32 v92, v92
    v_exp_f32 v93, v93
    v_exp_f32 v94, v94
    v_exp_f32 v95, v95
    v_cvt_pk_bf16_f32 v42, v88, v89
    v_cvt_pk_bf16_f32 v43, v90, v91
    v_mfma_f32_32x32x16_bf16 v[76:91], v[120:123], v[4:7], 0
    ds_read_b128 v[20:23], v108 offset:28672
    v_exp_f32 v96, v96
    v_exp_f32 v97, v97
    v_exp_f32 v98, v98
    v_exp_f32 v99, v99
    v_cvt_pk_bf16_f32 v36, v92, v93
    v_cvt_pk_bf16_f32 v37, v94, v95
    v_mfma_f32_32x32x8bf16_1k v[76:91], v[26:27], v[14:15], v[76:91]
    v_exp_f32 v100, v100
    v_exp_f32 v101, v101
    v_exp_f32 v102, v102
    v_exp_f32 v103, v103
    v_cvt_pk_bf16_f32 v38, v96, v97
    v_cvt_pk_bf16_f32 v39, v98, v99
    v_mfma_f32_32x32x16_bf16 v[44:59], v[32:35], v[40:43], v[44:59]
    ds_read_b128 v[128:131], v110 offset:33440
    v_exp_f32 v104, v104
    v_exp_f32 v105, v105
    v_exp_f32 v106, v106
    v_exp_f32 v107, v107
    v_cvt_pk_bf16_f32 v40, v100, v101
    v_cvt_pk_bf16_f32 v41, v102, v103
    v_mfma_f32_32x32x16_bf16 v[60:75], v[28:31], v[36:39], v[60:75]
    s_waitcnt lgkmcnt(2)
    v_exp_f32 v76, v76
    v_exp_f32 v77, v77
    v_exp_f32 v78, v78
    v_exp_f32 v79, v79
    v_cvt_pk_bf16_f32 v42, v104, v105
    v_cvt_pk_bf16_f32 v43, v106, v107
    v_mfma_f32_32x32x16_bf16 v[92:107], v[120:123], v[8:11], 0
    ds_read_b128 v[28:31], v110 offset:34048
    v_exp_f32 v80, v80
    v_exp_f32 v81, v81
    v_exp_f32 v82, v82
    v_exp_f32 v83, v83
    v_cvt_pk_bf16_f32 v36, v76, v77
    v_cvt_pk_bf16_f32 v37, v78, v79
    v_mfma_f32_32x32x8bf16_1k v[92:107], v[26:27], v[18:19], v[92:107]
    v_exp_f32 v84, v84
    v_exp_f32 v85, v85
    v_exp_f32 v86, v86
    v_exp_f32 v87, v87
    v_cvt_pk_bf16_f32 v38, v80, v81
    v_cvt_pk_bf16_f32 v39, v82, v83
    v_mfma_f32_32x32x16_bf16 v[60:75], v[32:35], v[40:43], v[60:75]
    v_exp_f32 v88, v88
    v_exp_f32 v89, v89
    v_exp_f32 v90, v90
    v_exp_f32 v91, v91
    v_cvt_pk_bf16_f32 v40, v84, v85
    v_cvt_pk_bf16_f32 v41, v86, v87
    v_mfma_f32_32x32x16_bf16 v[44:59], v[124:127], v[36:39], v[44:59]
    s_waitcnt lgkmcnt(1)
    v_exp_f32 v92, v92
    v_exp_f32 v93, v93
    v_exp_f32 v94, v94
    v_exp_f32 v95, v95
    v_cvt_pk_bf16_f32 v42, v88, v89
    v_cvt_pk_bf16_f32 v43, v90, v91
    v_mfma_f32_32x32x16_bf16 v[76:91], v[20:23], v[4:7], 0
    ds_read_b128 v[120:123], v108 offset:29696
    v_exp_f32 v96, v96
    v_exp_f32 v97, v97
    v_exp_f32 v98, v98
    v_exp_f32 v99, v99
    v_cvt_pk_bf16_f32 v36, v92, v93
    v_cvt_pk_bf16_f32 v37, v94, v95
    v_mfma_f32_32x32x8bf16_1k v[76:91], v[132:133], v[12:13], v[76:91]
    v_exp_f32 v100, v100
    v_exp_f32 v101, v101
    v_exp_f32 v102, v102
    v_exp_f32 v103, v103
    v_cvt_pk_bf16_f32 v38, v96, v97
    v_cvt_pk_bf16_f32 v39, v98, v99
    v_mfma_f32_32x32x16_bf16 v[44:59], v[128:131], v[40:43], v[44:59]
    ds_read_b128 v[32:35], v110 offset:34656
    v_exp_f32 v104, v104
    v_exp_f32 v105, v105
    v_exp_f32 v106, v106
    v_exp_f32 v107, v107
    v_cvt_pk_bf16_f32 v40, v100, v101
    v_cvt_pk_bf16_f32 v41, v102, v103
    v_mfma_f32_32x32x16_bf16 v[60:75], v[124:127], v[36:39], v[60:75]
    s_waitcnt lgkmcnt(2)
    v_exp_f32 v76, v76
    v_exp_f32 v77, v77
    v_exp_f32 v78, v78
    v_exp_f32 v79, v79
    v_cvt_pk_bf16_f32 v42, v104, v105
    v_cvt_pk_bf16_f32 v43, v106, v107
    v_mfma_f32_32x32x16_bf16 v[92:107], v[20:23], v[8:11], 0
    ds_read_b128 v[124:127], v110 offset:35264
    v_exp_f32 v80, v80
    v_exp_f32 v81, v81
    v_exp_f32 v82, v82
    v_exp_f32 v83, v83
    v_cvt_pk_bf16_f32 v36, v76, v77
    v_cvt_pk_bf16_f32 v37, v78, v79
    v_mfma_f32_32x32x8bf16_1k v[92:107], v[132:133], v[16:17], v[92:107]
    v_exp_f32 v84, v84
    v_exp_f32 v85, v85
    v_exp_f32 v86, v86
    v_exp_f32 v87, v87
    v_cvt_pk_bf16_f32 v38, v80, v81
    v_cvt_pk_bf16_f32 v39, v82, v83
    v_mfma_f32_32x32x16_bf16 v[60:75], v[128:131], v[40:43], v[60:75]
    v_exp_f32 v88, v88
    v_exp_f32 v89, v89
    v_exp_f32 v90, v90
    v_exp_f32 v91, v91
    v_cvt_pk_bf16_f32 v40, v84, v85
    v_cvt_pk_bf16_f32 v41, v86, v87
    v_mfma_f32_32x32x16_bf16 v[44:59], v[28:31], v[36:39], v[44:59]
    s_waitcnt lgkmcnt(1)
    v_exp_f32 v92, v92
    v_exp_f32 v93, v93
    v_exp_f32 v94, v94
    v_exp_f32 v95, v95
    v_cvt_pk_bf16_f32 v42, v88, v89
    v_cvt_pk_bf16_f32 v43, v90, v91
    v_mfma_f32_32x32x16_bf16 v[76:91], v[120:123], v[4:7], 0
    ds_read_b128 v[20:23], v108 offset:30720
    v_exp_f32 v96, v96
    v_exp_f32 v97, v97
    v_exp_f32 v98, v98
    v_exp_f32 v99, v99
    v_cvt_pk_bf16_f32 v36, v92, v93
    v_cvt_pk_bf16_f32 v37, v94, v95
    v_mfma_f32_32x32x8bf16_1k v[76:91], v[132:133], v[14:15], v[76:91]
    v_exp_f32 v100, v100
    v_exp_f32 v101, v101
    v_exp_f32 v102, v102
    v_exp_f32 v103, v103
    v_cvt_pk_bf16_f32 v38, v96, v97
    v_cvt_pk_bf16_f32 v39, v98, v99
    v_mfma_f32_32x32x16_bf16 v[44:59], v[32:35], v[40:43], v[44:59]
    ds_read_b128 v[128:131], v110 offset:35872
    v_exp_f32 v104, v104
    v_exp_f32 v105, v105
    v_exp_f32 v106, v106
    v_exp_f32 v107, v107
    v_cvt_pk_bf16_f32 v40, v100, v101
    v_cvt_pk_bf16_f32 v41, v102, v103
    v_mfma_f32_32x32x16_bf16 v[60:75], v[28:31], v[36:39], v[60:75]
    s_waitcnt lgkmcnt(2)
    v_exp_f32 v76, v76
    v_exp_f32 v77, v77
    v_exp_f32 v78, v78
    v_exp_f32 v79, v79
    v_cvt_pk_bf16_f32 v42, v104, v105
    v_cvt_pk_bf16_f32 v43, v106, v107
    v_mfma_f32_32x32x16_bf16 v[92:107], v[120:123], v[8:11], 0
    ds_read_b128 v[28:31], v110 offset:36480
    v_exp_f32 v80, v80
    v_exp_f32 v81, v81
    v_exp_f32 v82, v82
    v_exp_f32 v83, v83
    v_cvt_pk_bf16_f32 v36, v76, v77
    v_cvt_pk_bf16_f32 v37, v78, v79
    v_mfma_f32_32x32x8bf16_1k v[92:107], v[132:133], v[18:19], v[92:107]
    v_exp_f32 v84, v84
    v_exp_f32 v85, v85
    v_exp_f32 v86, v86
    v_exp_f32 v87, v87
    v_cvt_pk_bf16_f32 v38, v80, v81
    v_cvt_pk_bf16_f32 v39, v82, v83
    v_mfma_f32_32x32x16_bf16 v[60:75], v[32:35], v[40:43], v[60:75]
    v_exp_f32 v88, v88
    v_exp_f32 v89, v89
    v_exp_f32 v90, v90
    v_exp_f32 v91, v91
    v_cvt_pk_bf16_f32 v40, v84, v85
    v_cvt_pk_bf16_f32 v41, v86, v87
    v_mfma_f32_32x32x16_bf16 v[44:59], v[124:127], v[36:39], v[44:59]
    s_waitcnt lgkmcnt(1)
    v_exp_f32 v92, v92
    v_exp_f32 v93, v93
    v_exp_f32 v94, v94
    v_exp_f32 v95, v95
    v_cvt_pk_bf16_f32 v42, v88, v89
    v_cvt_pk_bf16_f32 v43, v90, v91
    v_mfma_f32_32x32x16_bf16 v[76:91], v[20:23], v[4:7], 0
    ds_read_b128 v[120:123], v108 offset:31744
    v_exp_f32 v96, v96
    v_exp_f32 v97, v97
    v_exp_f32 v98, v98
    v_exp_f32 v99, v99
    v_cvt_pk_bf16_f32 v36, v92, v93
    v_cvt_pk_bf16_f32 v37, v94, v95
    v_mfma_f32_32x32x8bf16_1k v[76:91], v[134:135], v[12:13], v[76:91]
    v_exp_f32 v100, v100
    v_exp_f32 v101, v101
    v_exp_f32 v102, v102
    v_exp_f32 v103, v103
    v_cvt_pk_bf16_f32 v38, v96, v97
    v_cvt_pk_bf16_f32 v39, v98, v99
    v_mfma_f32_32x32x16_bf16 v[44:59], v[128:131], v[40:43], v[44:59]
    ds_read_b128 v[32:35], v110 offset:37088
    v_exp_f32 v104, v104
    v_exp_f32 v105, v105
    v_exp_f32 v106, v106
    v_exp_f32 v107, v107
    v_cvt_pk_bf16_f32 v40, v100, v101
    v_cvt_pk_bf16_f32 v41, v102, v103
    v_mfma_f32_32x32x16_bf16 v[60:75], v[124:127], v[36:39], v[60:75]
    s_waitcnt lgkmcnt(2)
    v_exp_f32 v76, v76
    v_exp_f32 v77, v77
    v_exp_f32 v78, v78
    v_exp_f32 v79, v79
    v_cvt_pk_bf16_f32 v42, v104, v105
    v_cvt_pk_bf16_f32 v43, v106, v107
    v_mfma_f32_32x32x16_bf16 v[92:107], v[20:23], v[8:11], 0
    ds_read_b128 v[124:127], v110 offset:37696
    v_exp_f32 v80, v80
    v_exp_f32 v81, v81
    v_exp_f32 v82, v82
    v_exp_f32 v83, v83
    v_cvt_pk_bf16_f32 v36, v76, v77
    v_cvt_pk_bf16_f32 v37, v78, v79
    v_mfma_f32_32x32x8bf16_1k v[92:107], v[134:135], v[16:17], v[92:107]
    v_exp_f32 v84, v84
    v_exp_f32 v85, v85
    v_exp_f32 v86, v86
    v_exp_f32 v87, v87
    v_cvt_pk_bf16_f32 v38, v80, v81
    v_cvt_pk_bf16_f32 v39, v82, v83
    v_mfma_f32_32x32x16_bf16 v[60:75], v[128:131], v[40:43], v[60:75]
    v_exp_f32 v88, v88
    v_exp_f32 v89, v89
    v_exp_f32 v90, v90
    v_exp_f32 v91, v91
    v_cvt_pk_bf16_f32 v40, v84, v85
    v_cvt_pk_bf16_f32 v41, v86, v87
    v_mfma_f32_32x32x16_bf16 v[44:59], v[28:31], v[36:39], v[44:59]
    s_waitcnt lgkmcnt(1)
    v_exp_f32 v92, v92
    v_exp_f32 v93, v93
    v_exp_f32 v94, v94
    v_exp_f32 v95, v95
    v_cvt_pk_bf16_f32 v42, v88, v89
    v_cvt_pk_bf16_f32 v43, v90, v91
    v_mfma_f32_32x32x16_bf16 v[76:91], v[120:123], v[4:7], 0
    ds_read_b128 v[128:131], v110 offset:38304
    v_exp_f32 v96, v96
    v_exp_f32 v97, v97
    v_exp_f32 v98, v98
    v_exp_f32 v99, v99
    v_cvt_pk_bf16_f32 v36, v92, v93
    v_cvt_pk_bf16_f32 v37, v94, v95
    v_mfma_f32_32x32x8bf16_1k v[76:91], v[134:135], v[14:15], v[76:91]
    v_exp_f32 v100, v100
    v_exp_f32 v101, v101
    v_exp_f32 v102, v102
    v_exp_f32 v103, v103
    v_cvt_pk_bf16_f32 v38, v96, v97
    v_cvt_pk_bf16_f32 v39, v98, v99
    v_mfma_f32_32x32x16_bf16 v[44:59], v[32:35], v[40:43], v[44:59]
    v_exp_f32 v104, v104
    v_exp_f32 v105, v105
    v_exp_f32 v106, v106
    v_exp_f32 v107, v107
    v_cvt_pk_bf16_f32 v40, v100, v101
    v_cvt_pk_bf16_f32 v41, v102, v103
    v_mfma_f32_32x32x16_bf16 v[60:75], v[28:31], v[36:39], v[60:75]
    s_waitcnt lgkmcnt(1)
    v_exp_f32 v76, v76
    v_exp_f32 v77, v77
    v_exp_f32 v78, v78
    v_exp_f32 v79, v79
    v_cvt_pk_bf16_f32 v42, v104, v105
    v_cvt_pk_bf16_f32 v43, v106, v107
    v_mfma_f32_32x32x16_bf16 v[92:107], v[120:123], v[8:11], 0
    v_exp_f32 v80, v80
    v_exp_f32 v81, v81
    v_exp_f32 v82, v82
    v_exp_f32 v83, v83
    v_cvt_pk_bf16_f32 v36, v76, v77
    v_cvt_pk_bf16_f32 v37, v78, v79
    v_mfma_f32_32x32x8bf16_1k v[92:107], v[134:135], v[18:19], v[92:107]
    v_exp_f32 v84, v84
    v_exp_f32 v85, v85
    v_exp_f32 v86, v86
    v_exp_f32 v87, v87
    v_cvt_pk_bf16_f32 v38, v80, v81
    v_cvt_pk_bf16_f32 v39, v82, v83
    v_mfma_f32_32x32x16_bf16 v[60:75], v[32:35], v[40:43], v[60:75]
    v_exp_f32 v88, v88
    v_exp_f32 v89, v89
    v_exp_f32 v90, v90
    v_exp_f32 v91, v91
    v_cvt_pk_bf16_f32 v40, v84, v85
    v_cvt_pk_bf16_f32 v41, v86, v87
    v_mfma_f32_32x32x16_bf16 v[44:59], v[124:127], v[36:39], v[44:59]
    s_waitcnt lgkmcnt(0)
    v_exp_f32 v92, v92
    v_exp_f32 v93, v93
    v_exp_f32 v94, v94
    v_exp_f32 v95, v95
    v_cvt_pk_bf16_f32 v42, v88, v89
    v_cvt_pk_bf16_f32 v43, v90, v91
    v_exp_f32 v96, v96
    v_exp_f32 v97, v97
    v_exp_f32 v98, v98
    v_exp_f32 v99, v99
    v_cvt_pk_bf16_f32 v36, v92, v93
    v_cvt_pk_bf16_f32 v37, v94, v95
    v_exp_f32 v100, v100
    v_exp_f32 v101, v101
    v_exp_f32 v102, v102
    v_exp_f32 v103, v103
    v_cvt_pk_bf16_f32 v38, v96, v97
    v_cvt_pk_bf16_f32 v39, v98, v99
    v_mfma_f32_32x32x16_bf16 v[44:59], v[128:131], v[40:43], v[44:59]
    v_exp_f32 v104, v104
    v_exp_f32 v105, v105
    v_exp_f32 v106, v106
    v_exp_f32 v107, v107
    v_cvt_pk_bf16_f32 v40, v100, v101
    v_cvt_pk_bf16_f32 v41, v102, v103
    v_mfma_f32_32x32x16_bf16 v[60:75], v[124:127], v[36:39], v[60:75]
    v_cvt_pk_bf16_f32 v42, v104, v105
    v_cvt_pk_bf16_f32 v43, v106, v107
    s_nop 1
    v_mfma_f32_32x32x16_bf16 v[60:75], v[128:131], v[40:43], v[60:75]
    s_mov_b32 s98, 0
    s_cmp_eq_u32 s28, 0
    s_cbranch_scc0 L_apa_wpre
    s_cmp_lt_u32 s2, 192
    s_cbranch_scc0 L_apa_wpre
    s_lshr_b32 s37, s2, 3
    s_mul_i32 s38, s37, 43
    s_lshr_b32 s38, s38, 8
    s_mul_i32 s38, s38, 6
    s_sub_u32 s37, s37, s38
    s_mul_i32 s37, s37, 110592
    s_add_u32 s37, s37, s15
    s_add_u32 s37, s37, 28311552
    s_and_b32 s38, s2, 7
    s_lshl_b32 s38, s38, 6
    s_add_u32 s38, s38, 23166976
    s_lshl_b32 s40, s99, 14
    s_add_u32 s38, s38, s40
    v_and_b32 v114, 31, v2
    v_lshlrev_b32 v114, 9, v114
    buffer_load_dword v115, v114, s[4:7], s38 offen
    s_waitcnt vmcnt(0)
    v_cmp_eq_u32 vcc, s97, v115
    s_nop 4
    s_cmp_eq_u64 vcc, -1
    s_cselect_b32 s98, 1, 0
    buffer_load_dwordx4 v[136:139], v3, s[4:7], s37 offen
    s_add_u32 s37, s37, 4096
    buffer_load_dwordx4 v[140:143], v3, s[4:7], s37 offen
    s_add_u32 s37, s37, 4096
    buffer_load_dwordx4 v[144:147], v3, s[4:7], s37 offen
    s_add_u32 s37, s37, 4096
    buffer_load_dwordx4 v[148:151], v3, s[4:7], s37 offen
    s_add_u32 s37, s37, 4096
    buffer_load_dwordx4 v[152:155], v3, s[4:7], s37 offen
    s_add_u32 s37, s37, 4096
    buffer_load_dwordx4 v[156:159], v3, s[4:7], s37 offen
    s_add_u32 s37, s37, 4096
    buffer_load_dwordx4 v[160:163], v3, s[4:7], s37 offen
    s_add_u32 s37, s37, 4096
    buffer_load_dwordx4 v[164:167], v3, s[4:7], s37 offen
    s_add_u32 s37, s37, 4096
    buffer_load_dwordx4 v[168:171], v3, s[4:7], s37 offen
    s_add_u32 s37, s37, 4096
    buffer_load_dwordx4 v[172:175], v3, s[4:7], s37 offen
    s_add_u32 s37, s37, 4096
    buffer_load_dwordx4 v[176:179], v3, s[4:7], s37 offen
    s_add_u32 s37, s37, 4096
    buffer_load_dwordx4 v[180:183], v3, s[4:7], s37 offen
    s_add_u32 s37, s37, 4096
    buffer_load_dwordx4 v[184:187], v3, s[4:7], s37 offen
    s_add_u32 s37, s37, 4096
    buffer_load_dwordx4 v[188:191], v3, s[4:7], s37 offen
    s_add_u32 s37, s37, 4096
    buffer_load_dwordx4 v[192:195], v3, s[4:7], s37 offen
    s_add_u32 s37, s37, 4096
    buffer_load_dwordx4 v[196:199], v3, s[4:7], s37 offen
    s_add_u32 s37, s37, 4096
    buffer_load_dwordx4 v[200:203], v3, s[4:7], s37 offen
    s_add_u32 s37, s37, 4096
    buffer_load_dwordx4 v[204:207], v3, s[4:7], s37 offen
    s_add_u32 s37, s37, 4096
    buffer_load_dwordx4 v[208:211], v3, s[4:7], s37 offen
    s_add_u32 s37, s37, 4096
    buffer_load_dwordx4 v[212:215], v3, s[4:7], s37 offen
    s_add_u32 s37, s37, 4096
    buffer_load_dwordx4 v[216:219], v3, s[4:7], s37 offen
    s_add_u32 s37, s37, 4096
    buffer_load_dwordx4 v[220:223], v3, s[4:7], s37 offen
    s_add_u32 s37, s37, 4096
    buffer_load_dwordx4 v[224:227], v3, s[4:7], s37 offen
    s_add_u32 s37, s37, 4096
    buffer_load_dwordx4 v[228:231], v3, s[4:7], s37 offen
    s_add_u32 s37, s37, 4096
    buffer_load_dwordx4 v[232:235], v3, s[4:7], s37 offen
    s_add_u32 s37, s37, 4096
    buffer_load_dwordx4 v[236:239], v3, s[4:7], s37 offen
    s_add_u32 s37, s37, 4096
    buffer_load_dwordx4 v[240:243], v3, s[4:7], s37 offen
L_apa_wpre:
    s_barrier
    s_mul_i32 s19, s10, 3072
    v_add_u32 v112, s19, v3
    s_xor_b32 s19, s10, 4
    s_mul_i32 s19, s19, 3072
    v_add_u32 v113, s19, v3
    s_add_u32 s11, s11, s28
    s_nop 6
    ds_write_b128 v112, v[60:63]
    ds_write_b128 v112, v[64:67] offset:1024
    ds_write_b128 v112, v[68:71] offset:2048
    s_waitcnt lgkmcnt(0)
    s_barrier
    ds_read_b128 v[76:79], v113
    ds_read_b128 v[80:83], v113 offset:1024
    ds_read_b128 v[84:87], v113 offset:2048
    s_waitcnt lgkmcnt(0)
    v_add_f32 v44, v44, v76
    v_add_f32 v45, v45, v77
    v_add_f32 v46, v46, v78
    v_add_f32 v47, v47, v79
    v_add_f32 v48, v48, v80
    v_add_f32 v49, v49, v81
    v_add_f32 v50, v50, v82
    v_add_f32 v51, v51, v83
    v_add_f32 v52, v52, v84
    v_add_f32 v53, v53, v85
    v_add_f32 v54, v54, v86
    v_mov_b32 v113, 0
    v_mov_b32 v112, v54
    s_mov_b32 s21, 0x1f800000
    s_mov_b32 s22, 0x5f800000
    v_permlane32_swap_b32 v112, v54
    v_fma_f32 v113, v44, 0, v113
    v_fma_f32 v113, v45, 0, v113
    v_fma_f32 v113, v46, 0, v113
    v_fma_f32 v113, v47, 0, v113
    v_fma_f32 v113, v48, 0, v113
    v_fma_f32 v113, v49, 0, v113
    v_fma_f32 v113, v50, 0, v113
    v_fma_f32 v113, v51, 0, v113
    v_fma_f32 v113, v52, 0, v113
    v_fma_f32 v113, v53, 0, v113
    v_cmp_nge_f32 s[24:25], v112, s21
    v_cmp_nle_f32 s[26:27], v112, s22
    v_cmp_u_f32 vcc, v113, v113
    s_nop 4
    s_or_b64 s[24:25], s[24:25], s[26:27]
    s_or_b64 s[24:25], s[24:25], vcc
    s_cmp_lg_u64 s[24:25], 0
    s_cbranch_scc1 L_apa_slow
L_apa_fin:
    v_rcp_f32 v113, v112
    s_nop 0
    v_mul_f32 v44, v44, v113
    v_mul_f32 v45, v45, v113
    v_mul_f32 v46, v46, v113
    v_mul_f32 v47, v47, v113
    v_mul_f32 v48, v48, v113
    v_mul_f32 v49, v49, v113
    v_mul_f32 v50, v50, v113
    v_mul_f32 v51, v51, v113
    v_mul_f32 v52, v52, v113
    v_mul_f32 v53, v53, v113
    v_cvt_pk_bf16_f32 v36, v44, v45
    v_cvt_pk_bf16_f32 v37, v46, v47
    v_cvt_pk_bf16_f32 v38, v48, v49
    v_cvt_pk_bf16_f32 v39, v50, v51
    v_cvt_pk_bf16_f32 v40, v52, v53
    buffer_store_dwordx4 v[36:39], v117, s[4:7], s52 offen sc0 sc1
    s_mov_b32 exec_hi, 0
    buffer_store_dword v40, v118, s[4:7], s53 offen sc0 sc1
    s_mov_b32 exec_hi, -1
    s_barrier
L_apa_end:
    s_cmp_ge_u32 s2, 192
    s_cbranch_scc1 L_ap_nop
    v_mov_b32 v60, 1
    v_mul_u32_u24 v61, 1024, v2
    s_waitcnt vmcnt(0)
    s_mov_b64 exec, 0x3f
    buffer_store_dword v60, v61, s[4:7], s50 offen sc0 sc1
    s_mov_b64 exec, -1
    s_load_dwordx2 s[12:13], s[0:1], 88
    s_load_dwordx2 s[16:17], s[0:1], 0
    s_load_dwordx2 s[18:19], s[0:1], 72
    s_and_b32 s8, s2, 7
    s_lshr_b32 s9, s2, 3
    s_mul_i32 s11, s9, 43
    s_lshr_b32 s11, s11, 8
    s_mul_i32 s14, s11, 6
    s_sub_u32 s9, s9, s14
    s_lshl_b32 s8, s8, 2
    s_or_b32 s8, s8, s11
    v_lshrrev_b32 v1, 6, v0
    v_and_b32 v2, 63, v0
    v_readfirstlane_b32 s10, v1
    v_lshlrev_b32 v7, 4, v2
    s_cmp_ge_u32 s10, 4
    s_cbranch_scc0 L_app_compute
    s_sub_u32 s28, s10, 4
    s_lshl_b32 s38, s28, 10
    s_mul_i32 s36, s9, 110592
    s_add_u32 s36, s36, s38
    s_add_u32 s36, s36, 28311552
    s_lshl_b32 s30, s8, 6
    s_waitcnt lgkmcnt(0)
    s_mov_b32 s4, s12
    s_and_b32 s5, s13, 0xffff
    s_mov_b32 s6, 0x10000000
    s_mov_b32 s7, 0x00020000
    s_mov_b32 s24, s16
    s_and_b32 s25, s17, 0xffff
    s_mov_b32 s26, 0x240000
    s_mov_b32 s27, 0x00020000
    s_cmp_eq_u32 s99, 0
    s_cbranch_scc0 L_app_rs1
    v_mul_u32_u24 v9, 1152, v2
    s_mul_i32 s33, s30, 1152
    s_mul_i32 s34, s9, 192
    s_add_u32 s33, s33, s34
    s_lshl_b32 s34, s28, 4
    s_add_u32 s33, s33, s34
    s_mov_b32 s35, 64
    s_branch L_app_rs2
L_app_rs1:
    v_mov_b32 v9, v7
    s_mul_i32 s33, s9, 12
    s_add_u32 s33, s33, s28
    s_mul_i32 s33, s33, 33024
    s_lshl_b32 s34, s30, 4
    s_add_u32 s33, s33, s34
    s_add_u32 s33, s33, 11534336
    s_mov_b32 s35, 132096
    s_mov_b32 s24, s4
    s_mov_b32 s25, s5
    s_mov_b32 s26, s6
L_app_rs2:
    s_add_u32 m0, s38, 110592
    s_nop 0
    buffer_load_dwordx4 v9, s[24:27], s33 offen lds
    s_add_u32 s33, s33, s35
    s_add_u32 m0, s38, 114688
    s_nop 0
    buffer_load_dwordx4 v9, s[24:27], s33 offen lds
    s_add_u32 s33, s33, s35
    s_add_u32 m0, s38, 118784
    s_nop 0
    buffer_load_dwordx4 v9, s[24:27], s33 offen lds
    s_add_u32 s33, s33, s35
    v_lshrrev_b32 v8, 4, v2
    v_mul_u32_u24 v8, 8448, v8
    v_and_b32 v9, 15, v2
    v_lshl_add_u32 v8, v9, 4, v8
    s_mul_i32 s34, s9, 48
    s_lshl_b32 s35, s28, 2
    s_add_u32 s34, s34, s35
    s_mul_i32 s34, s34, 8448
    s_lshl_b32 s35, s30, 2
    s_add_u32 s34, s34, s35
    s_add_u32 s34, s34, 14680064
    s_add_u32 m0, s38, 122880
    s_add_u32 s40, s34, 0
    buffer_load_dwordx4 v8, s[4:7], s40 offen lds
    s_add_u32 m0, s38, 126976
    s_add_u32 s40, s34, 135168
    buffer_load_dwordx4 v8, s[4:7], s40 offen lds
    s_add_u32 m0, s38, 131072
    s_add_u32 s40, s34, 270336
    buffer_load_dwordx4 v8, s[4:7], s40 offen lds
    s_cmp_eq_u32 s28, 0
    s_cbranch_scc0 L_app_fs
    s_mul_i32 s45, s8, 6
    s_add_u32 s45, s45, s9
    s_mul_i32 s45, s45, 1024
    s_add_u32 s45, s45, 22773760
    s_mul_i32 s46, s99, 196608
    s_add_u32 s45, s45, s46
    v_mul_u32_u24 v62, 16, v2
    s_mov_b32 s46, 0
L_app_fp:
    buffer_load_dword v63, v62, s[4:7], s45 offen sc0 sc1
    s_add_u32 s46, s46, 1
    s_waitcnt vmcnt(0)
    v_cmp_eq_u32 vcc, 1, v63
    s_nop 4
    s_cmp_eq_u64 vcc, -1
    s_cbranch_scc1 L_app_fs
    s_cmp_lt_u32 s46, 0x100000
    s_cbranch_scc1 L_app_fp
L_app_fs:
    s_waitcnt vmcnt(0)
    s_barrier
    s_barrier
    s_branch L_app_end
L_app_compute:
    s_lshl_b32 s31, s10, 10
    v_add_u32 v62, s31, v7
    v_add_u32 v63, 65536, v62
    ds_write_b128 v62, v[136:139] offset:0
    ds_write_b128 v62, v[140:143] offset:4096
    ds_write_b128 v62, v[144:147] offset:8192
    ds_write_b128 v62, v[148:151] offset:12288
    ds_write_b128 v62, v[152:155] offset:16384
    ds_write_b128 v62, v[156:159] offset:20480
    ds_write_b128 v62, v[160:163] offset:24576
    ds_write_b128 v62, v[164:167] offset:28672
    ds_write_b128 v62, v[168:171] offset:32768
    ds_write_b128 v62, v[172:175] offset:36864
    ds_write_b128 v62, v[176:179] offset:40960
    ds_write_b128 v62, v[180:183] offset:45056
    ds_write_b128 v62, v[184:187] offset:49152
    ds_write_b128 v62, v[188:191] offset:53248
    ds_write_b128 v62, v[192:195] offset:57344
    ds_write_b128 v62, v[196:199] offset:61440
    ds_write_b128 v63, v[200:203] offset:0
    ds_write_b128 v63, v[204:207] offset:4096
    ds_write_b128 v63, v[208:211] offset:8192
    ds_write_b128 v63, v[212:215] offset:12288
    ds_write_b128 v63, v[216:219] offset:16384
    ds_write_b128 v63, v[220:223] offset:20480
    ds_write_b128 v63, v[224:227] offset:24576
    ds_write_b128 v63, v[228:231] offset:28672
    ds_write_b128 v63, v[232:235] offset:32768
    ds_write_b128 v63, v[236:239] offset:36864
    ds_write_b128 v63, v[240:243] offset:40960
    s_waitcnt lgkmcnt(0)
    v_and_b32 v176, 15, v2
    v_lshrrev_b32 v177, 4, v2
    s_lshl_b32 s30, s8, 6
    s_lshl_b32 s31, s10, 4
    s_add_u32 s30, s30, s31
    v_mul_u32_u24 v178, 33024, v177
    v_lshl_add_u32 v178, v176, 4, v178
    s_lshl_b32 s31, s30, 4
    s_add_u32 s31, s31, 8388608
    s_waitcnt lgkmcnt(0)
    s_mov_b32 s4, s12
    s_and_b32 s5, s13, 0xffff
    s_mov_b32 s6, 0x10000000
    s_mov_b32 s7, 0x00020000
    s_mov_b32 s44, s31
    s_barrier
    buffer_load_dwordx4 v[8:11], v178, s[4:7], s44 offen sc1
    s_add_u32 s44, s44, 132096
    buffer_load_dwordx4 v[12:15], v178, s[4:7], s44 offen sc1
    s_add_u32 s44, s44, 132096
    buffer_load_dwordx4 v[16:19], v178, s[4:7], s44 offen sc1
    s_add_u32 s44, s44, 132096
    buffer_load_dwordx4 v[20:23], v178, s[4:7], s44 offen sc1
    s_add_u32 s44, s44, 132096
    buffer_load_dwordx4 v[24:27], v178, s[4:7], s44 offen sc1
    s_add_u32 s44, s44, 132096
    buffer_load_dwordx4 v[28:31], v178, s[4:7], s44 offen sc1
    s_add_u32 s44, s44, 132096
    buffer_load_dwordx4 v[32:35], v178, s[4:7], s44 offen sc1
    s_add_u32 s44, s44, 132096
    buffer_load_dwordx4 v[36:39], v178, s[4:7], s44 offen sc1
    s_add_u32 s44, s44, 132096
    buffer_load_dwordx4 v[40:43], v178, s[4:7], s44 offen sc1
    s_add_u32 s44, s44, 132096
    buffer_load_dwordx4 v[44:47], v178, s[4:7], s44 offen sc1
    s_add_u32 s44, s44, 132096
    buffer_load_dwordx4 v[48:51], v178, s[4:7], s44 offen sc1
    s_add_u32 s44, s44, 132096
    buffer_load_dwordx4 v[52:55], v178, s[4:7], s44 offen sc1
    s_add_u32 s44, s44, 132096
    buffer_load_dwordx4 v[56:59], v178, s[4:7], s44 offen sc1
    s_add_u32 s44, s44, 132096
    buffer_load_dwordx4 v[60:63], v178, s[4:7], s44 offen sc1
    s_add_u32 s44, s44, 132096
    buffer_load_dwordx4 v[64:67], v178, s[4:7], s44 offen sc1
    s_add_u32 s44, s44, 132096
    buffer_load_dwordx4 v[68:71], v178, s[4:7], s44 offen sc1
    s_add_u32 s44, s44, 132096
    buffer_load_dwordx4 v[72:75], v178, s[4:7], s44 offen sc1
    s_add_u32 s44, s44, 132096
    buffer_load_dwordx4 v[76:79], v178, s[4:7], s44 offen sc1
    s_add_u32 s44, s44, 132096
    v_mov_b32 v128, 0
    v_mov_b32 v129, 0
    v_mov_b32 v130, 0
    v_mov_b32 v131, 0
    v_mov_b32 v132, 0
    v_mov_b32 v133, 0
    v_mov_b32 v134, 0
    v_mov_b32 v135, 0
    v_mov_b32 v136, 0
    v_mov_b32 v137, 0
    v_mov_b32 v138, 0
    v_mov_b32 v139, 0
    v_mov_b32 v140, 0
    v_mov_b32 v141, 0
    v_mov_b32 v142, 0
    v_mov_b32 v143, 0
    v_mov_b32 v144, 0
    v_mov_b32 v145, 0
    v_mov_b32 v146, 0
    v_mov_b32 v147, 0
    v_mov_b32 v148, 0
    v_mov_b32 v149, 0
    v_mov_b32 v150, 0
    v_mov_b32 v151, 0
    v_add_u32 v182, 55296, v7
    v_lshrrev_b32 v179, 1, v177
    v_lshlrev_b32 v179, 10, v179
    v_lshl_add_u32 v179, v176, 4, v179
    v_and_b32 v180, 1, v177
    v_lshl_add_u32 v179, v180, 3, v179
    s_lshl_b32 s31, s10, 8
    s_add_u32 s31, s31, 110592
    v_add_u32 v179, s31, v179
    v_lshlrev_b32 v181, 9, v177
    v_lshl_add_u32 v181, v176, 2, v181
    s_lshl_b32 s31, s10, 6
    s_add_u32 s31, s31, 122880
    v_add_u32 v181, s31, v181
    ds_read_b128 v[80:83], v7 offset:0
    ds_read_b128 v[84:87], v7 offset:1024
    ds_read_b128 v[88:91], v7 offset:2048
    ds_read_b128 v[92:95], v7 offset:3072
    ds_read_b128 v[96:99], v7 offset:4096
    ds_read_b128 v[100:103], v7 offset:5120
    s_waitcnt vmcnt(17) lgkmcnt(0)
    v_mfma_f32_16x16x32_bf16 v[128:131], v[80:83], v[8:11], v[128:131]
    ds_read_b128 v[104:107], v7 offset:6144
    v_mfma_f32_16x16x32_bf16 v[132:135], v[84:87], v[8:11], v[132:135]
    ds_read_b128 v[108:111], v7 offset:7168
    v_mfma_f32_16x16x32_bf16 v[136:139], v[88:91], v[8:11], v[136:139]
    ds_read_b128 v[112:115], v7 offset:8192
    v_mfma_f32_16x16x32_bf16 v[140:143], v[92:95], v[8:11], v[140:143]
    ds_read_b128 v[116:119], v7 offset:9216
    v_mfma_f32_16x16x32_bf16 v[144:147], v[96:99], v[8:11], v[144:147]
    ds_read_b128 v[120:123], v7 offset:10240
    v_mfma_f32_16x16x32_bf16 v[148:151], v[100:103], v[8:11], v[148:151]
    ds_read_b128 v[124:127], v7 offset:11264
    s_waitcnt vmcnt(16) lgkmcnt(0)
    v_mfma_f32_16x16x32_bf16 v[128:131], v[104:107], v[12:15], v[128:131]
    ds_read_b128 v[80:83], v7 offset:12288
    v_mfma_f32_16x16x32_bf16 v[132:135], v[108:111], v[12:15], v[132:135]
    ds_read_b128 v[84:87], v7 offset:13312
    v_mfma_f32_16x16x32_bf16 v[136:139], v[112:115], v[12:15], v[136:139]
    ds_read_b128 v[88:91], v7 offset:14336
    v_mfma_f32_16x16x32_bf16 v[140:143], v[116:119], v[12:15], v[140:143]
    ds_read_b128 v[92:95], v7 offset:15360
    v_mfma_f32_16x16x32_bf16 v[144:147], v[120:123], v[12:15], v[144:147]
    ds_read_b128 v[96:99], v7 offset:16384
    v_mfma_f32_16x16x32_bf16 v[148:151], v[124:127], v[12:15], v[148:151]
    ds_read_b128 v[100:103], v7 offset:17408
    s_waitcnt vmcnt(15) lgkmcnt(0)
    v_mfma_f32_16x16x32_bf16 v[128:131], v[80:83], v[16:19], v[128:131]
    ds_read_b128 v[104:107], v7 offset:18432
    v_mfma_f32_16x16x32_bf16 v[132:135], v[84:87], v[16:19], v[132:135]
    ds_read_b128 v[108:111], v7 offset:19456
    v_mfma_f32_16x16x32_bf16 v[136:139], v[88:91], v[16:19], v[136:139]
    ds_read_b128 v[112:115], v7 offset:20480
    v_mfma_f32_16x16x32_bf16 v[140:143], v[92:95], v[16:19], v[140:143]
    ds_read_b128 v[116:119], v7 offset:21504
    v_mfma_f32_16x16x32_bf16 v[144:147], v[96:99], v[16:19], v[144:147]
    ds_read_b128 v[120:123], v7 offset:22528
    v_mfma_f32_16x16x32_bf16 v[148:151], v[100:103], v[16:19], v[148:151]
    ds_read_b128 v[124:127], v7 offset:23552
    s_waitcnt vmcnt(14) lgkmcnt(0)
    v_mfma_f32_16x16x32_bf16 v[128:131], v[104:107], v[20:23], v[128:131]
    ds_read_b128 v[80:83], v7 offset:24576
    v_mfma_f32_16x16x32_bf16 v[132:135], v[108:111], v[20:23], v[132:135]
    ds_read_b128 v[84:87], v7 offset:25600
    v_mfma_f32_16x16x32_bf16 v[136:139], v[112:115], v[20:23], v[136:139]
    ds_read_b128 v[88:91], v7 offset:26624
    v_mfma_f32_16x16x32_bf16 v[140:143], v[116:119], v[20:23], v[140:143]
    ds_read_b128 v[92:95], v7 offset:27648
    v_mfma_f32_16x16x32_bf16 v[144:147], v[120:123], v[20:23], v[144:147]
    ds_read_b128 v[96:99], v7 offset:28672
    v_mfma_f32_16x16x32_bf16 v[148:151], v[124:127], v[20:23], v[148:151]
    ds_read_b128 v[100:103], v7 offset:29696
    s_waitcnt vmcnt(13) lgkmcnt(0)
    v_mfma_f32_16x16x32_bf16 v[128:131], v[80:83], v[24:27], v[128:131]
    ds_read_b128 v[104:107], v7 offset:30720
    v_mfma_f32_16x16x32_bf16 v[132:135], v[84:87], v[24:27], v[132:135]
    ds_read_b128 v[108:111], v7 offset:31744
    v_mfma_f32_16x16x32_bf16 v[136:139], v[88:91], v[24:27], v[136:139]
    ds_read_b128 v[112:115], v7 offset:32768
    v_mfma_f32_16x16x32_bf16 v[140:143], v[92:95], v[24:27], v[140:143]
    ds_read_b128 v[116:119], v7 offset:33792
    v_mfma_f32_16x16x32_bf16 v[144:147], v[96:99], v[24:27], v[144:147]
    ds_read_b128 v[120:123], v7 offset:34816
    v_mfma_f32_16x16x32_bf16 v[148:151], v[100:103], v[24:27], v[148:151]
    ds_read_b128 v[124:127], v7 offset:35840
    s_waitcnt vmcnt(12) lgkmcnt(0)
    v_mfma_f32_16x16x32_bf16 v[128:131], v[104:107], v[28:31], v[128:131]
    ds_read_b128 v[80:83], v7 offset:36864
    v_mfma_f32_16x16x32_bf16 v[132:135], v[108:111], v[28:31], v[132:135]
    ds_read_b128 v[84:87], v7 offset:37888
    v_mfma_f32_16x16x32_bf16 v[136:139], v[112:115], v[28:31], v[136:139]
    ds_read_b128 v[88:91], v7 offset:38912
    v_mfma_f32_16x16x32_bf16 v[140:143], v[116:119], v[28:31], v[140:143]
    ds_read_b128 v[92:95], v7 offset:39936
    v_mfma_f32_16x16x32_bf16 v[144:147], v[120:123], v[28:31], v[144:147]
    ds_read_b128 v[96:99], v7 offset:40960
    v_mfma_f32_16x16x32_bf16 v[148:151], v[124:127], v[28:31], v[148:151]
    ds_read_b128 v[100:103], v7 offset:41984
    s_waitcnt vmcnt(11) lgkmcnt(0)
    v_mfma_f32_16x16x32_bf16 v[128:131], v[80:83], v[32:35], v[128:131]
    ds_read_b128 v[104:107], v7 offset:43008
    v_mfma_f32_16x16x32_bf16 v[132:135], v[84:87], v[32:35], v[132:135]
    ds_read_b128 v[108:111], v7 offset:44032
    v_mfma_f32_16x16x32_bf16 v[136:139], v[88:91], v[32:35], v[136:139]
    ds_read_b128 v[112:115], v7 offset:45056
    v_mfma_f32_16x16x32_bf16 v[140:143], v[92:95], v[32:35], v[140:143]
    ds_read_b128 v[116:119], v7 offset:46080
    v_mfma_f32_16x16x32_bf16 v[144:147], v[96:99], v[32:35], v[144:147]
    ds_read_b128 v[120:123], v7 offset:47104
    v_mfma_f32_16x16x32_bf16 v[148:151], v[100:103], v[32:35], v[148:151]
    ds_read_b128 v[124:127], v7 offset:48128
    s_waitcnt vmcnt(10) lgkmcnt(0)
    v_mfma_f32_16x16x32_bf16 v[128:131], v[104:107], v[36:39], v[128:131]
    ds_read_b128 v[80:83], v7 offset:49152
    v_mfma_f32_16x16x32_bf16 v[132:135], v[108:111], v[36:39], v[132:135]
    ds_read_b128 v[84:87], v7 offset:50176
    v_mfma_f32_16x16x32_bf16 v[136:139], v[112:115], v[36:39], v[136:139]
    ds_read_b128 v[88:91], v7 offset:51200
    v_mfma_f32_16x16x32_bf16 v[140:143], v[116:119], v[36:39], v[140:143]
    ds_read_b128 v[92:95], v7 offset:52224
    v_mfma_f32_16x16x32_bf16 v[144:147], v[120:123], v[36:39], v[144:147]
    ds_read_b128 v[96:99], v7 offset:53248
    v_mfma_f32_16x16x32_bf16 v[148:151], v[124:127], v[36:39], v[148:151]
    ds_read_b128 v[100:103], v7 offset:54272
    s_waitcnt vmcnt(9) lgkmcnt(0)
    v_mfma_f32_16x16x32_bf16 v[128:131], v[80:83], v[40:43], v[128:131]
    ds_read_b128 v[104:107], v182 offset:0
    v_mfma_f32_16x16x32_bf16 v[132:135], v[84:87], v[40:43], v[132:135]
    ds_read_b128 v[108:111], v182 offset:1024
    v_mfma_f32_16x16x32_bf16 v[136:139], v[88:91], v[40:43], v[136:139]
    ds_read_b128 v[112:115], v182 offset:2048
    v_mfma_f32_16x16x32_bf16 v[140:143], v[92:95], v[40:43], v[140:143]
    ds_read_b128 v[116:119], v182 offset:3072
    v_mfma_f32_16x16x32_bf16 v[144:147], v[96:99], v[40:43], v[144:147]
    ds_read_b128 v[120:123], v182 offset:4096
    v_mfma_f32_16x16x32_bf16 v[148:151], v[100:103], v[40:43], v[148:151]
    ds_read_b128 v[124:127], v182 offset:5120
    s_waitcnt vmcnt(8) lgkmcnt(0)
    v_mfma_f32_16x16x32_bf16 v[128:131], v[104:107], v[44:47], v[128:131]
    ds_read_b128 v[80:83], v182 offset:6144
    v_mfma_f32_16x16x32_bf16 v[132:135], v[108:111], v[44:47], v[132:135]
    ds_read_b128 v[84:87], v182 offset:7168
    v_mfma_f32_16x16x32_bf16 v[136:139], v[112:115], v[44:47], v[136:139]
    ds_read_b128 v[88:91], v182 offset:8192
    v_mfma_f32_16x16x32_bf16 v[140:143], v[116:119], v[44:47], v[140:143]
    ds_read_b128 v[92:95], v182 offset:9216
    v_mfma_f32_16x16x32_bf16 v[144:147], v[120:123], v[44:47], v[144:147]
    ds_read_b128 v[96:99], v182 offset:10240
    v_mfma_f32_16x16x32_bf16 v[148:151], v[124:127], v[44:47], v[148:151]
    ds_read_b128 v[100:103], v182 offset:11264
    s_waitcnt vmcnt(7) lgkmcnt(0)
    v_mfma_f32_16x16x32_bf16 v[128:131], v[80:83], v[48:51], v[128:131]
    ds_read_b128 v[104:107], v182 offset:12288
    v_mfma_f32_16x16x32_bf16 v[132:135], v[84:87], v[48:51], v[132:135]
    ds_read_b128 v[108:111], v182 offset:13312
    v_mfma_f32_16x16x32_bf16 v[136:139], v[88:91], v[48:51], v[136:139]
    ds_read_b128 v[112:115], v182 offset:14336
    v_mfma_f32_16x16x32_bf16 v[140:143], v[92:95], v[48:51], v[140:143]
    ds_read_b128 v[116:119], v182 offset:15360
    v_mfma_f32_16x16x32_bf16 v[144:147], v[96:99], v[48:51], v[144:147]
    ds_read_b128 v[120:123], v182 offset:16384
    v_mfma_f32_16x16x32_bf16 v[148:151], v[100:103], v[48:51], v[148:151]
    ds_read_b128 v[124:127], v182 offset:17408
    s_waitcnt vmcnt(6) lgkmcnt(0)
    v_mfma_f32_16x16x32_bf16 v[128:131], v[104:107], v[52:55], v[128:131]
    ds_read_b128 v[80:83], v182 offset:18432
    v_mfma_f32_16x16x32_bf16 v[132:135], v[108:111], v[52:55], v[132:135]
    ds_read_b128 v[84:87], v182 offset:19456
    v_mfma_f32_16x16x32_bf16 v[136:139], v[112:115], v[52:55], v[136:139]
    ds_read_b128 v[88:91], v182 offset:20480
    v_mfma_f32_16x16x32_bf16 v[140:143], v[116:119], v[52:55], v[140:143]
    ds_read_b128 v[92:95], v182 offset:21504
    v_mfma_f32_16x16x32_bf16 v[144:147], v[120:123], v[52:55], v[144:147]
    ds_read_b128 v[96:99], v182 offset:22528
    v_mfma_f32_16x16x32_bf16 v[148:151], v[124:127], v[52:55], v[148:151]
    ds_read_b128 v[100:103], v182 offset:23552
    s_waitcnt vmcnt(5) lgkmcnt(0)
    v_mfma_f32_16x16x32_bf16 v[128:131], v[80:83], v[56:59], v[128:131]
    ds_read_b128 v[104:107], v182 offset:24576
    v_mfma_f32_16x16x32_bf16 v[132:135], v[84:87], v[56:59], v[132:135]
    ds_read_b128 v[108:111], v182 offset:25600
    v_mfma_f32_16x16x32_bf16 v[136:139], v[88:91], v[56:59], v[136:139]
    ds_read_b128 v[112:115], v182 offset:26624
    v_mfma_f32_16x16x32_bf16 v[140:143], v[92:95], v[56:59], v[140:143]
    ds_read_b128 v[116:119], v182 offset:27648
    v_mfma_f32_16x16x32_bf16 v[144:147], v[96:99], v[56:59], v[144:147]
    ds_read_b128 v[120:123], v182 offset:28672
    v_mfma_f32_16x16x32_bf16 v[148:151], v[100:103], v[56:59], v[148:151]
    ds_read_b128 v[124:127], v182 offset:29696
    s_waitcnt vmcnt(4) lgkmcnt(0)
    v_mfma_f32_16x16x32_bf16 v[128:131], v[104:107], v[60:63], v[128:131]
    ds_read_b128 v[80:83], v182 offset:30720
    v_mfma_f32_16x16x32_bf16 v[132:135], v[108:111], v[60:63], v[132:135]
    ds_read_b128 v[84:87], v182 offset:31744
    v_mfma_f32_16x16x32_bf16 v[136:139], v[112:115], v[60:63], v[136:139]
    ds_read_b128 v[88:91], v182 offset:32768
    v_mfma_f32_16x16x32_bf16 v[140:143], v[116:119], v[60:63], v[140:143]
    ds_read_b128 v[92:95], v182 offset:33792
    v_mfma_f32_16x16x32_bf16 v[144:147], v[120:123], v[60:63], v[144:147]
    ds_read_b128 v[96:99], v182 offset:34816
    v_mfma_f32_16x16x32_bf16 v[148:151], v[124:127], v[60:63], v[148:151]
    ds_read_b128 v[100:103], v182 offset:35840
    s_waitcnt vmcnt(3) lgkmcnt(0)
    v_mfma_f32_16x16x32_bf16 v[128:131], v[80:83], v[64:67], v[128:131]
    ds_read_b128 v[104:107], v182 offset:36864
    v_mfma_f32_16x16x32_bf16 v[132:135], v[84:87], v[64:67], v[132:135]
    ds_read_b128 v[108:111], v182 offset:37888
    v_mfma_f32_16x16x32_bf16 v[136:139], v[88:91], v[64:67], v[136:139]
    ds_read_b128 v[112:115], v182 offset:38912
    v_mfma_f32_16x16x32_bf16 v[140:143], v[92:95], v[64:67], v[140:143]
    ds_read_b128 v[116:119], v182 offset:39936
    v_mfma_f32_16x16x32_bf16 v[144:147], v[96:99], v[64:67], v[144:147]
    ds_read_b128 v[120:123], v182 offset:40960
    v_mfma_f32_16x16x32_bf16 v[148:151], v[100:103], v[64:67], v[148:151]
    ds_read_b128 v[124:127], v182 offset:41984
    s_waitcnt vmcnt(2) lgkmcnt(0)
    v_mfma_f32_16x16x32_bf16 v[128:131], v[104:107], v[68:71], v[128:131]
    ds_read_b128 v[80:83], v182 offset:43008
    v_mfma_f32_16x16x32_bf16 v[132:135], v[108:111], v[68:71], v[132:135]
    ds_read_b128 v[84:87], v182 offset:44032
    v_mfma_f32_16x16x32_bf16 v[136:139], v[112:115], v[68:71], v[136:139]
    ds_read_b128 v[88:91], v182 offset:45056
    v_mfma_f32_16x16x32_bf16 v[140:143], v[116:119], v[68:71], v[140:143]
    ds_read_b128 v[92:95], v182 offset:46080
    v_mfma_f32_16x16x32_bf16 v[144:147], v[120:123], v[68:71], v[144:147]
    ds_read_b128 v[96:99], v182 offset:47104
    v_mfma_f32_16x16x32_bf16 v[148:151], v[124:127], v[68:71], v[148:151]
    ds_read_b128 v[100:103], v182 offset:48128
    s_waitcnt vmcnt(1) lgkmcnt(0)
    v_mfma_f32_16x16x32_bf16 v[128:131], v[80:83], v[72:75], v[128:131]
    ds_read_b128 v[104:107], v182 offset:49152
    v_mfma_f32_16x16x32_bf16 v[132:135], v[84:87], v[72:75], v[132:135]
    ds_read_b128 v[108:111], v182 offset:50176
    v_mfma_f32_16x16x32_bf16 v[136:139], v[88:91], v[72:75], v[136:139]
    ds_read_b128 v[112:115], v182 offset:51200
    v_mfma_f32_16x16x32_bf16 v[140:143], v[92:95], v[72:75], v[140:143]
    ds_read_b128 v[116:119], v182 offset:52224
    v_mfma_f32_16x16x32_bf16 v[144:147], v[96:99], v[72:75], v[144:147]
    ds_read_b128 v[120:123], v182 offset:53248
    v_mfma_f32_16x16x32_bf16 v[148:151], v[100:103], v[72:75], v[148:151]
    ds_read_b128 v[124:127], v182 offset:54272
    s_waitcnt vmcnt(0) lgkmcnt(0)
    v_mfma_f32_16x16x32_bf16 v[128:131], v[104:107], v[76:79], v[128:131]
    ds_read_b64 v[152:153], v179 offset:0
    ds_read_b64 v[154:155], v179 offset:2048
    v_mfma_f32_16x16x32_bf16 v[132:135], v[108:111], v[76:79], v[132:135]
    ds_read_b64 v[156:157], v179 offset:4096
    ds_read_b64 v[158:159], v179 offset:6144
    v_mfma_f32_16x16x32_bf16 v[136:139], v[112:115], v[76:79], v[136:139]
    ds_read_b64 v[160:161], v179 offset:8192
    ds_read_b64 v[162:163], v179 offset:10240
    v_mfma_f32_16x16x32_bf16 v[140:143], v[116:119], v[76:79], v[140:143]
    ds_read2st64_b32 v[164:165], v181 offset0:0 offset1:1
    ds_read2st64_b32 v[166:167], v181 offset0:8 offset1:9
    v_mfma_f32_16x16x32_bf16 v[144:147], v[120:123], v[76:79], v[144:147]
    ds_read2st64_b32 v[168:169], v181 offset0:16 offset1:17
    ds_read2st64_b32 v[170:171], v181 offset0:24 offset1:25
    v_mfma_f32_16x16x32_bf16 v[148:151], v[124:127], v[76:79], v[148:151]
    ds_read2st64_b32 v[172:173], v181 offset0:32 offset1:33
    ds_read2st64_b32 v[174:175], v181 offset0:40 offset1:41
    s_waitcnt lgkmcnt(0)
    s_barrier
    v_lshlrev_b32 v8, 16, v152
    v_and_b32 v9, 0xffff0000, v152
    v_lshlrev_b32 v10, 16, v153
    v_and_b32 v11, 0xffff0000, v153
    v_lshlrev_b32 v12, 16, v154
    v_and_b32 v13, 0xffff0000, v154
    v_lshlrev_b32 v14, 16, v155
    v_and_b32 v15, 0xffff0000, v155
    v_lshlrev_b32 v16, 16, v156
    v_and_b32 v17, 0xffff0000, v156
    v_lshlrev_b32 v18, 16, v157
    v_and_b32 v19, 0xffff0000, v157
    v_lshlrev_b32 v20, 16, v158
    v_and_b32 v21, 0xffff0000, v158
    v_lshlrev_b32 v22, 16, v159
    v_and_b32 v23, 0xffff0000, v159
    v_lshlrev_b32 v24, 16, v160
    v_and_b32 v25, 0xffff0000, v160
    v_lshlrev_b32 v26, 16, v161
    v_and_b32 v27, 0xffff0000, v161
    v_lshlrev_b32 v28, 16, v162
    v_and_b32 v29, 0xffff0000, v162
    v_lshlrev_b32 v30, 16, v163
    v_and_b32 v31, 0xffff0000, v163
    v_pk_add_f32 v[8:9], v[8:9], v[128:129]
    v_pk_add_f32 v[10:11], v[10:11], v[130:131]
    v_pk_add_f32 v[12:13], v[12:13], v[132:133]
    v_pk_add_f32 v[14:15], v[14:15], v[134:135]
    v_pk_add_f32 v[16:17], v[16:17], v[136:137]
    v_pk_add_f32 v[18:19], v[18:19], v[138:139]
    v_pk_add_f32 v[20:21], v[20:21], v[140:141]
    v_pk_add_f32 v[22:23], v[22:23], v[142:143]
    v_pk_add_f32 v[24:25], v[24:25], v[144:145]
    v_pk_add_f32 v[26:27], v[26:27], v[146:147]
    v_pk_add_f32 v[28:29], v[28:29], v[148:149]
    v_pk_add_f32 v[30:31], v[30:31], v[150:151]
    v_pk_add_f32 v[32:33], v[8:9], v[10:11]
    v_pk_mul_f32 v[34:35], v[8:9], v[8:9]
    v_pk_fma_f32 v[34:35], v[10:11], v[10:11], v[34:35]
    v_pk_add_f32 v[32:33], v[32:33], v[12:13]
    v_pk_fma_f32 v[34:35], v[12:13], v[12:13], v[34:35]
    v_pk_add_f32 v[32:33], v[32:33], v[14:15]
    v_pk_fma_f32 v[34:35], v[14:15], v[14:15], v[34:35]
    v_pk_add_f32 v[32:33], v[32:33], v[16:17]
    v_pk_fma_f32 v[34:35], v[16:17], v[16:17], v[34:35]
    v_pk_add_f32 v[32:33], v[32:33], v[18:19]
    v_pk_fma_f32 v[34:35], v[18:19], v[18:19], v[34:35]
    v_pk_add_f32 v[32:33], v[32:33], v[20:21]
    v_pk_fma_f32 v[34:35], v[20:21], v[20:21], v[34:35]
    v_pk_add_f32 v[32:33], v[32:33], v[22:23]
    v_pk_fma_f32 v[34:35], v[22:23], v[22:23], v[34:35]
    v_pk_add_f32 v[32:33], v[32:33], v[24:25]
    v_pk_fma_f32 v[34:35], v[24:25], v[24:25], v[34:35]
    v_pk_add_f32 v[32:33], v[32:33], v[26:27]
    v_pk_fma_f32 v[34:35], v[26:27], v[26:27], v[34:35]
    v_pk_add_f32 v[32:33], v[32:33], v[28:29]
    v_pk_fma_f32 v[34:35], v[28:29], v[28:29], v[34:35]
    v_pk_add_f32 v[32:33], v[32:33], v[30:31]
    v_pk_fma_f32 v[34:35], v[30:31], v[30:31], v[34:35]
    v_add_f32 v184, v32, v33
    v_add_f32 v185, v34, v35
    v_mov_b32 v186, v184
    v_mov_b32 v187, v185
    s_nop 1
    v_permlane32_swap_b32 v186, v184
    v_permlane32_swap_b32 v187, v185
    s_nop 1
    v_add_f32 v184, v184, v186
    v_add_f32 v185, v185, v187
    v_mov_b32 v186, v184
    v_mov_b32 v187, v185
    s_nop 1
    v_permlane16_swap_b32 v186, v184
    v_permlane16_swap_b32 v187, v185
    s_nop 1
    v_add_f32 v184, v184, v186
    v_add_f32 v185, v185, v187
    v_or_b32 v185, 0x80000000, v185
    v_mul_u32_u24 v188, 48, v176
    s_mul_i32 s35, s30, 48
    s_add_u32 s35, s35, 22020096
    s_mul_i32 s36, s99, 98304
    s_add_u32 s35, s35, s36
    s_lshl_b32 s36, s9, 3
    s_add_u32 s36, s36, s35
    s_mov_b64 exec, 0xffff
    s_cmp_eq_u32 s98, 1
    s_cbranch_scc0 L_app_dw1
    buffer_store_dwordx2 v[184:185], v188, s[4:7], s36 offen
    s_branch L_app_dj1
L_app_dw1:
    buffer_store_dwordx2 v[184:185], v188, s[4:7], s36 offen sc0 sc1
L_app_dj1:
    s_mov_b64 exec, -1
    v_lshl_add_u32 v189, v177, 3, v188
    v_and_b32 v190, 1, v177
    v_lshl_add_u32 v190, v190, 3, v188
    v_lshlrev_b32 v128, 16, v164
    v_and_b32 v129, 0xffff0000, v164
    v_lshlrev_b32 v130, 16, v165
    v_and_b32 v131, 0xffff0000, v165
    v_lshlrev_b32 v132, 16, v166
    v_and_b32 v133, 0xffff0000, v166
    v_lshlrev_b32 v134, 16, v167
    v_and_b32 v135, 0xffff0000, v167
    v_lshlrev_b32 v136, 16, v168
    v_and_b32 v137, 0xffff0000, v168
    v_lshlrev_b32 v138, 16, v169
    v_and_b32 v139, 0xffff0000, v169
    v_lshlrev_b32 v140, 16, v170
    v_and_b32 v141, 0xffff0000, v170
    v_lshlrev_b32 v142, 16, v171
    v_and_b32 v143, 0xffff0000, v171
    v_lshlrev_b32 v144, 16, v172
    v_and_b32 v145, 0xffff0000, v172
    v_lshlrev_b32 v146, 16, v173
    v_and_b32 v147, 0xffff0000, v173
    v_lshlrev_b32 v148, 16, v174
    v_and_b32 v149, 0xffff0000, v174
    v_lshlrev_b32 v150, 16, v175
    v_and_b32 v151, 0xffff0000, v175
    s_mov_b32 s37, 0
L_app_poll:
    buffer_load_dwordx2 v[192:193], v189, s[4:7], s35 offen sc1
    buffer_load_dwordx2 v[194:195], v190, s[4:7], s35 offen offset:32 sc1
    s_add_u32 s37, s37, 1
    s_waitcnt vmcnt(0)
    v_and_b32 v191, v193, v195
    v_cmp_gt_i32 vcc, 0, v191
    s_nop 4
    s_cmp_eq_u64 vcc, -1
    s_cbranch_scc1 L_app_got
    s_cmp_lt_u32 s37, 0x100000
    s_cbranch_scc1 L_app_poll
L_app_got:
    v_and_b32 v193, 0x7fffffff, v193
    v_and_b32 v195, 0x7fffffff, v195
    v_cmp_gt_u32 vcc, 2, v177
    s_nop 1
    v_cndmask_b32 v194, 0, v194, vcc
    v_cndmask_b32 v195, 0, v195, vcc
    v_add_f32 v184, v192, v194
    v_add_f32 v185, v193, v195
    v_mov_b32 v186, v184
    v_mov_b32 v187, v185
    s_nop 1
    v_permlane32_swap_b32 v186, v184
    v_permlane32_swap_b32 v187, v185
    s_nop 1
    v_add_f32 v184, v184, v186
    v_add_f32 v185, v185, v187
    v_mov_b32 v186, v184
    v_mov_b32 v187, v185
    s_nop 1
    v_permlane16_swap_b32 v186, v184
    v_permlane16_swap_b32 v187, v185
    s_nop 1
    v_add_f32 v184, v184, v186
    v_add_f32 v185, v185, v187
    s_mov_b32 s43, 0x3ae38e39
    v_mul_f32 v184, s43, v184
    v_mul_f32 v185, s43, v185
    v_fma_f32 v185, -v184, v184, v185
    v_max_f32 v185, 0, v185
    v_add_f32 v185, 0x3727c5ac, v185
    v_rsq_f32 v185, v185
    v_sub_f32 v192, 0, v184
    v_mov_b32 v194, v185
    v_mov_b32 v195, v185
    v_mov_b32 v193, v192
    v_pk_add_f32 v[32:33], v[8:9], v[192:193]
    v_pk_add_f32 v[34:35], v[10:11], v[192:193]
    v_pk_add_f32 v[36:37], v[12:13], v[192:193]
    v_pk_add_f32 v[38:39], v[14:15], v[192:193]
    v_pk_add_f32 v[40:41], v[16:17], v[192:193]
    v_pk_add_f32 v[42:43], v[18:19], v[192:193]
    v_pk_add_f32 v[44:45], v[20:21], v[192:193]
    v_pk_add_f32 v[46:47], v[22:23], v[192:193]
    v_pk_add_f32 v[48:49], v[24:25], v[192:193]
    v_pk_add_f32 v[50:51], v[26:27], v[192:193]
    v_pk_add_f32 v[52:53], v[28:29], v[192:193]
    v_pk_add_f32 v[54:55], v[30:31], v[192:193]
    v_pk_mul_f32 v[32:33], v[32:33], v[194:195]
    v_pk_mul_f32 v[34:35], v[34:35], v[194:195]
    v_pk_mul_f32 v[36:37], v[36:37], v[194:195]
    v_pk_mul_f32 v[38:39], v[38:39], v[194:195]
    v_pk_mul_f32 v[40:41], v[40:41], v[194:195]
    v_pk_mul_f32 v[42:43], v[42:43], v[194:195]
    v_pk_mul_f32 v[44:45], v[44:45], v[194:195]
    v_pk_mul_f32 v[46:47], v[46:47], v[194:195]
    v_pk_mul_f32 v[48:49], v[48:49], v[194:195]
    v_pk_mul_f32 v[50:51], v[50:51], v[194:195]
    v_pk_mul_f32 v[52:53], v[52:53], v[194:195]
    v_pk_mul_f32 v[54:55], v[54:55], v[194:195]
    v_pk_fma_f32 v[8:9], v[32:33], v[128:129], v[8:9]
    v_pk_fma_f32 v[10:11], v[34:35], v[130:131], v[10:11]
    v_pk_fma_f32 v[12:13], v[36:37], v[132:133], v[12:13]
    v_pk_fma_f32 v[14:15], v[38:39], v[134:135], v[14:15]
    v_pk_fma_f32 v[16:17], v[40:41], v[136:137], v[16:17]
    v_pk_fma_f32 v[18:19], v[42:43], v[138:139], v[18:19]
    v_pk_fma_f32 v[20:21], v[44:45], v[140:141], v[20:21]
    v_pk_fma_f32 v[22:23], v[46:47], v[142:143], v[22:23]
    v_pk_fma_f32 v[24:25], v[48:49], v[144:145], v[24:25]
    v_pk_fma_f32 v[26:27], v[50:51], v[146:147], v[26:27]
    v_pk_fma_f32 v[28:29], v[52:53], v[148:149], v[28:29]
    v_pk_fma_f32 v[30:31], v[54:55], v[150:151], v[30:31]
    v_cvt_pk_bf16_f32 v56, v8, v9
    v_cvt_pk_bf16_f32 v57, v10, v11
    v_cvt_pk_bf16_f32 v58, v12, v13
    v_cvt_pk_bf16_f32 v59, v14, v15
    v_cvt_pk_bf16_f32 v60, v16, v17
    v_cvt_pk_bf16_f32 v61, v18, v19
    v_cvt_pk_bf16_f32 v62, v20, v21
    v_cvt_pk_bf16_f32 v63, v22, v23
    v_cvt_pk_bf16_f32 v64, v24, v25
    v_cvt_pk_bf16_f32 v65, v26, v27
    v_cvt_pk_bf16_f32 v66, v28, v29
    v_cvt_pk_bf16_f32 v67, v30, v31
    s_cmp_eq_u32 s99, 0
    s_cbranch_scc0 L_app_e1
    v_lshrrev_b32 v180, 1, v177
    v_mul_u32_u24 v180, 33024, v180
    v_lshl_add_u32 v180, v176, 4, v180
    v_and_b32 v179, 1, v177
    v_lshl_add_u32 v180, v179, 3, v180
    s_mul_i32 s33, s9, 396288
    s_lshl_b32 s34, s30, 4
    s_add_u32 s33, s33, s34
    s_add_u32 s33, s33, 11534336
    s_cmp_eq_u32 s98, 1
    s_cbranch_scc0 L_app_dw2
    s_mov_b32 s34, s33
    buffer_store_dwordx2 v[56:57], v180, s[4:7], s34 offen
    s_add_u32 s34, s34, 66048
    buffer_store_dwordx2 v[58:59], v180, s[4:7], s34 offen
    s_add_u32 s34, s34, 66048
    buffer_store_dwordx2 v[60:61], v180, s[4:7], s34 offen
    s_add_u32 s34, s34, 66048
    buffer_store_dwordx2 v[62:63], v180, s[4:7], s34 offen
    s_add_u32 s34, s34, 66048
    buffer_store_dwordx2 v[64:65], v180, s[4:7], s34 offen
    s_add_u32 s34, s34, 66048
    buffer_store_dwordx2 v[66:67], v180, s[4:7], s34 offen
    s_branch L_app_dj2
L_app_dw2:
    s_mov_b32 s34, s33
    buffer_store_dwordx2 v[56:57], v180, s[4:7], s34 offen sc0 sc1
    s_add_u32 s34, s34, 66048
    buffer_store_dwordx2 v[58:59], v180, s[4:7], s34 offen sc0 sc1
    s_add_u32 s34, s34, 66048
    buffer_store_dwordx2 v[60:61], v180, s[4:7], s34 offen sc0 sc1
    s_add_u32 s34, s34, 66048
    buffer_store_dwordx2 v[62:63], v180, s[4:7], s34 offen sc0 sc1
    s_add_u32 s34, s34, 66048
    buffer_store_dwordx2 v[64:65], v180, s[4:7], s34 offen sc0 sc1
    s_add_u32 s34, s34, 66048
    buffer_store_dwordx2 v[66:67], v180, s[4:7], s34 offen sc0 sc1
L_app_dj2:
    v_lshlrev_b32 v8, 16, v56
    v_and_b32 v9, 0xffff0000, v56
    v_lshlrev_b32 v10, 16, v57
    v_and_b32 v11, 0xffff0000, v57
    v_lshlrev_b32 v12, 16, v58
    v_and_b32 v13, 0xffff0000, v58
    v_lshlrev_b32 v14, 16, v59
    v_and_b32 v15, 0xffff0000, v59
    v_lshlrev_b32 v16, 16, v60
    v_and_b32 v17, 0xffff0000, v60
    v_lshlrev_b32 v18, 16, v61
    v_and_b32 v19, 0xffff0000, v61
    v_lshlrev_b32 v20, 16, v62
    v_and_b32 v21, 0xffff0000, v62
    v_lshlrev_b32 v22, 16, v63
    v_and_b32 v23, 0xffff0000, v63
    v_lshlrev_b32 v24, 16, v64
    v_and_b32 v25, 0xffff0000, v64
    v_lshlrev_b32 v26, 16, v65
    v_and_b32 v27, 0xffff0000, v65
    v_lshlrev_b32 v28, 16, v66
    v_and_b32 v29, 0xffff0000, v66
    v_lshlrev_b32 v30, 16, v67
    v_and_b32 v31, 0xffff0000, v67
    v_pk_add_f32 v[32:33], v[8:9], v[10:11]
    v_pk_mul_f32 v[34:35], v[8:9], v[8:9]
    v_pk_fma_f32 v[34:35], v[10:11], v[10:11], v[34:35]
    v_pk_add_f32 v[32:33], v[32:33], v[12:13]
    v_pk_fma_f32 v[34:35], v[12:13], v[12:13], v[34:35]
    v_pk_add_f32 v[32:33], v[32:33], v[14:15]
    v_pk_fma_f32 v[34:35], v[14:15], v[14:15], v[34:35]
    v_pk_add_f32 v[32:33], v[32:33], v[16:17]
    v_pk_fma_f32 v[34:35], v[16:17], v[16:17], v[34:35]
    v_pk_add_f32 v[32:33], v[32:33], v[18:19]
    v_pk_fma_f32 v[34:35], v[18:19], v[18:19], v[34:35]
    v_pk_add_f32 v[32:33], v[32:33], v[20:21]
    v_pk_fma_f32 v[34:35], v[20:21], v[20:21], v[34:35]
    v_pk_add_f32 v[32:33], v[32:33], v[22:23]
    v_pk_fma_f32 v[34:35], v[22:23], v[22:23], v[34:35]
    v_pk_add_f32 v[32:33], v[32:33], v[24:25]
    v_pk_fma_f32 v[34:35], v[24:25], v[24:25], v[34:35]
    v_pk_add_f32 v[32:33], v[32:33], v[26:27]
    v_pk_fma_f32 v[34:35], v[26:27], v[26:27], v[34:35]
    v_pk_add_f32 v[32:33], v[32:33], v[28:29]
    v_pk_fma_f32 v[34:35], v[28:29], v[28:29], v[34:35]
    v_pk_add_f32 v[32:33], v[32:33], v[30:31]
    v_pk_fma_f32 v[34:35], v[30:31], v[30:31], v[34:35]
    v_add_f32 v184, v32, v33
    v_add_f32 v185, v34, v35
    v_mov_b32 v186, v184
    v_mov_b32 v187, v185
    s_nop 1
    v_permlane32_swap_b32 v186, v184
    v_permlane32_swap_b32 v187, v185
    s_nop 1
    v_add_f32 v184, v184, v186
    v_add_f32 v185, v185, v187
    v_mov_b32 v186, v184
    v_mov_b32 v187, v185
    s_nop 1
    v_permlane16_swap_b32 v186, v184
    v_permlane16_swap_b32 v187, v185
    s_nop 1
    v_add_f32 v184, v184, v186
    v_add_f32 v185, v185, v187
    s_mul_i32 s35, s30, 48
    s_lshl_b32 s36, s9, 3
    s_add_u32 s35, s35, s36
    s_add_u32 s35, s35, 20971520
    s_mov_b64 exec, 0xffff
    s_cmp_eq_u32 s98, 1
    s_cbranch_scc0 L_app_dw3
    buffer_store_dwordx2 v[184:185], v188, s[4:7], s35 offen
    s_branch L_app_dj3
L_app_dw3:
    buffer_store_dwordx2 v[184:185], v188, s[4:7], s35 offen sc0 sc1
L_app_dj3:
    s_mov_b64 exec, -1
    s_lshr_b32 s35, s8, 1
    s_mul_i32 s35, s35, 14336
    s_and_b32 s36, s8, 1
    s_mul_i32 s36, s36, 6
    s_add_u32 s36, s36, s9
    s_lshl_b32 s36, s36, 2
    s_add_u32 s36, s36, s10
    s_mul_i32 s36, s36, 16
    s_add_u32 s35, s35, s36
    s_add_u32 s35, s35, 22544384
    v_mov_b32 v32, 1
    v_mul_u32_u24 v33, 1024, v2
    s_waitcnt vmcnt(0)
    s_mov_b64 exec, 0x3fff
    s_cmp_eq_u32 s98, 1
    s_cbranch_scc0 L_app_dw4
    buffer_store_dword v32, v33, s[4:7], s35 offen
    s_branch L_app_dj4
L_app_dw4:
    buffer_store_dword v32, v33, s[4:7], s35 offen sc0 sc1
L_app_dj4:
    s_mov_b64 exec, -1
    s_branch L_app_end
L_app_e1:
    s_mov_b32 s24, s18
    s_and_b32 s25, s19, 0xffff
    s_mov_b32 s26, 0x240000
    s_mov_b32 s27, 0x00020000
    s_mul_i32 s33, s10, 3072
    s_add_u32 s33, s33, 135168
    v_mul_u32_u24 v179, 192, v176
    v_lshl_add_u32 v179, v177, 3, v179
    v_add_u32 v179, s33, v179
    ds_write_b64 v179, v[56:57] offset:0
    ds_write_b64 v179, v[58:59] offset:32
    ds_write_b64 v179, v[60:61] offset:64
    ds_write_b64 v179, v[62:63] offset:96
    ds_write_b64 v179, v[64:65] offset:128
    ds_write_b64 v179, v[66:67] offset:160
    v_add_u32 v180, s33, v7
    s_mul_i32 s34, s30, 1152
    s_mul_i32 s35, s9, 192
    s_add_u32 s34, s34, s35
    s_waitcnt lgkmcnt(0)
    ds_read_b128 v[32:35], v180 offset:0
    v_add_u32 v181, 0, v2
    v_mul_u32_u24 v182, 5462, v181
    v_lshrrev_b32 v182, 16, v182
    v_mul_u32_u24 v183, 12, v182
    v_sub_u32 v183, v181, v183
    v_mul_u32_u24 v182, 1152, v182
    v_lshl_add_u32 v44, v183, 4, v182
    ds_read_b128 v[36:39], v180 offset:1024
    v_add_u32 v181, 64, v2
    v_mul_u32_u24 v182, 5462, v181
    v_lshrrev_b32 v182, 16, v182
    v_mul_u32_u24 v183, 12, v182
    v_sub_u32 v183, v181, v183
    v_mul_u32_u24 v182, 1152, v182
    v_lshl_add_u32 v45, v183, 4, v182
    ds_read_b128 v[40:43], v180 offset:2048
    v_add_u32 v181, 128, v2
    v_mul_u32_u24 v182, 5462, v181
    v_lshrrev_b32 v182, 16, v182
    v_mul_u32_u24 v183, 12, v182
    v_sub_u32 v183, v181, v183
    v_mul_u32_u24 v182, 1152, v182
    v_lshl_add_u32 v46, v183, 4, v182
    s_waitcnt lgkmcnt(2)
    buffer_store_dwordx4 v[32:35], v44, s[24:27], s34 offen sc0 sc1
    s_waitcnt lgkmcnt(1)
    buffer_store_dwordx4 v[36:39], v45, s[24:27], s34 offen sc0 sc1
    s_waitcnt lgkmcnt(0)
    buffer_store_dwordx4 v[40:43], v46, s[24:27], s34 offen sc0 sc1
L_app_end:
    s_cmp_eq_u32 s99, 0
    s_cbranch_scc1 L_ap_q
    s_branch L_ap_fin
L_ap_nop:
    v_mov_b32 v60, 1
    v_mul_u32_u24 v61, 1024, v2
    s_waitcnt vmcnt(0)
    s_mov_b64 exec, 0x3f
    buffer_store_dword v60, v61, s[4:7], s50 offen sc0 sc1
    s_mov_b64 exec, -1
    s_cmp_eq_u32 s99, 0
    s_cbranch_scc0 L_ap_fin
    s_cmp_ge_u32 s2, 224
    s_cbranch_scc1 L_ap_fin
L_ap_q:
    s_load_dwordx2 s[12:13], s[0:1], 88
    s_load_dwordx2 s[16:17], s[0:1], 0
    s_and_b32 s8, s2, 7
    s_lshr_b32 s9, s2, 3
    s_lshl_b32 s8, s8, 1
    s_and_b32 s11, s9, 1
    s_or_b32 s8, s8, s11
    s_lshr_b32 s9, s9, 1
    v_lshrrev_b32 v1, 6, v0
    v_and_b32 v2, 63, v0
    v_readfirstlane_b32 s10, v1
    v_lshlrev_b32 v7, 4, v2
    s_cmp_ge_u32 s10, 4
    s_cbranch_scc0 L_apq_compute
    s_sub_u32 s28, s10, 4
    s_lshl_b32 s38, s28, 11
    s_mul_i32 s36, s9, 147456
    s_add_u32 s36, s36, s38
    s_add_u32 s36, s36, 25165824
    s_lshl_b32 s30, s8, 7
    s_lshl_b32 s31, s28, 5
    s_add_u32 s30, s30, s31
    s_mul_i32 s32, s28, 33024
    s_lshl_b32 s39, s8, 11
    s_add_u32 s32, s32, s39
    s_add_u32 s32, s32, 11534336
    s_mov_b32 s33, 1024
    s_mov_b32 s34, 132096
    v_mov_b32 v3, v7
    s_waitcnt lgkmcnt(0)
    s_mov_b32 s4, s12
    s_and_b32 s5, s13, 0xffff
    s_mov_b32 s6, 0x10000000
    s_mov_b32 s7, 0x00020000
    s_add_u32 m0, s38, 73728
    s_add_u32 s40, s36, 1024
    buffer_load_dwordx4 v7, s[4:7], s36 offen  lds
    s_add_u32 m0, s38, 74752
    s_add_u32 s36, s36, 8192
    buffer_load_dwordx4 v7, s[4:7], s40 offen  lds
    s_add_u32 m0, s38, 81920
    s_add_u32 s40, s36, 1024
    buffer_load_dwordx4 v7, s[4:7], s36 offen  lds
    s_add_u32 m0, s38, 82944
    s_add_u32 s36, s36, 8192
    buffer_load_dwordx4 v7, s[4:7], s40 offen  lds
    s_add_u32 m0, s38, 90112
    s_add_u32 s40, s36, 1024
    buffer_load_dwordx4 v7, s[4:7], s36 offen  lds
    s_add_u32 m0, s38, 91136
    s_add_u32 s36, s36, 8192
    buffer_load_dwordx4 v7, s[4:7], s40 offen  lds
    s_add_u32 m0, s38, 98304
    s_add_u32 s40, s36, 1024
    buffer_load_dwordx4 v7, s[4:7], s36 offen  lds
    s_add_u32 m0, s38, 99328
    s_add_u32 s36, s36, 8192
    buffer_load_dwordx4 v7, s[4:7], s40 offen  lds
    s_add_u32 m0, s38, 106496
    s_add_u32 s40, s36, 1024
    buffer_load_dwordx4 v7, s[4:7], s36 offen  lds
    s_add_u32 m0, s38, 107520
    s_add_u32 s36, s36, 8192
    buffer_load_dwordx4 v7, s[4:7], s40 offen  lds
    s_add_u32 m0, s38, 114688
    s_add_u32 s40, s36, 1024
    buffer_load_dwordx4 v7, s[4:7], s36 offen  lds
    s_add_u32 m0, s38, 115712
    s_add_u32 s36, s36, 8192
    buffer_load_dwordx4 v7, s[4:7], s40 offen  lds
    s_add_u32 m0, s38, 122880
    s_add_u32 s40, s36, 1024
    buffer_load_dwordx4 v7, s[4:7], s36 offen  lds
    s_add_u32 m0, s38, 123904
    s_add_u32 s36, s36, 8192
    buffer_load_dwordx4 v7, s[4:7], s40 offen  lds
    s_add_u32 m0, s38, 131072
    s_add_u32 s40, s36, 1024
    buffer_load_dwordx4 v7, s[4:7], s36 offen  lds
    s_add_u32 m0, s38, 132096
    s_add_u32 s36, s36, 8192
    buffer_load_dwordx4 v7, s[4:7], s40 offen  lds
    s_cmp_eq_u32 s28, 0
    s_cbranch_scc0 L_ap_wq
    s_mul_i32 s42, s8, 14
    s_add_u32 s42, s42, s9
    s_mul_i32 s42, s42, 1024
    s_add_u32 s42, s42, 22544384
    v_mul_u32_u24 v14, 16, v2
    s_mov_b32 s41, 0
    s_mov_b32 exec_hi, 0xffff
L_ap_wqp:
    buffer_load_dword v23, v14, s[4:7], s42 offen sc1
    s_add_u32 s41, s41, 1
    s_waitcnt vmcnt(0)
    v_cmp_eq_u32 vcc, 1, v23
    s_nop 4
    s_cmp_eq_u64 vcc, exec
    s_cbranch_scc1 L_ap_wqg
    s_cmp_lt_u32 s41, 0x100000
    s_cbranch_scc1 L_ap_wqp
L_ap_wqg:
    s_mov_b64 exec, -1
L_ap_wq:
    s_barrier
    s_add_u32 m0, s38, 0
    s_add_u32 s40, s32, s33
    buffer_load_dwordx4 v3, s[4:7], s32 offen sc1 lds
    s_add_u32 m0, s38, 1024
    s_add_u32 s32, s32, s34
    buffer_load_dwordx4 v3, s[4:7], s40 offen sc1 lds
    s_add_u32 m0, s38, 8192
    s_add_u32 s40, s32, s33
    buffer_load_dwordx4 v3, s[4:7], s32 offen sc1 lds
    s_add_u32 m0, s38, 9216
    s_add_u32 s32, s32, s34
    buffer_load_dwordx4 v3, s[4:7], s40 offen sc1 lds
    s_add_u32 m0, s38, 16384
    s_add_u32 s40, s32, s33
    buffer_load_dwordx4 v3, s[4:7], s32 offen sc1 lds
    s_add_u32 m0, s38, 17408
    s_add_u32 s32, s32, s34
    buffer_load_dwordx4 v3, s[4:7], s40 offen sc1 lds
    s_add_u32 m0, s38, 24576
    s_add_u32 s40, s32, s33
    buffer_load_dwordx4 v3, s[4:7], s32 offen sc1 lds
    s_add_u32 m0, s38, 25600
    s_add_u32 s32, s32, s34
    buffer_load_dwordx4 v3, s[4:7], s40 offen sc1 lds
    s_add_u32 m0, s38, 32768
    s_add_u32 s40, s32, s33
    buffer_load_dwordx4 v3, s[4:7], s32 offen sc1 lds
    s_add_u32 m0, s38, 33792
    s_add_u32 s32, s32, s34
    buffer_load_dwordx4 v3, s[4:7], s40 offen sc1 lds
    v_and_b32 v10, 31, v2
    v_lshrrev_b32 v11, 5, v2
    v_mul_u32_u24 v12, 48, v10
    v_mul_u32_u24 v13, 24, v11
    v_add_u32 v12, v12, v13
    s_mul_i32 s41, s30, 48
    s_add_u32 s41, s41, 20971520
    buffer_load_dwordx2 v[16:17], v12, s[4:7], s41 offen sc1
    buffer_load_dwordx2 v[18:19], v12, s[4:7], s41 offen offset:8 sc1
    buffer_load_dwordx2 v[20:21], v12, s[4:7], s41 offen offset:16 sc1
    s_lshl_b32 s42, s9, 9
    s_lshl_b32 s43, s28, 7
    s_add_u32 s42, s42, s43
    s_add_u32 s42, s42, 21495808
    v_lshlrev_b32 v13, 2, v10
    buffer_load_dword v22, v13, s[4:7], s42 offen
    s_add_u32 s42, s42, 7168
    buffer_load_dword v23, v13, s[4:7], s42 offen
    s_add_u32 s42, s42, 7168
    buffer_load_dword v24, v13, s[4:7], s42 offen
    s_add_u32 s42, s42, 7168
    buffer_load_dword v25, v13, s[4:7], s42 offen
    s_waitcnt vmcnt(13)
    s_barrier
    s_add_u32 m0, s38, 40960
    s_add_u32 s40, s32, s33
    buffer_load_dwordx4 v3, s[4:7], s32 offen sc1 lds
    s_add_u32 m0, s38, 41984
    s_add_u32 s32, s32, s34
    buffer_load_dwordx4 v3, s[4:7], s40 offen sc1 lds
    s_add_u32 m0, s38, 139264
    s_add_u32 s40, s36, 1024
    buffer_load_dwordx4 v7, s[4:7], s36 offen  lds
    s_add_u32 m0, s38, 140288
    s_add_u32 s36, s36, 8192
    buffer_load_dwordx4 v7, s[4:7], s40 offen  lds
    s_waitcnt vmcnt(15)
    s_barrier
    s_add_u32 m0, s38, 49152
    s_add_u32 s40, s32, s33
    buffer_load_dwordx4 v3, s[4:7], s32 offen sc1 lds
    s_add_u32 m0, s38, 50176
    s_add_u32 s32, s32, s34
    buffer_load_dwordx4 v3, s[4:7], s40 offen sc1 lds
    s_add_u32 m0, s38, 73728
    s_add_u32 s40, s36, 1024
    buffer_load_dwordx4 v7, s[4:7], s36 offen  lds
    s_add_u32 m0, s38, 74752
    s_add_u32 s36, s36, 8192
    buffer_load_dwordx4 v7, s[4:7], s40 offen  lds
    s_waitcnt vmcnt(17)
    s_barrier
    s_add_u32 m0, s38, 57344
    s_add_u32 s40, s32, s33
    buffer_load_dwordx4 v3, s[4:7], s32 offen sc1 lds
    s_add_u32 m0, s38, 58368
    s_add_u32 s32, s32, s34
    buffer_load_dwordx4 v3, s[4:7], s40 offen sc1 lds
    s_add_u32 m0, s38, 81920
    s_add_u32 s40, s36, 1024
    buffer_load_dwordx4 v7, s[4:7], s36 offen  lds
    s_add_u32 m0, s38, 82944
    s_add_u32 s36, s36, 8192
    buffer_load_dwordx4 v7, s[4:7], s40 offen  lds
    s_waitcnt vmcnt(19)
    s_barrier
    s_add_u32 m0, s38, 65536
    s_add_u32 s40, s32, s33
    buffer_load_dwordx4 v3, s[4:7], s32 offen sc1 lds
    s_add_u32 m0, s38, 66560
    s_add_u32 s32, s32, s34
    buffer_load_dwordx4 v3, s[4:7], s40 offen sc1 lds
    s_add_u32 m0, s38, 90112
    s_add_u32 s40, s36, 1024
    buffer_load_dwordx4 v7, s[4:7], s36 offen  lds
    s_add_u32 m0, s38, 91136
    s_add_u32 s36, s36, 8192
    buffer_load_dwordx4 v7, s[4:7], s40 offen  lds
    s_waitcnt vmcnt(14)
    s_barrier
    s_add_u32 m0, s38, 0
    s_add_u32 s40, s32, s33
    buffer_load_dwordx4 v3, s[4:7], s32 offen sc1 lds
    s_add_u32 m0, s38, 1024
    s_add_u32 s32, s32, s34
    buffer_load_dwordx4 v3, s[4:7], s40 offen sc1 lds
    s_add_u32 m0, s38, 98304
    s_add_u32 s40, s36, 1024
    buffer_load_dwordx4 v7, s[4:7], s36 offen  lds
    s_add_u32 m0, s38, 99328
    s_add_u32 s36, s36, 8192
    buffer_load_dwordx4 v7, s[4:7], s40 offen  lds
    s_waitcnt vmcnt(14)
    s_barrier
    s_add_u32 m0, s38, 8192
    s_add_u32 s40, s32, s33
    buffer_load_dwordx4 v3, s[4:7], s32 offen sc1 lds
    s_add_u32 m0, s38, 9216
    s_add_u32 s32, s32, s34
    buffer_load_dwordx4 v3, s[4:7], s40 offen sc1 lds
    s_add_u32 m0, s38, 106496
    s_add_u32 s40, s36, 1024
    buffer_load_dwordx4 v7, s[4:7], s36 offen  lds
    s_add_u32 m0, s38, 107520
    s_add_u32 s36, s36, 8192
    buffer_load_dwordx4 v7, s[4:7], s40 offen  lds
    s_waitcnt vmcnt(14)
    s_barrier
    s_add_u32 m0, s38, 16384
    s_add_u32 s40, s32, s33
    buffer_load_dwordx4 v3, s[4:7], s32 offen sc1 lds
    s_add_u32 m0, s38, 17408
    s_add_u32 s32, s32, s34
    buffer_load_dwordx4 v3, s[4:7], s40 offen sc1 lds
    s_add_u32 m0, s38, 114688
    s_add_u32 s40, s36, 1024
    buffer_load_dwordx4 v7, s[4:7], s36 offen  lds
    s_add_u32 m0, s38, 115712
    s_add_u32 s36, s36, 8192
    buffer_load_dwordx4 v7, s[4:7], s40 offen  lds
    s_waitcnt vmcnt(14)
    s_barrier
    s_add_u32 m0, s38, 24576
    s_add_u32 s40, s32, s33
    buffer_load_dwordx4 v3, s[4:7], s32 offen sc1 lds
    s_add_u32 m0, s38, 25600
    s_add_u32 s32, s32, s34
    buffer_load_dwordx4 v3, s[4:7], s40 offen sc1 lds
    s_add_u32 m0, s38, 122880
    s_add_u32 s40, s36, 1024
    buffer_load_dwordx4 v7, s[4:7], s36 offen  lds
    s_add_u32 m0, s38, 123904
    s_add_u32 s36, s36, 8192
    buffer_load_dwordx4 v7, s[4:7], s40 offen  lds
    s_waitcnt vmcnt(14)
    s_barrier
    s_add_u32 m0, s38, 32768
    s_add_u32 s40, s32, s33
    buffer_load_dwordx4 v3, s[4:7], s32 offen sc1 lds
    s_add_u32 m0, s38, 33792
    s_add_u32 s32, s32, s34
    buffer_load_dwordx4 v3, s[4:7], s40 offen sc1 lds
    s_add_u32 m0, s38, 131072
    s_add_u32 s40, s36, 1024
    buffer_load_dwordx4 v7, s[4:7], s36 offen  lds
    s_add_u32 m0, s38, 132096
    s_add_u32 s36, s36, 8192
    buffer_load_dwordx4 v7, s[4:7], s40 offen  lds
    s_waitcnt vmcnt(14)
    s_barrier
    s_add_u32 m0, s38, 40960
    s_add_u32 s40, s32, s33
    buffer_load_dwordx4 v3, s[4:7], s32 offen sc1 lds
    s_add_u32 m0, s38, 41984
    s_add_u32 s32, s32, s34
    buffer_load_dwordx4 v3, s[4:7], s40 offen sc1 lds
    s_add_u32 m0, s38, 139264
    s_add_u32 s40, s36, 1024
    buffer_load_dwordx4 v7, s[4:7], s36 offen  lds
    s_add_u32 m0, s38, 140288
    s_add_u32 s36, s36, 8192
    buffer_load_dwordx4 v7, s[4:7], s40 offen  lds
    s_waitcnt vmcnt(14)
    s_barrier
    s_add_u32 m0, s38, 49152
    s_add_u32 s40, s32, s33
    buffer_load_dwordx4 v3, s[4:7], s32 offen sc1 lds
    s_add_u32 m0, s38, 50176
    s_add_u32 s32, s32, s34
    buffer_load_dwordx4 v3, s[4:7], s40 offen sc1 lds
    s_waitcnt vmcnt(42)
    v_add_f32 v22, v22, v23
    v_add_f32 v24, v24, v25
    v_add_f32 v16, v16, v18
    v_add_f32 v17, v17, v19
    v_add_f32 v22, v22, v24
    v_add_f32 v16, v16, v20
    v_add_f32 v17, v17, v21
    s_nop 1
    v_mov_b32 v18, v16
    v_mov_b32 v19, v17
    s_nop 1
    v_permlane32_swap_b32 v18, v16
    v_permlane32_swap_b32 v19, v17
    s_nop 1
    v_add_f32 v16, v16, v18
    v_add_f32 v17, v17, v19
    s_mov_b32 s42, 0x3ae38e39
    v_mul_f32 v16, s42, v16
    v_mul_f32 v17, s42, v17
    v_fma_f32 v17, -v16, v16, v17
    v_max_f32 v17, 0, v17
    v_add_f32 v17, 0x3727c5ac, v17
    v_rsq_f32 v17, v17
    s_lshl_b32 s42, s28, 7
    v_lshlrev_b32 v18, 2, v10
    v_add_u32 v18, s42, v18
    v_mul_f32 v16, v16, v17
    v_lshlrev_b32 v19, 1, v18
    s_mov_b32 exec_hi, 0
    ds_write_b32 v18, v17 offset:0
    ds_write_b32 v18, v16 offset:512
    ds_write_b32 v19, v17 offset:1024
    ds_write_b32 v19, v16 offset:1028
    ds_write_b32 v18, v22 offset:2048
    s_mov_b32 exec_hi, -1
    s_waitcnt lgkmcnt(0)
    s_waitcnt vmcnt(12)
    s_barrier
    s_add_u32 m0, s38, 57344
    s_add_u32 s40, s32, s33
    buffer_load_dwordx4 v3, s[4:7], s32 offen sc1 lds
    s_add_u32 m0, s38, 58368
    s_add_u32 s32, s32, s34
    buffer_load_dwordx4 v3, s[4:7], s40 offen sc1 lds
    s_waitcnt vmcnt(10)
    s_barrier
    s_add_u32 m0, s38, 65536
    s_add_u32 s40, s32, s33
    buffer_load_dwordx4 v3, s[4:7], s32 offen sc1 lds
    s_add_u32 m0, s38, 66560
    s_add_u32 s32, s32, s34
    buffer_load_dwordx4 v3, s[4:7], s40 offen sc1 lds
    s_waitcnt vmcnt(8)
    s_barrier
    s_waitcnt vmcnt(4)
    s_barrier
    s_waitcnt vmcnt(2)
    s_barrier
    s_waitcnt vmcnt(0)
    s_barrier
    s_barrier
    s_branch L_apq_end
L_apq_compute:
    s_and_b32 s28, s10, 1
    s_lshr_b32 s29, s10, 1
    v_and_b32 v105, 31, v2
    v_lshrrev_b32 v106, 5, v2
    s_cmp_ge_u32 s9, 8
    s_cselect_b32 s33, 1, 0
    s_cmp_ge_u32 s9, 13
    s_cselect_b32 s33, 0, s33
    v_lshlrev_b32 v3, 4, v105
    v_lshl_add_u32 v3, v106, 11, v3
    s_lshl_b32 s30, s28, 10
    v_add_u32 v3, s30, v3
    v_add_u32 v4, 4096, v3
    s_lshl_b32 s30, s29, 11
    s_add_u32 s30, s30, 73728
    v_add_u32 v5, s30, v7
    s_lshl_b32 s31, s8, 2
    s_lshl_b32 s30, s28, 1
    s_add_u32 s31, s31, s30
    s_waitcnt lgkmcnt(0)
    v_add_u32 v107, 40960, v3
    v_add_u32 v108, 40960, v4
    v_add_u32 v6, 40960, v5
    s_mov_b32 s4, s12
    s_and_b32 s5, s13, 0xffff
    s_mov_b32 s6, 0x10000000
    s_mov_b32 s7, 0x00020000
    s_cmp_eq_u32 s33, 1
    s_cbranch_scc1 L_apq_vt
    s_barrier
    s_barrier
    ds_read_b128 v[8:11], v3 offset:0
    ds_read_b128 v[24:27], v5 offset:0
    ds_read_b128 v[12:15], v3 offset:512
    ds_read_b128 v[28:31], v5 offset:1024
    s_waitcnt lgkmcnt(2)
    v_mfma_f32_32x32x16_bf16 v[40:55], v[24:27], v[8:11], 0
    ds_read_b128 v[16:19], v4 offset:0
    ds_read_b128 v[32:35], v5 offset:4096
    s_waitcnt lgkmcnt(2)
    v_mfma_f32_32x32x16_bf16 v[56:71], v[28:31], v[8:11], 0
    ds_read_b128 v[20:23], v4 offset:512
    ds_read_b128 v[36:39], v5 offset:5120
    v_mfma_f32_32x32x16_bf16 v[72:87], v[24:27], v[12:15], 0
    v_mfma_f32_32x32x16_bf16 v[88:103], v[28:31], v[12:15], 0
    s_waitcnt lgkmcnt(2)
    v_mfma_f32_32x32x16_bf16 v[40:55], v[32:35], v[16:19], v[40:55]
    ds_read_b128 v[8:11], v3 offset:8192
    ds_read_b128 v[24:27], v5 offset:8192
    s_waitcnt lgkmcnt(2)
    v_mfma_f32_32x32x16_bf16 v[56:71], v[36:39], v[16:19], v[56:71]
    ds_read_b128 v[12:15], v3 offset:8704
    ds_read_b128 v[28:31], v5 offset:9216
    v_mfma_f32_32x32x16_bf16 v[72:87], v[32:35], v[20:23], v[72:87]
    v_mfma_f32_32x32x16_bf16 v[88:103], v[36:39], v[20:23], v[88:103]
    s_barrier
    s_waitcnt lgkmcnt(2)
    v_mfma_f32_32x32x16_bf16 v[40:55], v[24:27], v[8:11], v[40:55]
    ds_read_b128 v[16:19], v4 offset:8192
    ds_read_b128 v[32:35], v5 offset:12288
    s_waitcnt lgkmcnt(2)
    v_mfma_f32_32x32x16_bf16 v[56:71], v[28:31], v[8:11], v[56:71]
    ds_read_b128 v[20:23], v4 offset:8704
    ds_read_b128 v[36:39], v5 offset:13312
    v_mfma_f32_32x32x16_bf16 v[72:87], v[24:27], v[12:15], v[72:87]
    v_mfma_f32_32x32x16_bf16 v[88:103], v[28:31], v[12:15], v[88:103]
    s_waitcnt lgkmcnt(2)
    v_mfma_f32_32x32x16_bf16 v[40:55], v[32:35], v[16:19], v[40:55]
    ds_read_b128 v[8:11], v3 offset:16384
    ds_read_b128 v[24:27], v5 offset:16384
    s_waitcnt lgkmcnt(2)
    v_mfma_f32_32x32x16_bf16 v[56:71], v[36:39], v[16:19], v[56:71]
    ds_read_b128 v[12:15], v3 offset:16896
    ds_read_b128 v[28:31], v5 offset:17408
    v_mfma_f32_32x32x16_bf16 v[72:87], v[32:35], v[20:23], v[72:87]
    v_mfma_f32_32x32x16_bf16 v[88:103], v[36:39], v[20:23], v[88:103]
    s_barrier
    s_waitcnt lgkmcnt(2)
    v_mfma_f32_32x32x16_bf16 v[40:55], v[24:27], v[8:11], v[40:55]
    ds_read_b128 v[16:19], v4 offset:16384
    ds_read_b128 v[32:35], v5 offset:20480
    s_waitcnt lgkmcnt(2)
    v_mfma_f32_32x32x16_bf16 v[56:71], v[28:31], v[8:11], v[56:71]
    ds_read_b128 v[20:23], v4 offset:16896
    ds_read_b128 v[36:39], v5 offset:21504
    v_mfma_f32_32x32x16_bf16 v[72:87], v[24:27], v[12:15], v[72:87]
    v_mfma_f32_32x32x16_bf16 v[88:103], v[28:31], v[12:15], v[88:103]
    s_waitcnt lgkmcnt(2)
    v_mfma_f32_32x32x16_bf16 v[40:55], v[32:35], v[16:19], v[40:55]
    ds_read_b128 v[8:11], v3 offset:24576
    ds_read_b128 v[24:27], v5 offset:24576
    s_waitcnt lgkmcnt(2)
    v_mfma_f32_32x32x16_bf16 v[56:71], v[36:39], v[16:19], v[56:71]
    ds_read_b128 v[12:15], v3 offset:25088
    ds_read_b128 v[28:31], v5 offset:25600
    v_mfma_f32_32x32x16_bf16 v[72:87], v[32:35], v[20:23], v[72:87]
    v_mfma_f32_32x32x16_bf16 v[88:103], v[36:39], v[20:23], v[88:103]
    s_barrier
    s_waitcnt lgkmcnt(2)
    v_mfma_f32_32x32x16_bf16 v[40:55], v[24:27], v[8:11], v[40:55]
    ds_read_b128 v[16:19], v4 offset:24576
    ds_read_b128 v[32:35], v5 offset:28672
    s_waitcnt lgkmcnt(2)
    v_mfma_f32_32x32x16_bf16 v[56:71], v[28:31], v[8:11], v[56:71]
    ds_read_b128 v[20:23], v4 offset:25088
    ds_read_b128 v[36:39], v5 offset:29696
    v_mfma_f32_32x32x16_bf16 v[72:87], v[24:27], v[12:15], v[72:87]
    v_mfma_f32_32x32x16_bf16 v[88:103], v[28:31], v[12:15], v[88:103]
    s_waitcnt lgkmcnt(2)
    v_mfma_f32_32x32x16_bf16 v[40:55], v[32:35], v[16:19], v[40:55]
    ds_read_b128 v[8:11], v3 offset:32768
    ds_read_b128 v[24:27], v5 offset:32768
    s_waitcnt lgkmcnt(2)
    v_mfma_f32_32x32x16_bf16 v[56:71], v[36:39], v[16:19], v[56:71]
    ds_read_b128 v[12:15], v3 offset:33280
    ds_read_b128 v[28:31], v5 offset:33792
    v_mfma_f32_32x32x16_bf16 v[72:87], v[32:35], v[20:23], v[72:87]
    v_mfma_f32_32x32x16_bf16 v[88:103], v[36:39], v[20:23], v[88:103]
    s_barrier
    s_waitcnt lgkmcnt(2)
    v_mfma_f32_32x32x16_bf16 v[40:55], v[24:27], v[8:11], v[40:55]
    ds_read_b128 v[16:19], v4 offset:32768
    ds_read_b128 v[32:35], v5 offset:36864
    s_waitcnt lgkmcnt(2)
    v_mfma_f32_32x32x16_bf16 v[56:71], v[28:31], v[8:11], v[56:71]
    ds_read_b128 v[20:23], v4 offset:33280
    ds_read_b128 v[36:39], v5 offset:37888
    v_mfma_f32_32x32x16_bf16 v[72:87], v[24:27], v[12:15], v[72:87]
    v_mfma_f32_32x32x16_bf16 v[88:103], v[28:31], v[12:15], v[88:103]
    s_waitcnt lgkmcnt(2)
    v_mfma_f32_32x32x16_bf16 v[40:55], v[32:35], v[16:19], v[40:55]
    ds_read_b128 v[8:11], v107 offset:0
    ds_read_b128 v[24:27], v6 offset:0
    s_waitcnt lgkmcnt(2)
    v_mfma_f32_32x32x16_bf16 v[56:71], v[36:39], v[16:19], v[56:71]
    ds_read_b128 v[12:15], v107 offset:512
    ds_read_b128 v[28:31], v6 offset:1024
    v_mfma_f32_32x32x16_bf16 v[72:87], v[32:35], v[20:23], v[72:87]
    v_mfma_f32_32x32x16_bf16 v[88:103], v[36:39], v[20:23], v[88:103]
    s_barrier
    s_waitcnt lgkmcnt(2)
    v_mfma_f32_32x32x16_bf16 v[40:55], v[24:27], v[8:11], v[40:55]
    ds_read_b128 v[16:19], v108 offset:0
    ds_read_b128 v[32:35], v6 offset:4096
    s_waitcnt lgkmcnt(2)
    v_mfma_f32_32x32x16_bf16 v[56:71], v[28:31], v[8:11], v[56:71]
    ds_read_b128 v[20:23], v108 offset:512
    ds_read_b128 v[36:39], v6 offset:5120
    v_mfma_f32_32x32x16_bf16 v[72:87], v[24:27], v[12:15], v[72:87]
    v_mfma_f32_32x32x16_bf16 v[88:103], v[28:31], v[12:15], v[88:103]
    s_waitcnt lgkmcnt(2)
    v_mfma_f32_32x32x16_bf16 v[40:55], v[32:35], v[16:19], v[40:55]
    ds_read_b128 v[8:11], v107 offset:8192
    ds_read_b128 v[24:27], v6 offset:8192
    s_waitcnt lgkmcnt(2)
    v_mfma_f32_32x32x16_bf16 v[56:71], v[36:39], v[16:19], v[56:71]
    ds_read_b128 v[12:15], v107 offset:8704
    ds_read_b128 v[28:31], v6 offset:9216
    v_mfma_f32_32x32x16_bf16 v[72:87], v[32:35], v[20:23], v[72:87]
    v_mfma_f32_32x32x16_bf16 v[88:103], v[36:39], v[20:23], v[88:103]
    s_barrier
    s_waitcnt lgkmcnt(2)
    v_mfma_f32_32x32x16_bf16 v[40:55], v[24:27], v[8:11], v[40:55]
    ds_read_b128 v[16:19], v108 offset:8192
    ds_read_b128 v[32:35], v6 offset:12288
    s_waitcnt lgkmcnt(2)
    v_mfma_f32_32x32x16_bf16 v[56:71], v[28:31], v[8:11], v[56:71]
    ds_read_b128 v[20:23], v108 offset:8704
    ds_read_b128 v[36:39], v6 offset:13312
    v_mfma_f32_32x32x16_bf16 v[72:87], v[24:27], v[12:15], v[72:87]
    v_mfma_f32_32x32x16_bf16 v[88:103], v[28:31], v[12:15], v[88:103]
    s_waitcnt lgkmcnt(2)
    v_mfma_f32_32x32x16_bf16 v[40:55], v[32:35], v[16:19], v[40:55]
    ds_read_b128 v[8:11], v107 offset:16384
    ds_read_b128 v[24:27], v6 offset:16384
    s_waitcnt lgkmcnt(2)
    v_mfma_f32_32x32x16_bf16 v[56:71], v[36:39], v[16:19], v[56:71]
    ds_read_b128 v[12:15], v107 offset:16896
    ds_read_b128 v[28:31], v6 offset:17408
    v_mfma_f32_32x32x16_bf16 v[72:87], v[32:35], v[20:23], v[72:87]
    v_mfma_f32_32x32x16_bf16 v[88:103], v[36:39], v[20:23], v[88:103]
    s_barrier
    s_waitcnt lgkmcnt(2)
    v_mfma_f32_32x32x16_bf16 v[40:55], v[24:27], v[8:11], v[40:55]
    ds_read_b128 v[16:19], v108 offset:16384
    ds_read_b128 v[32:35], v6 offset:20480
    s_waitcnt lgkmcnt(2)
    v_mfma_f32_32x32x16_bf16 v[56:71], v[28:31], v[8:11], v[56:71]
    ds_read_b128 v[20:23], v108 offset:16896
    ds_read_b128 v[36:39], v6 offset:21504
    v_mfma_f32_32x32x16_bf16 v[72:87], v[24:27], v[12:15], v[72:87]
    v_mfma_f32_32x32x16_bf16 v[88:103], v[28:31], v[12:15], v[88:103]
    s_waitcnt lgkmcnt(2)
    v_mfma_f32_32x32x16_bf16 v[40:55], v[32:35], v[16:19], v[40:55]
    ds_read_b128 v[8:11], v107 offset:24576
    ds_read_b128 v[24:27], v6 offset:24576
    s_waitcnt lgkmcnt(2)
    v_mfma_f32_32x32x16_bf16 v[56:71], v[36:39], v[16:19], v[56:71]
    ds_read_b128 v[12:15], v107 offset:25088
    ds_read_b128 v[28:31], v6 offset:25600
    v_mfma_f32_32x32x16_bf16 v[72:87], v[32:35], v[20:23], v[72:87]
    v_mfma_f32_32x32x16_bf16 v[88:103], v[36:39], v[20:23], v[88:103]
    s_barrier
    s_waitcnt lgkmcnt(2)
    v_mfma_f32_32x32x16_bf16 v[40:55], v[24:27], v[8:11], v[40:55]
    ds_read_b128 v[16:19], v108 offset:24576
    ds_read_b128 v[32:35], v6 offset:28672
    s_waitcnt lgkmcnt(2)
    v_mfma_f32_32x32x16_bf16 v[56:71], v[28:31], v[8:11], v[56:71]
    ds_read_b128 v[20:23], v108 offset:25088
    ds_read_b128 v[36:39], v6 offset:29696
    v_mfma_f32_32x32x16_bf16 v[72:87], v[24:27], v[12:15], v[72:87]
    v_mfma_f32_32x32x16_bf16 v[88:103], v[28:31], v[12:15], v[88:103]
    s_waitcnt lgkmcnt(2)
    v_mfma_f32_32x32x16_bf16 v[40:55], v[32:35], v[16:19], v[40:55]
    ds_read_b128 v[8:11], v3 offset:0
    ds_read_b128 v[24:27], v5 offset:0
    s_waitcnt lgkmcnt(2)
    v_mfma_f32_32x32x16_bf16 v[56:71], v[36:39], v[16:19], v[56:71]
    ds_read_b128 v[12:15], v3 offset:512
    ds_read_b128 v[28:31], v5 offset:1024
    v_mfma_f32_32x32x16_bf16 v[72:87], v[32:35], v[20:23], v[72:87]
    v_mfma_f32_32x32x16_bf16 v[88:103], v[36:39], v[20:23], v[88:103]
    s_barrier
    s_waitcnt lgkmcnt(2)
    v_mfma_f32_32x32x16_bf16 v[40:55], v[24:27], v[8:11], v[40:55]
    ds_read_b128 v[16:19], v4 offset:0
    ds_read_b128 v[32:35], v5 offset:4096
    s_waitcnt lgkmcnt(2)
    v_mfma_f32_32x32x16_bf16 v[56:71], v[28:31], v[8:11], v[56:71]
    ds_read_b128 v[20:23], v4 offset:512
    ds_read_b128 v[36:39], v5 offset:5120
    v_mfma_f32_32x32x16_bf16 v[72:87], v[24:27], v[12:15], v[72:87]
    v_mfma_f32_32x32x16_bf16 v[88:103], v[28:31], v[12:15], v[88:103]
    s_waitcnt lgkmcnt(2)
    v_mfma_f32_32x32x16_bf16 v[40:55], v[32:35], v[16:19], v[40:55]
    ds_read_b128 v[8:11], v3 offset:8192
    ds_read_b128 v[24:27], v5 offset:8192
    s_waitcnt lgkmcnt(2)
    v_mfma_f32_32x32x16_bf16 v[56:71], v[36:39], v[16:19], v[56:71]
    ds_read_b128 v[12:15], v3 offset:8704
    ds_read_b128 v[28:31], v5 offset:9216
    v_mfma_f32_32x32x16_bf16 v[72:87], v[32:35], v[20:23], v[72:87]
    v_mfma_f32_32x32x16_bf16 v[88:103], v[36:39], v[20:23], v[88:103]
    s_barrier
    s_waitcnt lgkmcnt(2)
    v_mfma_f32_32x32x16_bf16 v[40:55], v[24:27], v[8:11], v[40:55]
    ds_read_b128 v[16:19], v4 offset:8192
    ds_read_b128 v[32:35], v5 offset:12288
    s_waitcnt lgkmcnt(2)
    v_mfma_f32_32x32x16_bf16 v[56:71], v[28:31], v[8:11], v[56:71]
    ds_read_b128 v[20:23], v4 offset:8704
    ds_read_b128 v[36:39], v5 offset:13312
    v_mfma_f32_32x32x16_bf16 v[72:87], v[24:27], v[12:15], v[72:87]
    v_mfma_f32_32x32x16_bf16 v[88:103], v[28:31], v[12:15], v[88:103]
    s_waitcnt lgkmcnt(2)
    v_mfma_f32_32x32x16_bf16 v[40:55], v[32:35], v[16:19], v[40:55]
    ds_read_b128 v[8:11], v3 offset:16384
    ds_read_b128 v[24:27], v5 offset:16384
    s_waitcnt lgkmcnt(2)
    v_mfma_f32_32x32x16_bf16 v[56:71], v[36:39], v[16:19], v[56:71]
    ds_read_b128 v[12:15], v3 offset:16896
    ds_read_b128 v[28:31], v5 offset:17408
    v_mfma_f32_32x32x16_bf16 v[72:87], v[32:35], v[20:23], v[72:87]
    v_mfma_f32_32x32x16_bf16 v[88:103], v[36:39], v[20:23], v[88:103]
    s_barrier
    s_waitcnt lgkmcnt(2)
    v_mfma_f32_32x32x16_bf16 v[40:55], v[24:27], v[8:11], v[40:55]
    ds_read_b128 v[16:19], v4 offset:16384
    ds_read_b128 v[32:35], v5 offset:20480
    s_waitcnt lgkmcnt(2)
    v_mfma_f32_32x32x16_bf16 v[56:71], v[28:31], v[8:11], v[56:71]
    ds_read_b128 v[20:23], v4 offset:16896
    ds_read_b128 v[36:39], v5 offset:21504
    v_mfma_f32_32x32x16_bf16 v[72:87], v[24:27], v[12:15], v[72:87]
    v_mfma_f32_32x32x16_bf16 v[88:103], v[28:31], v[12:15], v[88:103]
    s_waitcnt lgkmcnt(2)
    v_mfma_f32_32x32x16_bf16 v[40:55], v[32:35], v[16:19], v[40:55]
    ds_read_b128 v[8:11], v3 offset:24576
    ds_read_b128 v[24:27], v5 offset:24576
    s_waitcnt lgkmcnt(2)
    v_mfma_f32_32x32x16_bf16 v[56:71], v[36:39], v[16:19], v[56:71]
    ds_read_b128 v[12:15], v3 offset:25088
    ds_read_b128 v[28:31], v5 offset:25600
    v_mfma_f32_32x32x16_bf16 v[72:87], v[32:35], v[20:23], v[72:87]
    v_mfma_f32_32x32x16_bf16 v[88:103], v[36:39], v[20:23], v[88:103]
    s_barrier
    s_waitcnt lgkmcnt(2)
    v_mfma_f32_32x32x16_bf16 v[40:55], v[24:27], v[8:11], v[40:55]
    ds_read_b128 v[16:19], v4 offset:24576
    ds_read_b128 v[32:35], v5 offset:28672
    s_waitcnt lgkmcnt(2)
    v_mfma_f32_32x32x16_bf16 v[56:71], v[28:31], v[8:11], v[56:71]
    ds_read_b128 v[20:23], v4 offset:25088
    ds_read_b128 v[36:39], v5 offset:29696
    v_mfma_f32_32x32x16_bf16 v[72:87], v[24:27], v[12:15], v[72:87]
    v_mfma_f32_32x32x16_bf16 v[88:103], v[28:31], v[12:15], v[88:103]
    s_waitcnt lgkmcnt(2)
    v_mfma_f32_32x32x16_bf16 v[40:55], v[32:35], v[16:19], v[40:55]
    ds_read_b128 v[8:11], v3 offset:32768
    ds_read_b128 v[24:27], v5 offset:32768
    s_waitcnt lgkmcnt(2)
    v_mfma_f32_32x32x16_bf16 v[56:71], v[36:39], v[16:19], v[56:71]
    ds_read_b128 v[12:15], v3 offset:33280
    ds_read_b128 v[28:31], v5 offset:33792
    v_mfma_f32_32x32x16_bf16 v[72:87], v[32:35], v[20:23], v[72:87]
    v_mfma_f32_32x32x16_bf16 v[88:103], v[36:39], v[20:23], v[88:103]
    s_barrier
    s_waitcnt lgkmcnt(2)
    v_mfma_f32_32x32x16_bf16 v[40:55], v[24:27], v[8:11], v[40:55]
    ds_read_b128 v[16:19], v4 offset:32768
    ds_read_b128 v[32:35], v5 offset:36864
    s_waitcnt lgkmcnt(2)
    v_mfma_f32_32x32x16_bf16 v[56:71], v[28:31], v[8:11], v[56:71]
    ds_read_b128 v[20:23], v4 offset:33280
    ds_read_b128 v[36:39], v5 offset:37888
    v_mfma_f32_32x32x16_bf16 v[72:87], v[24:27], v[12:15], v[72:87]
    v_mfma_f32_32x32x16_bf16 v[88:103], v[28:31], v[12:15], v[88:103]
    s_waitcnt lgkmcnt(2)
    v_mfma_f32_32x32x16_bf16 v[40:55], v[32:35], v[16:19], v[40:55]
    ds_read_b128 v[8:11], v107 offset:0
    ds_read_b128 v[24:27], v6 offset:0
    s_waitcnt lgkmcnt(2)
    v_mfma_f32_32x32x16_bf16 v[56:71], v[36:39], v[16:19], v[56:71]
    ds_read_b128 v[12:15], v107 offset:512
    ds_read_b128 v[28:31], v6 offset:1024
    v_mfma_f32_32x32x16_bf16 v[72:87], v[32:35], v[20:23], v[72:87]
    v_mfma_f32_32x32x16_bf16 v[88:103], v[36:39], v[20:23], v[88:103]
    s_barrier
    s_waitcnt lgkmcnt(2)
    v_mfma_f32_32x32x16_bf16 v[40:55], v[24:27], v[8:11], v[40:55]
    ds_read_b128 v[16:19], v108 offset:0
    ds_read_b128 v[32:35], v6 offset:4096
    s_waitcnt lgkmcnt(2)
    v_mfma_f32_32x32x16_bf16 v[56:71], v[28:31], v[8:11], v[56:71]
    ds_read_b128 v[20:23], v108 offset:512
    ds_read_b128 v[36:39], v6 offset:5120
    v_mfma_f32_32x32x16_bf16 v[72:87], v[24:27], v[12:15], v[72:87]
    v_mfma_f32_32x32x16_bf16 v[88:103], v[28:31], v[12:15], v[88:103]
    s_waitcnt lgkmcnt(2)
    v_mfma_f32_32x32x16_bf16 v[40:55], v[32:35], v[16:19], v[40:55]
    ds_read_b128 v[8:11], v107 offset:8192
    ds_read_b128 v[24:27], v6 offset:8192
    s_waitcnt lgkmcnt(2)
    v_mfma_f32_32x32x16_bf16 v[56:71], v[36:39], v[16:19], v[56:71]
    ds_read_b128 v[12:15], v107 offset:8704
    ds_read_b128 v[28:31], v6 offset:9216
    v_mfma_f32_32x32x16_bf16 v[72:87], v[32:35], v[20:23], v[72:87]
    v_mfma_f32_32x32x16_bf16 v[88:103], v[36:39], v[20:23], v[88:103]
    s_barrier
    s_waitcnt lgkmcnt(2)
    v_mfma_f32_32x32x16_bf16 v[40:55], v[24:27], v[8:11], v[40:55]
    ds_read_b128 v[16:19], v108 offset:8192
    ds_read_b128 v[32:35], v6 offset:12288
    s_waitcnt lgkmcnt(2)
    v_mfma_f32_32x32x16_bf16 v[56:71], v[28:31], v[8:11], v[56:71]
    ds_read_b128 v[20:23], v108 offset:8704
    ds_read_b128 v[36:39], v6 offset:13312
    v_mfma_f32_32x32x16_bf16 v[72:87], v[24:27], v[12:15], v[72:87]
    v_mfma_f32_32x32x16_bf16 v[88:103], v[28:31], v[12:15], v[88:103]
    s_waitcnt lgkmcnt(2)
    v_mfma_f32_32x32x16_bf16 v[40:55], v[32:35], v[16:19], v[40:55]
    ds_read_b128 v[8:11], v107 offset:16384
    ds_read_b128 v[24:27], v6 offset:16384
    s_waitcnt lgkmcnt(2)
    v_mfma_f32_32x32x16_bf16 v[56:71], v[36:39], v[16:19], v[56:71]
    ds_read_b128 v[12:15], v107 offset:16896
    ds_read_b128 v[28:31], v6 offset:17408
    v_mfma_f32_32x32x16_bf16 v[72:87], v[32:35], v[20:23], v[72:87]
    v_mfma_f32_32x32x16_bf16 v[88:103], v[36:39], v[20:23], v[88:103]
    s_barrier
    s_waitcnt lgkmcnt(2)
    v_mfma_f32_32x32x16_bf16 v[40:55], v[24:27], v[8:11], v[40:55]
    ds_read_b128 v[16:19], v108 offset:16384
    ds_read_b128 v[32:35], v6 offset:20480
    s_waitcnt lgkmcnt(2)
    v_mfma_f32_32x32x16_bf16 v[56:71], v[28:31], v[8:11], v[56:71]
    ds_read_b128 v[20:23], v108 offset:16896
    ds_read_b128 v[36:39], v6 offset:21504
    v_mfma_f32_32x32x16_bf16 v[72:87], v[24:27], v[12:15], v[72:87]
    v_mfma_f32_32x32x16_bf16 v[88:103], v[28:31], v[12:15], v[88:103]
    s_waitcnt lgkmcnt(2)
    v_mfma_f32_32x32x16_bf16 v[40:55], v[32:35], v[16:19], v[40:55]
    ds_read_b128 v[8:11], v107 offset:24576
    ds_read_b128 v[24:27], v6 offset:24576
    s_waitcnt lgkmcnt(2)
    v_mfma_f32_32x32x16_bf16 v[56:71], v[36:39], v[16:19], v[56:71]
    ds_read_b128 v[12:15], v107 offset:25088
    ds_read_b128 v[28:31], v6 offset:25600
    v_mfma_f32_32x32x16_bf16 v[72:87], v[32:35], v[20:23], v[72:87]
    v_mfma_f32_32x32x16_bf16 v[88:103], v[36:39], v[20:23], v[88:103]
    s_barrier
    s_waitcnt lgkmcnt(2)
    v_mfma_f32_32x32x16_bf16 v[40:55], v[24:27], v[8:11], v[40:55]
    ds_read_b128 v[16:19], v108 offset:24576
    ds_read_b128 v[32:35], v6 offset:28672
    s_waitcnt lgkmcnt(2)
    v_mfma_f32_32x32x16_bf16 v[56:71], v[28:31], v[8:11], v[56:71]
    ds_read_b128 v[20:23], v108 offset:25088
    ds_read_b128 v[36:39], v6 offset:29696
    v_mfma_f32_32x32x16_bf16 v[72:87], v[24:27], v[12:15], v[72:87]
    v_mfma_f32_32x32x16_bf16 v[88:103], v[28:31], v[12:15], v[88:103]
    s_waitcnt lgkmcnt(2)
    v_mfma_f32_32x32x16_bf16 v[40:55], v[32:35], v[16:19], v[40:55]
    s_waitcnt lgkmcnt(0)
    v_mfma_f32_32x32x16_bf16 v[56:71], v[36:39], v[16:19], v[56:71]
    v_mfma_f32_32x32x16_bf16 v[72:87], v[32:35], v[20:23], v[72:87]
    v_mfma_f32_32x32x16_bf16 v[88:103], v[36:39], v[20:23], v[88:103]
    s_lshl_b32 s30, s28, 9
    v_lshlrev_b32 v109, 3, v105
    v_add_u32 v109, s30, v109
    s_lshl_b32 s30, s29, 8
    v_lshlrev_b32 v110, 4, v106
    v_add_u32 v110, s30, v110
    ds_read_b64 v[112:113], v109 offset:1024
    ds_read_b64 v[114:115], v109 offset:1280
    ds_read_b128 v[8:11], v110 offset:2048
    ds_read_b128 v[12:15], v110 offset:2080
    ds_read_b128 v[16:19], v110 offset:2112
    ds_read_b128 v[20:23], v110 offset:2144
    ds_read_b128 v[24:27], v110 offset:2176
    ds_read_b128 v[28:31], v110 offset:2208
    ds_read_b128 v[32:35], v110 offset:2240
    ds_read_b128 v[36:39], v110 offset:2272
    s_cmp_ge_u32 s9, 4
    s_cselect_b32 s35, 1, 0
    s_cmp_eq_u32 s9, 13
    s_cselect_b32 s35, s29, s35
    s_mov_b32 s36, 0x3eae1a93
    s_cmp_eq_u32 s35, 1
    s_cselect_b32 s36, 1.0, s36
    s_and_b32 s34, s9, 3
    s_lshl_b32 s37, s34, 2
    s_lshl_b32 s38, s29, 1
    s_add_u32 s37, s37, s38
    s_lshl_b32 s37, s37, 1
    s_mul_i32 s38, s37, 151552
    s_lshl_b32 s39, s37, 16
    s_add_u32 s39, s39, 5242880
    s_add_u32 s38, s38, 0
    s_mov_b32 s40, 151552
    s_cmp_eq_u32 s35, 1
    s_cselect_b32 s38, s38, s39
    s_cselect_b32 s40, s40, 65536
    s_lshl_b32 s39, s31, 10
    s_add_u32 s38, s38, s39
    s_add_u32 s39, s38, s40
    s_lshl_b32 s43, s40, 1
    s_waitcnt lgkmcnt(8)
    v_mul_f32 v108, s36, v112
    v_mul_f32 v110, s36, v113
    v_mul_f32 v112, s36, v114
    v_mul_f32 v114, s36, v115
    v_mov_b32 v109, v108
    v_mov_b32 v111, v110
    v_mov_b32 v113, v112
    v_mov_b32 v115, v114
    s_waitcnt lgkmcnt(0)
    s_cmp_eq_u32 s9, 13
    s_cbranch_scc1 L_apq_exst
    v_pk_mul_f32 v[116:117], v[110:111], v[8:9]
    v_pk_fma_f32 v[40:41], v[40:41], v[108:109], v[116:117] neg_lo:[0,0,1] neg_hi:[0,0,1]
    v_pk_mul_f32 v[116:117], v[110:111], v[10:11]
    v_pk_fma_f32 v[42:43], v[42:43], v[108:109], v[116:117] neg_lo:[0,0,1] neg_hi:[0,0,1]
    v_pk_mul_f32 v[116:117], v[110:111], v[12:13]
    v_pk_fma_f32 v[44:45], v[44:45], v[108:109], v[116:117] neg_lo:[0,0,1] neg_hi:[0,0,1]
    v_pk_mul_f32 v[116:117], v[110:111], v[14:15]
    v_pk_fma_f32 v[46:47], v[46:47], v[108:109], v[116:117] neg_lo:[0,0,1] neg_hi:[0,0,1]
    v_pk_mul_f32 v[116:117], v[110:111], v[16:17]
    v_pk_fma_f32 v[48:49], v[48:49], v[108:109], v[116:117] neg_lo:[0,0,1] neg_hi:[0,0,1]
    v_pk_mul_f32 v[116:117], v[110:111], v[18:19]
    v_pk_fma_f32 v[50:51], v[50:51], v[108:109], v[116:117] neg_lo:[0,0,1] neg_hi:[0,0,1]
    v_pk_mul_f32 v[116:117], v[110:111], v[20:21]
    v_pk_fma_f32 v[52:53], v[52:53], v[108:109], v[116:117] neg_lo:[0,0,1] neg_hi:[0,0,1]
    v_pk_mul_f32 v[116:117], v[110:111], v[22:23]
    v_pk_fma_f32 v[54:55], v[54:55], v[108:109], v[116:117] neg_lo:[0,0,1] neg_hi:[0,0,1]
    v_cvt_pk_bf16_f32 v40, v40, v41
    v_cvt_pk_bf16_f32 v41, v42, v43
    v_cvt_pk_bf16_f32 v42, v44, v45
    v_cvt_pk_bf16_f32 v43, v46, v47
    v_cvt_pk_bf16_f32 v44, v48, v49
    v_cvt_pk_bf16_f32 v45, v50, v51
    v_cvt_pk_bf16_f32 v46, v52, v53
    v_cvt_pk_bf16_f32 v47, v54, v55
    buffer_store_dwordx4 v[40:43], v7, s[4:7], s38 offen offset:0 nt
    buffer_store_dwordx4 v[44:47], v7, s[4:7], s39 offen offset:0 nt
    v_pk_mul_f32 v[116:117], v[114:115], v[8:9]
    v_pk_fma_f32 v[72:73], v[72:73], v[112:113], v[116:117] neg_lo:[0,0,1] neg_hi:[0,0,1]
    v_pk_mul_f32 v[116:117], v[114:115], v[10:11]
    v_pk_fma_f32 v[74:75], v[74:75], v[112:113], v[116:117] neg_lo:[0,0,1] neg_hi:[0,0,1]
    v_pk_mul_f32 v[116:117], v[114:115], v[12:13]
    v_pk_fma_f32 v[76:77], v[76:77], v[112:113], v[116:117] neg_lo:[0,0,1] neg_hi:[0,0,1]
    v_pk_mul_f32 v[116:117], v[114:115], v[14:15]
    v_pk_fma_f32 v[78:79], v[78:79], v[112:113], v[116:117] neg_lo:[0,0,1] neg_hi:[0,0,1]
    v_pk_mul_f32 v[116:117], v[114:115], v[16:17]
    v_pk_fma_f32 v[80:81], v[80:81], v[112:113], v[116:117] neg_lo:[0,0,1] neg_hi:[0,0,1]
    v_pk_mul_f32 v[116:117], v[114:115], v[18:19]
    v_pk_fma_f32 v[82:83], v[82:83], v[112:113], v[116:117] neg_lo:[0,0,1] neg_hi:[0,0,1]
    v_pk_mul_f32 v[116:117], v[114:115], v[20:21]
    v_pk_fma_f32 v[84:85], v[84:85], v[112:113], v[116:117] neg_lo:[0,0,1] neg_hi:[0,0,1]
    v_pk_mul_f32 v[116:117], v[114:115], v[22:23]
    v_pk_fma_f32 v[86:87], v[86:87], v[112:113], v[116:117] neg_lo:[0,0,1] neg_hi:[0,0,1]
    v_cvt_pk_bf16_f32 v72, v72, v73
    v_cvt_pk_bf16_f32 v73, v74, v75
    v_cvt_pk_bf16_f32 v74, v76, v77
    v_cvt_pk_bf16_f32 v75, v78, v79
    v_cvt_pk_bf16_f32 v76, v80, v81
    v_cvt_pk_bf16_f32 v77, v82, v83
    v_cvt_pk_bf16_f32 v78, v84, v85
    v_cvt_pk_bf16_f32 v79, v86, v87
    buffer_store_dwordx4 v[72:75], v7, s[4:7], s38 offen offset:1024 nt
    buffer_store_dwordx4 v[76:79], v7, s[4:7], s39 offen offset:1024 nt
    s_add_u32 s38, s38, s43
    s_add_u32 s39, s39, s43
    v_pk_mul_f32 v[116:117], v[110:111], v[24:25]
    v_pk_fma_f32 v[56:57], v[56:57], v[108:109], v[116:117] neg_lo:[0,0,1] neg_hi:[0,0,1]
    v_pk_mul_f32 v[116:117], v[110:111], v[26:27]
    v_pk_fma_f32 v[58:59], v[58:59], v[108:109], v[116:117] neg_lo:[0,0,1] neg_hi:[0,0,1]
    v_pk_mul_f32 v[116:117], v[110:111], v[28:29]
    v_pk_fma_f32 v[60:61], v[60:61], v[108:109], v[116:117] neg_lo:[0,0,1] neg_hi:[0,0,1]
    v_pk_mul_f32 v[116:117], v[110:111], v[30:31]
    v_pk_fma_f32 v[62:63], v[62:63], v[108:109], v[116:117] neg_lo:[0,0,1] neg_hi:[0,0,1]
    v_pk_mul_f32 v[116:117], v[110:111], v[32:33]
    v_pk_fma_f32 v[64:65], v[64:65], v[108:109], v[116:117] neg_lo:[0,0,1] neg_hi:[0,0,1]
    v_pk_mul_f32 v[116:117], v[110:111], v[34:35]
    v_pk_fma_f32 v[66:67], v[66:67], v[108:109], v[116:117] neg_lo:[0,0,1] neg_hi:[0,0,1]
    v_pk_mul_f32 v[116:117], v[110:111], v[36:37]
    v_pk_fma_f32 v[68:69], v[68:69], v[108:109], v[116:117] neg_lo:[0,0,1] neg_hi:[0,0,1]
    v_pk_mul_f32 v[116:117], v[110:111], v[38:39]
    v_pk_fma_f32 v[70:71], v[70:71], v[108:109], v[116:117] neg_lo:[0,0,1] neg_hi:[0,0,1]
    v_cvt_pk_bf16_f32 v56, v56, v57
    v_cvt_pk_bf16_f32 v57, v58, v59
    v_cvt_pk_bf16_f32 v58, v60, v61
    v_cvt_pk_bf16_f32 v59, v62, v63
    v_cvt_pk_bf16_f32 v60, v64, v65
    v_cvt_pk_bf16_f32 v61, v66, v67
    v_cvt_pk_bf16_f32 v62, v68, v69
    v_cvt_pk_bf16_f32 v63, v70, v71
    buffer_store_dwordx4 v[56:59], v7, s[4:7], s38 offen offset:0 nt
    buffer_store_dwordx4 v[60:63], v7, s[4:7], s39 offen offset:0 nt
    v_pk_mul_f32 v[116:117], v[114:115], v[24:25]
    v_pk_fma_f32 v[88:89], v[88:89], v[112:113], v[116:117] neg_lo:[0,0,1] neg_hi:[0,0,1]
    v_pk_mul_f32 v[116:117], v[114:115], v[26:27]
    v_pk_fma_f32 v[90:91], v[90:91], v[112:113], v[116:117] neg_lo:[0,0,1] neg_hi:[0,0,1]
    v_pk_mul_f32 v[116:117], v[114:115], v[28:29]
    v_pk_fma_f32 v[92:93], v[92:93], v[112:113], v[116:117] neg_lo:[0,0,1] neg_hi:[0,0,1]
    v_pk_mul_f32 v[116:117], v[114:115], v[30:31]
    v_pk_fma_f32 v[94:95], v[94:95], v[112:113], v[116:117] neg_lo:[0,0,1] neg_hi:[0,0,1]
    v_pk_mul_f32 v[116:117], v[114:115], v[32:33]
    v_pk_fma_f32 v[96:97], v[96:97], v[112:113], v[116:117] neg_lo:[0,0,1] neg_hi:[0,0,1]
    v_pk_mul_f32 v[116:117], v[114:115], v[34:35]
    v_pk_fma_f32 v[98:99], v[98:99], v[112:113], v[116:117] neg_lo:[0,0,1] neg_hi:[0,0,1]
    v_pk_mul_f32 v[116:117], v[114:115], v[36:37]
    v_pk_fma_f32 v[100:101], v[100:101], v[112:113], v[116:117] neg_lo:[0,0,1] neg_hi:[0,0,1]
    v_pk_mul_f32 v[116:117], v[114:115], v[38:39]
    v_pk_fma_f32 v[102:103], v[102:103], v[112:113], v[116:117] neg_lo:[0,0,1] neg_hi:[0,0,1]
    v_cvt_pk_bf16_f32 v88, v88, v89
    v_cvt_pk_bf16_f32 v89, v90, v91
    v_cvt_pk_bf16_f32 v90, v92, v93
    v_cvt_pk_bf16_f32 v91, v94, v95
    v_cvt_pk_bf16_f32 v92, v96, v97
    v_cvt_pk_bf16_f32 v93, v98, v99
    v_cvt_pk_bf16_f32 v94, v100, v101
    v_cvt_pk_bf16_f32 v95, v102, v103
    buffer_store_dwordx4 v[88:91], v7, s[4:7], s38 offen offset:1024 nt
    buffer_store_dwordx4 v[92:95], v7, s[4:7], s39 offen offset:1024 nt
    s_branch L_apq_end
L_apq_exst:
    v_pk_mul_f32 v[116:117], v[110:111], v[8:9]
    v_pk_fma_f32 v[40:41], v[40:41], v[108:109], v[116:117] neg_lo:[0,0,1] neg_hi:[0,0,1]
    v_pk_mul_f32 v[116:117], v[110:111], v[10:11]
    v_pk_fma_f32 v[42:43], v[42:43], v[108:109], v[116:117] neg_lo:[0,0,1] neg_hi:[0,0,1]
    v_pk_mul_f32 v[116:117], v[110:111], v[12:13]
    v_pk_fma_f32 v[44:45], v[44:45], v[108:109], v[116:117] neg_lo:[0,0,1] neg_hi:[0,0,1]
    v_pk_mul_f32 v[116:117], v[110:111], v[14:15]
    v_pk_fma_f32 v[46:47], v[46:47], v[108:109], v[116:117] neg_lo:[0,0,1] neg_hi:[0,0,1]
    v_pk_mul_f32 v[116:117], v[110:111], v[16:17]
    v_pk_fma_f32 v[48:49], v[48:49], v[108:109], v[116:117] neg_lo:[0,0,1] neg_hi:[0,0,1]
    v_pk_mul_f32 v[116:117], v[110:111], v[18:19]
    v_pk_fma_f32 v[50:51], v[50:51], v[108:109], v[116:117] neg_lo:[0,0,1] neg_hi:[0,0,1]
    v_pk_mul_f32 v[116:117], v[110:111], v[20:21]
    v_pk_fma_f32 v[52:53], v[52:53], v[108:109], v[116:117] neg_lo:[0,0,1] neg_hi:[0,0,1]
    v_pk_mul_f32 v[116:117], v[110:111], v[22:23]
    v_pk_fma_f32 v[54:55], v[54:55], v[108:109], v[116:117] neg_lo:[0,0,1] neg_hi:[0,0,1]
    v_pk_mul_f32 v[116:117], v[114:115], v[8:9]
    v_pk_fma_f32 v[72:73], v[72:73], v[112:113], v[116:117] neg_lo:[0,0,1] neg_hi:[0,0,1]
    v_pk_mul_f32 v[116:117], v[114:115], v[10:11]
    v_pk_fma_f32 v[74:75], v[74:75], v[112:113], v[116:117] neg_lo:[0,0,1] neg_hi:[0,0,1]
    v_pk_mul_f32 v[116:117], v[114:115], v[12:13]
    v_pk_fma_f32 v[76:77], v[76:77], v[112:113], v[116:117] neg_lo:[0,0,1] neg_hi:[0,0,1]
    v_pk_mul_f32 v[116:117], v[114:115], v[14:15]
    v_pk_fma_f32 v[78:79], v[78:79], v[112:113], v[116:117] neg_lo:[0,0,1] neg_hi:[0,0,1]
    v_pk_mul_f32 v[116:117], v[114:115], v[16:17]
    v_pk_fma_f32 v[80:81], v[80:81], v[112:113], v[116:117] neg_lo:[0,0,1] neg_hi:[0,0,1]
    v_pk_mul_f32 v[116:117], v[114:115], v[18:19]
    v_pk_fma_f32 v[82:83], v[82:83], v[112:113], v[116:117] neg_lo:[0,0,1] neg_hi:[0,0,1]
    v_pk_mul_f32 v[116:117], v[114:115], v[20:21]
    v_pk_fma_f32 v[84:85], v[84:85], v[112:113], v[116:117] neg_lo:[0,0,1] neg_hi:[0,0,1]
    v_pk_mul_f32 v[116:117], v[114:115], v[22:23]
    v_pk_fma_f32 v[86:87], v[86:87], v[112:113], v[116:117] neg_lo:[0,0,1] neg_hi:[0,0,1]
    v_pk_mul_f32 v[116:117], v[110:111], v[24:25]
    v_pk_fma_f32 v[56:57], v[56:57], v[108:109], v[116:117] neg_lo:[0,0,1] neg_hi:[0,0,1]
    v_pk_mul_f32 v[116:117], v[110:111], v[26:27]
    v_pk_fma_f32 v[58:59], v[58:59], v[108:109], v[116:117] neg_lo:[0,0,1] neg_hi:[0,0,1]
    v_pk_mul_f32 v[116:117], v[110:111], v[28:29]
    v_pk_fma_f32 v[60:61], v[60:61], v[108:109], v[116:117] neg_lo:[0,0,1] neg_hi:[0,0,1]
    v_pk_mul_f32 v[116:117], v[110:111], v[30:31]
    v_pk_fma_f32 v[62:63], v[62:63], v[108:109], v[116:117] neg_lo:[0,0,1] neg_hi:[0,0,1]
    v_pk_mul_f32 v[116:117], v[110:111], v[32:33]
    v_pk_fma_f32 v[64:65], v[64:65], v[108:109], v[116:117] neg_lo:[0,0,1] neg_hi:[0,0,1]
    v_pk_mul_f32 v[116:117], v[110:111], v[34:35]
    v_pk_fma_f32 v[66:67], v[66:67], v[108:109], v[116:117] neg_lo:[0,0,1] neg_hi:[0,0,1]
    v_pk_mul_f32 v[116:117], v[110:111], v[36:37]
    v_pk_fma_f32 v[68:69], v[68:69], v[108:109], v[116:117] neg_lo:[0,0,1] neg_hi:[0,0,1]
    v_pk_mul_f32 v[116:117], v[110:111], v[38:39]
    v_pk_fma_f32 v[70:71], v[70:71], v[108:109], v[116:117] neg_lo:[0,0,1] neg_hi:[0,0,1]
    v_pk_mul_f32 v[116:117], v[114:115], v[24:25]
    v_pk_fma_f32 v[88:89], v[88:89], v[112:113], v[116:117] neg_lo:[0,0,1] neg_hi:[0,0,1]
    v_pk_mul_f32 v[116:117], v[114:115], v[26:27]
    v_pk_fma_f32 v[90:91], v[90:91], v[112:113], v[116:117] neg_lo:[0,0,1] neg_hi:[0,0,1]
    v_pk_mul_f32 v[116:117], v[114:115], v[28:29]
    v_pk_fma_f32 v[92:93], v[92:93], v[112:113], v[116:117] neg_lo:[0,0,1] neg_hi:[0,0,1]
    v_pk_mul_f32 v[116:117], v[114:115], v[30:31]
    v_pk_fma_f32 v[94:95], v[94:95], v[112:113], v[116:117] neg_lo:[0,0,1] neg_hi:[0,0,1]
    v_pk_mul_f32 v[116:117], v[114:115], v[32:33]
    v_pk_fma_f32 v[96:97], v[96:97], v[112:113], v[116:117] neg_lo:[0,0,1] neg_hi:[0,0,1]
    v_pk_mul_f32 v[116:117], v[114:115], v[34:35]
    v_pk_fma_f32 v[98:99], v[98:99], v[112:113], v[116:117] neg_lo:[0,0,1] neg_hi:[0,0,1]
    v_pk_mul_f32 v[116:117], v[114:115], v[36:37]
    v_pk_fma_f32 v[100:101], v[100:101], v[112:113], v[116:117] neg_lo:[0,0,1] neg_hi:[0,0,1]
    v_pk_mul_f32 v[116:117], v[114:115], v[38:39]
    v_pk_fma_f32 v[102:103], v[102:103], v[112:113], v[116:117] neg_lo:[0,0,1] neg_hi:[0,0,1]
    v_cvt_pk_bf16_f32 v8, v40, v41
    v_cvt_pk_bf16_f32 v10, v42, v43
    v_cvt_pk_bf16_f32 v12, v44, v45
    v_cvt_pk_bf16_f32 v14, v46, v47
    v_cvt_pk_bf16_f32 v16, v48, v49
    v_cvt_pk_bf16_f32 v18, v50, v51
    v_cvt_pk_bf16_f32 v20, v52, v53
    v_cvt_pk_bf16_f32 v22, v54, v55
    v_cvt_pk_bf16_f32 v9, v72, v73
    v_cvt_pk_bf16_f32 v11, v74, v75
    v_cvt_pk_bf16_f32 v13, v76, v77
    v_cvt_pk_bf16_f32 v15, v78, v79
    v_cvt_pk_bf16_f32 v17, v80, v81
    v_cvt_pk_bf16_f32 v19, v82, v83
    v_cvt_pk_bf16_f32 v21, v84, v85
    v_cvt_pk_bf16_f32 v23, v86, v87
    v_cvt_pk_bf16_f32 v24, v56, v57
    v_cvt_pk_bf16_f32 v26, v58, v59
    v_cvt_pk_bf16_f32 v28, v60, v61
    v_cvt_pk_bf16_f32 v30, v62, v63
    v_cvt_pk_bf16_f32 v32, v64, v65
    v_cvt_pk_bf16_f32 v34, v66, v67
    v_cvt_pk_bf16_f32 v36, v68, v69
    v_cvt_pk_bf16_f32 v38, v70, v71
    v_cvt_pk_bf16_f32 v25, v88, v89
    v_cvt_pk_bf16_f32 v27, v90, v91
    v_cvt_pk_bf16_f32 v29, v92, v93
    v_cvt_pk_bf16_f32 v31, v94, v95
    v_cvt_pk_bf16_f32 v33, v96, v97
    v_cvt_pk_bf16_f32 v35, v98, v99
    v_cvt_pk_bf16_f32 v37, v100, v101
    v_cvt_pk_bf16_f32 v39, v102, v103
    s_mov_b32 s40, 151552
    s_cmp_eq_u32 s35, 1
    s_cselect_b32 s40, s40, 8192
    v_mul_lo_u32 v112, v106, s40
    v_lshlrev_b32 v112, 1, v112
    s_cbranch_scc1 L_apq_exk
    v_lshl_add_u32 v112, v105, 3, v112
    s_lshl_b32 s38, s31, 7
    s_add_u32 s38, s38, 7340032
    s_branch L_apq_exj
L_apq_exk:
    v_lshl_add_u32 v112, v105, 4, v112
    s_lshr_b32 s38, s31, 2
    s_lshl_b32 s38, s38, 9
    s_and_b32 s39, s31, 3
    s_lshl_b32 s39, s39, 2
    s_add_u32 s38, s38, s39
    s_add_u32 s38, s38, 65536
L_apq_exj:
    s_mul_i32 s42, s40, 0
    s_add_u32 s42, s42, s38
    buffer_store_dwordx2 v[8:9], v112, s[4:7], s42 offen
    s_mul_i32 s42, s40, 1
    s_add_u32 s42, s42, s38
    buffer_store_dwordx2 v[10:11], v112, s[4:7], s42 offen
    s_mul_i32 s42, s40, 4
    s_add_u32 s42, s42, s38
    buffer_store_dwordx2 v[12:13], v112, s[4:7], s42 offen
    s_mul_i32 s42, s40, 5
    s_add_u32 s42, s42, s38
    buffer_store_dwordx2 v[14:15], v112, s[4:7], s42 offen
    s_mul_i32 s42, s40, 8
    s_add_u32 s42, s42, s38
    buffer_store_dwordx2 v[16:17], v112, s[4:7], s42 offen
    s_mul_i32 s42, s40, 9
    s_add_u32 s42, s42, s38
    buffer_store_dwordx2 v[18:19], v112, s[4:7], s42 offen
    s_mul_i32 s42, s40, 12
    s_add_u32 s42, s42, s38
    buffer_store_dwordx2 v[20:21], v112, s[4:7], s42 offen
    s_mul_i32 s42, s40, 13
    s_add_u32 s42, s42, s38
    buffer_store_dwordx2 v[22:23], v112, s[4:7], s42 offen
    s_mul_i32 s42, s40, 16
    s_add_u32 s42, s42, s38
    buffer_store_dwordx2 v[24:25], v112, s[4:7], s42 offen
    s_mul_i32 s42, s40, 17
    s_add_u32 s42, s42, s38
    buffer_store_dwordx2 v[26:27], v112, s[4:7], s42 offen
    s_mul_i32 s42, s40, 20
    s_add_u32 s42, s42, s38
    buffer_store_dwordx2 v[28:29], v112, s[4:7], s42 offen
    s_mul_i32 s42, s40, 21
    s_add_u32 s42, s42, s38
    buffer_store_dwordx2 v[30:31], v112, s[4:7], s42 offen
    s_mul_i32 s42, s40, 24
    s_add_u32 s42, s42, s38
    buffer_store_dwordx2 v[32:33], v112, s[4:7], s42 offen
    s_mul_i32 s42, s40, 25
    s_add_u32 s42, s42, s38
    buffer_store_dwordx2 v[34:35], v112, s[4:7], s42 offen
    s_mul_i32 s42, s40, 28
    s_add_u32 s42, s42, s38
    buffer_store_dwordx2 v[36:37], v112, s[4:7], s42 offen
    s_mul_i32 s42, s40, 29
    s_add_u32 s42, s42, s38
    buffer_store_dwordx2 v[38:39], v112, s[4:7], s42 offen
    s_branch L_apq_end
L_apq_vt:
    s_barrier
    s_barrier
    ds_read_b128 v[8:11], v3 offset:0
    ds_read_b128 v[24:27], v5 offset:0
    ds_read_b128 v[12:15], v3 offset:512
    ds_read_b128 v[28:31], v5 offset:1024
    s_waitcnt lgkmcnt(2)
    v_mfma_f32_32x32x16_bf16 v[40:55], v[8:11], v[24:27], 0
    ds_read_b128 v[16:19], v4 offset:0
    ds_read_b128 v[32:35], v5 offset:4096
    s_waitcnt lgkmcnt(2)
    v_mfma_f32_32x32x16_bf16 v[56:71], v[8:11], v[28:31], 0
    ds_read_b128 v[20:23], v4 offset:512
    ds_read_b128 v[36:39], v5 offset:5120
    v_mfma_f32_32x32x16_bf16 v[72:87], v[12:15], v[24:27], 0
    v_mfma_f32_32x32x16_bf16 v[88:103], v[12:15], v[28:31], 0
    s_waitcnt lgkmcnt(2)
    v_mfma_f32_32x32x16_bf16 v[40:55], v[16:19], v[32:35], v[40:55]
    ds_read_b128 v[8:11], v3 offset:8192
    ds_read_b128 v[24:27], v5 offset:8192
    s_waitcnt lgkmcnt(2)
    v_mfma_f32_32x32x16_bf16 v[56:71], v[16:19], v[36:39], v[56:71]
    ds_read_b128 v[12:15], v3 offset:8704
    ds_read_b128 v[28:31], v5 offset:9216
    v_mfma_f32_32x32x16_bf16 v[72:87], v[20:23], v[32:35], v[72:87]
    v_mfma_f32_32x32x16_bf16 v[88:103], v[20:23], v[36:39], v[88:103]
    s_barrier
    s_waitcnt lgkmcnt(2)
    v_mfma_f32_32x32x16_bf16 v[40:55], v[8:11], v[24:27], v[40:55]
    ds_read_b128 v[16:19], v4 offset:8192
    ds_read_b128 v[32:35], v5 offset:12288
    s_waitcnt lgkmcnt(2)
    v_mfma_f32_32x32x16_bf16 v[56:71], v[8:11], v[28:31], v[56:71]
    ds_read_b128 v[20:23], v4 offset:8704
    ds_read_b128 v[36:39], v5 offset:13312
    v_mfma_f32_32x32x16_bf16 v[72:87], v[12:15], v[24:27], v[72:87]
    v_mfma_f32_32x32x16_bf16 v[88:103], v[12:15], v[28:31], v[88:103]
    s_waitcnt lgkmcnt(2)
    v_mfma_f32_32x32x16_bf16 v[40:55], v[16:19], v[32:35], v[40:55]
    ds_read_b128 v[8:11], v3 offset:16384
    ds_read_b128 v[24:27], v5 offset:16384
    s_waitcnt lgkmcnt(2)
    v_mfma_f32_32x32x16_bf16 v[56:71], v[16:19], v[36:39], v[56:71]
    ds_read_b128 v[12:15], v3 offset:16896
    ds_read_b128 v[28:31], v5 offset:17408
    v_mfma_f32_32x32x16_bf16 v[72:87], v[20:23], v[32:35], v[72:87]
    v_mfma_f32_32x32x16_bf16 v[88:103], v[20:23], v[36:39], v[88:103]
    s_barrier
    s_waitcnt lgkmcnt(2)
    v_mfma_f32_32x32x16_bf16 v[40:55], v[8:11], v[24:27], v[40:55]
    ds_read_b128 v[16:19], v4 offset:16384
    ds_read_b128 v[32:35], v5 offset:20480
    s_waitcnt lgkmcnt(2)
    v_mfma_f32_32x32x16_bf16 v[56:71], v[8:11], v[28:31], v[56:71]
    ds_read_b128 v[20:23], v4 offset:16896
    ds_read_b128 v[36:39], v5 offset:21504
    v_mfma_f32_32x32x16_bf16 v[72:87], v[12:15], v[24:27], v[72:87]
    v_mfma_f32_32x32x16_bf16 v[88:103], v[12:15], v[28:31], v[88:103]
    s_waitcnt lgkmcnt(2)
    v_mfma_f32_32x32x16_bf16 v[40:55], v[16:19], v[32:35], v[40:55]
    ds_read_b128 v[8:11], v3 offset:24576
    ds_read_b128 v[24:27], v5 offset:24576
    s_waitcnt lgkmcnt(2)
    v_mfma_f32_32x32x16_bf16 v[56:71], v[16:19], v[36:39], v[56:71]
    ds_read_b128 v[12:15], v3 offset:25088
    ds_read_b128 v[28:31], v5 offset:25600
    v_mfma_f32_32x32x16_bf16 v[72:87], v[20:23], v[32:35], v[72:87]
    v_mfma_f32_32x32x16_bf16 v[88:103], v[20:23], v[36:39], v[88:103]
    s_barrier
    s_waitcnt lgkmcnt(2)
    v_mfma_f32_32x32x16_bf16 v[40:55], v[8:11], v[24:27], v[40:55]
    ds_read_b128 v[16:19], v4 offset:24576
    ds_read_b128 v[32:35], v5 offset:28672
    s_waitcnt lgkmcnt(2)
    v_mfma_f32_32x32x16_bf16 v[56:71], v[8:11], v[28:31], v[56:71]
    ds_read_b128 v[20:23], v4 offset:25088
    ds_read_b128 v[36:39], v5 offset:29696
    v_mfma_f32_32x32x16_bf16 v[72:87], v[12:15], v[24:27], v[72:87]
    v_mfma_f32_32x32x16_bf16 v[88:103], v[12:15], v[28:31], v[88:103]
    s_waitcnt lgkmcnt(2)
    v_mfma_f32_32x32x16_bf16 v[40:55], v[16:19], v[32:35], v[40:55]
    ds_read_b128 v[8:11], v3 offset:32768
    ds_read_b128 v[24:27], v5 offset:32768
    s_waitcnt lgkmcnt(2)
    v_mfma_f32_32x32x16_bf16 v[56:71], v[16:19], v[36:39], v[56:71]
    ds_read_b128 v[12:15], v3 offset:33280
    ds_read_b128 v[28:31], v5 offset:33792
    v_mfma_f32_32x32x16_bf16 v[72:87], v[20:23], v[32:35], v[72:87]
    v_mfma_f32_32x32x16_bf16 v[88:103], v[20:23], v[36:39], v[88:103]
    s_barrier
    s_waitcnt lgkmcnt(2)
    v_mfma_f32_32x32x16_bf16 v[40:55], v[8:11], v[24:27], v[40:55]
    ds_read_b128 v[16:19], v4 offset:32768
    ds_read_b128 v[32:35], v5 offset:36864
    s_waitcnt lgkmcnt(2)
    v_mfma_f32_32x32x16_bf16 v[56:71], v[8:11], v[28:31], v[56:71]
    ds_read_b128 v[20:23], v4 offset:33280
    ds_read_b128 v[36:39], v5 offset:37888
    v_mfma_f32_32x32x16_bf16 v[72:87], v[12:15], v[24:27], v[72:87]
    v_mfma_f32_32x32x16_bf16 v[88:103], v[12:15], v[28:31], v[88:103]
    s_waitcnt lgkmcnt(2)
    v_mfma_f32_32x32x16_bf16 v[40:55], v[16:19], v[32:35], v[40:55]
    ds_read_b128 v[8:11], v107 offset:0
    ds_read_b128 v[24:27], v6 offset:0
    s_waitcnt lgkmcnt(2)
    v_mfma_f32_32x32x16_bf16 v[56:71], v[16:19], v[36:39], v[56:71]
    ds_read_b128 v[12:15], v107 offset:512
    ds_read_b128 v[28:31], v6 offset:1024
    v_mfma_f32_32x32x16_bf16 v[72:87], v[20:23], v[32:35], v[72:87]
    v_mfma_f32_32x32x16_bf16 v[88:103], v[20:23], v[36:39], v[88:103]
    s_barrier
    s_waitcnt lgkmcnt(2)
    v_mfma_f32_32x32x16_bf16 v[40:55], v[8:11], v[24:27], v[40:55]
    ds_read_b128 v[16:19], v108 offset:0
    ds_read_b128 v[32:35], v6 offset:4096
    s_waitcnt lgkmcnt(2)
    v_mfma_f32_32x32x16_bf16 v[56:71], v[8:11], v[28:31], v[56:71]
    ds_read_b128 v[20:23], v108 offset:512
    ds_read_b128 v[36:39], v6 offset:5120
    v_mfma_f32_32x32x16_bf16 v[72:87], v[12:15], v[24:27], v[72:87]
    v_mfma_f32_32x32x16_bf16 v[88:103], v[12:15], v[28:31], v[88:103]
    s_waitcnt lgkmcnt(2)
    v_mfma_f32_32x32x16_bf16 v[40:55], v[16:19], v[32:35], v[40:55]
    ds_read_b128 v[8:11], v107 offset:8192
    ds_read_b128 v[24:27], v6 offset:8192
    s_waitcnt lgkmcnt(2)
    v_mfma_f32_32x32x16_bf16 v[56:71], v[16:19], v[36:39], v[56:71]
    ds_read_b128 v[12:15], v107 offset:8704
    ds_read_b128 v[28:31], v6 offset:9216
    v_mfma_f32_32x32x16_bf16 v[72:87], v[20:23], v[32:35], v[72:87]
    v_mfma_f32_32x32x16_bf16 v[88:103], v[20:23], v[36:39], v[88:103]
    s_barrier
    s_waitcnt lgkmcnt(2)
    v_mfma_f32_32x32x16_bf16 v[40:55], v[8:11], v[24:27], v[40:55]
    ds_read_b128 v[16:19], v108 offset:8192
    ds_read_b128 v[32:35], v6 offset:12288
    s_waitcnt lgkmcnt(2)
    v_mfma_f32_32x32x16_bf16 v[56:71], v[8:11], v[28:31], v[56:71]
    ds_read_b128 v[20:23], v108 offset:8704
    ds_read_b128 v[36:39], v6 offset:13312
    v_mfma_f32_32x32x16_bf16 v[72:87], v[12:15], v[24:27], v[72:87]
    v_mfma_f32_32x32x16_bf16 v[88:103], v[12:15], v[28:31], v[88:103]
    s_waitcnt lgkmcnt(2)
    v_mfma_f32_32x32x16_bf16 v[40:55], v[16:19], v[32:35], v[40:55]
    ds_read_b128 v[8:11], v107 offset:16384
    ds_read_b128 v[24:27], v6 offset:16384
    s_waitcnt lgkmcnt(2)
    v_mfma_f32_32x32x16_bf16 v[56:71], v[16:19], v[36:39], v[56:71]
    ds_read_b128 v[12:15], v107 offset:16896
    ds_read_b128 v[28:31], v6 offset:17408
    v_mfma_f32_32x32x16_bf16 v[72:87], v[20:23], v[32:35], v[72:87]
    v_mfma_f32_32x32x16_bf16 v[88:103], v[20:23], v[36:39], v[88:103]
    s_barrier
    s_waitcnt lgkmcnt(2)
    v_mfma_f32_32x32x16_bf16 v[40:55], v[8:11], v[24:27], v[40:55]
    ds_read_b128 v[16:19], v108 offset:16384
    ds_read_b128 v[32:35], v6 offset:20480
    s_waitcnt lgkmcnt(2)
    v_mfma_f32_32x32x16_bf16 v[56:71], v[8:11], v[28:31], v[56:71]
    ds_read_b128 v[20:23], v108 offset:16896
    ds_read_b128 v[36:39], v6 offset:21504
    v_mfma_f32_32x32x16_bf16 v[72:87], v[12:15], v[24:27], v[72:87]
    v_mfma_f32_32x32x16_bf16 v[88:103], v[12:15], v[28:31], v[88:103]
    s_waitcnt lgkmcnt(2)
    v_mfma_f32_32x32x16_bf16 v[40:55], v[16:19], v[32:35], v[40:55]
    ds_read_b128 v[8:11], v107 offset:24576
    ds_read_b128 v[24:27], v6 offset:24576
    s_waitcnt lgkmcnt(2)
    v_mfma_f32_32x32x16_bf16 v[56:71], v[16:19], v[36:39], v[56:71]
    ds_read_b128 v[12:15], v107 offset:25088
    ds_read_b128 v[28:31], v6 offset:25600
    v_mfma_f32_32x32x16_bf16 v[72:87], v[20:23], v[32:35], v[72:87]
    v_mfma_f32_32x32x16_bf16 v[88:103], v[20:23], v[36:39], v[88:103]
    s_barrier
    s_waitcnt lgkmcnt(2)
    v_mfma_f32_32x32x16_bf16 v[40:55], v[8:11], v[24:27], v[40:55]
    ds_read_b128 v[16:19], v108 offset:24576
    ds_read_b128 v[32:35], v6 offset:28672
    s_waitcnt lgkmcnt(2)
    v_mfma_f32_32x32x16_bf16 v[56:71], v[8:11], v[28:31], v[56:71]
    ds_read_b128 v[20:23], v108 offset:25088
    ds_read_b128 v[36:39], v6 offset:29696
    v_mfma_f32_32x32x16_bf16 v[72:87], v[12:15], v[24:27], v[72:87]
    v_mfma_f32_32x32x16_bf16 v[88:103], v[12:15], v[28:31], v[88:103]
    s_waitcnt lgkmcnt(2)
    v_mfma_f32_32x32x16_bf16 v[40:55], v[16:19], v[32:35], v[40:55]
    ds_read_b128 v[8:11], v3 offset:0
    ds_read_b128 v[24:27], v5 offset:0
    s_waitcnt lgkmcnt(2)
    v_mfma_f32_32x32x16_bf16 v[56:71], v[16:19], v[36:39], v[56:71]
    ds_read_b128 v[12:15], v3 offset:512
    ds_read_b128 v[28:31], v5 offset:1024
    v_mfma_f32_32x32x16_bf16 v[72:87], v[20:23], v[32:35], v[72:87]
    v_mfma_f32_32x32x16_bf16 v[88:103], v[20:23], v[36:39], v[88:103]
    s_barrier
    s_waitcnt lgkmcnt(2)
    v_mfma_f32_32x32x16_bf16 v[40:55], v[8:11], v[24:27], v[40:55]
    ds_read_b128 v[16:19], v4 offset:0
    ds_read_b128 v[32:35], v5 offset:4096
    s_waitcnt lgkmcnt(2)
    v_mfma_f32_32x32x16_bf16 v[56:71], v[8:11], v[28:31], v[56:71]
    ds_read_b128 v[20:23], v4 offset:512
    ds_read_b128 v[36:39], v5 offset:5120
    v_mfma_f32_32x32x16_bf16 v[72:87], v[12:15], v[24:27], v[72:87]
    v_mfma_f32_32x32x16_bf16 v[88:103], v[12:15], v[28:31], v[88:103]
    s_waitcnt lgkmcnt(2)
    v_mfma_f32_32x32x16_bf16 v[40:55], v[16:19], v[32:35], v[40:55]
    ds_read_b128 v[8:11], v3 offset:8192
    ds_read_b128 v[24:27], v5 offset:8192
    s_waitcnt lgkmcnt(2)
    v_mfma_f32_32x32x16_bf16 v[56:71], v[16:19], v[36:39], v[56:71]
    ds_read_b128 v[12:15], v3 offset:8704
    ds_read_b128 v[28:31], v5 offset:9216
    v_mfma_f32_32x32x16_bf16 v[72:87], v[20:23], v[32:35], v[72:87]
    v_mfma_f32_32x32x16_bf16 v[88:103], v[20:23], v[36:39], v[88:103]
    s_barrier
    s_waitcnt lgkmcnt(2)
    v_mfma_f32_32x32x16_bf16 v[40:55], v[8:11], v[24:27], v[40:55]
    ds_read_b128 v[16:19], v4 offset:8192
    ds_read_b128 v[32:35], v5 offset:12288
    s_waitcnt lgkmcnt(2)
    v_mfma_f32_32x32x16_bf16 v[56:71], v[8:11], v[28:31], v[56:71]
    ds_read_b128 v[20:23], v4 offset:8704
    ds_read_b128 v[36:39], v5 offset:13312
    v_mfma_f32_32x32x16_bf16 v[72:87], v[12:15], v[24:27], v[72:87]
    v_mfma_f32_32x32x16_bf16 v[88:103], v[12:15], v[28:31], v[88:103]
    s_waitcnt lgkmcnt(2)
    v_mfma_f32_32x32x16_bf16 v[40:55], v[16:19], v[32:35], v[40:55]
    ds_read_b128 v[8:11], v3 offset:16384
    ds_read_b128 v[24:27], v5 offset:16384
    s_waitcnt lgkmcnt(2)
    v_mfma_f32_32x32x16_bf16 v[56:71], v[16:19], v[36:39], v[56:71]
    ds_read_b128 v[12:15], v3 offset:16896
    ds_read_b128 v[28:31], v5 offset:17408
    v_mfma_f32_32x32x16_bf16 v[72:87], v[20:23], v[32:35], v[72:87]
    v_mfma_f32_32x32x16_bf16 v[88:103], v[20:23], v[36:39], v[88:103]
    s_barrier
    s_waitcnt lgkmcnt(2)
    v_mfma_f32_32x32x16_bf16 v[40:55], v[8:11], v[24:27], v[40:55]
    ds_read_b128 v[16:19], v4 offset:16384
    ds_read_b128 v[32:35], v5 offset:20480
    s_waitcnt lgkmcnt(2)
    v_mfma_f32_32x32x16_bf16 v[56:71], v[8:11], v[28:31], v[56:71]
    ds_read_b128 v[20:23], v4 offset:16896
    ds_read_b128 v[36:39], v5 offset:21504
    v_mfma_f32_32x32x16_bf16 v[72:87], v[12:15], v[24:27], v[72:87]
    v_mfma_f32_32x32x16_bf16 v[88:103], v[12:15], v[28:31], v[88:103]
    s_waitcnt lgkmcnt(2)
    v_mfma_f32_32x32x16_bf16 v[40:55], v[16:19], v[32:35], v[40:55]
    ds_read_b128 v[8:11], v3 offset:24576
    ds_read_b128 v[24:27], v5 offset:24576
    s_waitcnt lgkmcnt(2)
    v_mfma_f32_32x32x16_bf16 v[56:71], v[16:19], v[36:39], v[56:71]
    ds_read_b128 v[12:15], v3 offset:25088
    ds_read_b128 v[28:31], v5 offset:25600
    v_mfma_f32_32x32x16_bf16 v[72:87], v[20:23], v[32:35], v[72:87]
    v_mfma_f32_32x32x16_bf16 v[88:103], v[20:23], v[36:39], v[88:103]
    s_barrier
    s_waitcnt lgkmcnt(2)
    v_mfma_f32_32x32x16_bf16 v[40:55], v[8:11], v[24:27], v[40:55]
    ds_read_b128 v[16:19], v4 offset:24576
    ds_read_b128 v[32:35], v5 offset:28672
    s_waitcnt lgkmcnt(2)
    v_mfma_f32_32x32x16_bf16 v[56:71], v[8:11], v[28:31], v[56:71]
    ds_read_b128 v[20:23], v4 offset:25088
    ds_read_b128 v[36:39], v5 offset:29696
    v_mfma_f32_32x32x16_bf16 v[72:87], v[12:15], v[24:27], v[72:87]
    v_mfma_f32_32x32x16_bf16 v[88:103], v[12:15], v[28:31], v[88:103]
    s_waitcnt lgkmcnt(2)
    v_mfma_f32_32x32x16_bf16 v[40:55], v[16:19], v[32:35], v[40:55]
    ds_read_b128 v[8:11], v3 offset:32768
    ds_read_b128 v[24:27], v5 offset:32768
    s_waitcnt lgkmcnt(2)
    v_mfma_f32_32x32x16_bf16 v[56:71], v[16:19], v[36:39], v[56:71]
    ds_read_b128 v[12:15], v3 offset:33280
    ds_read_b128 v[28:31], v5 offset:33792
    v_mfma_f32_32x32x16_bf16 v[72:87], v[20:23], v[32:35], v[72:87]
    v_mfma_f32_32x32x16_bf16 v[88:103], v[20:23], v[36:39], v[88:103]
    s_barrier
    s_waitcnt lgkmcnt(2)
    v_mfma_f32_32x32x16_bf16 v[40:55], v[8:11], v[24:27], v[40:55]
    ds_read_b128 v[16:19], v4 offset:32768
    ds_read_b128 v[32:35], v5 offset:36864
    s_waitcnt lgkmcnt(2)
    v_mfma_f32_32x32x16_bf16 v[56:71], v[8:11], v[28:31], v[56:71]
    ds_read_b128 v[20:23], v4 offset:33280
    ds_read_b128 v[36:39], v5 offset:37888
    v_mfma_f32_32x32x16_bf16 v[72:87], v[12:15], v[24:27], v[72:87]
    v_mfma_f32_32x32x16_bf16 v[88:103], v[12:15], v[28:31], v[88:103]
    s_waitcnt lgkmcnt(2)
    v_mfma_f32_32x32x16_bf16 v[40:55], v[16:19], v[32:35], v[40:55]
    ds_read_b128 v[8:11], v107 offset:0
    ds_read_b128 v[24:27], v6 offset:0
    s_waitcnt lgkmcnt(2)
    v_mfma_f32_32x32x16_bf16 v[56:71], v[16:19], v[36:39], v[56:71]
    ds_read_b128 v[12:15], v107 offset:512
    ds_read_b128 v[28:31], v6 offset:1024
    v_mfma_f32_32x32x16_bf16 v[72:87], v[20:23], v[32:35], v[72:87]
    v_mfma_f32_32x32x16_bf16 v[88:103], v[20:23], v[36:39], v[88:103]
    s_barrier
    s_waitcnt lgkmcnt(2)
    v_mfma_f32_32x32x16_bf16 v[40:55], v[8:11], v[24:27], v[40:55]
    ds_read_b128 v[16:19], v108 offset:0
    ds_read_b128 v[32:35], v6 offset:4096
    s_waitcnt lgkmcnt(2)
    v_mfma_f32_32x32x16_bf16 v[56:71], v[8:11], v[28:31], v[56:71]
    ds_read_b128 v[20:23], v108 offset:512
    ds_read_b128 v[36:39], v6 offset:5120
    v_mfma_f32_32x32x16_bf16 v[72:87], v[12:15], v[24:27], v[72:87]
    v_mfma_f32_32x32x16_bf16 v[88:103], v[12:15], v[28:31], v[88:103]
    s_waitcnt lgkmcnt(2)
    v_mfma_f32_32x32x16_bf16 v[40:55], v[16:19], v[32:35], v[40:55]
    ds_read_b128 v[8:11], v107 offset:8192
    ds_read_b128 v[24:27], v6 offset:8192
    s_waitcnt lgkmcnt(2)
    v_mfma_f32_32x32x16_bf16 v[56:71], v[16:19], v[36:39], v[56:71]
    ds_read_b128 v[12:15], v107 offset:8704
    ds_read_b128 v[28:31], v6 offset:9216
    v_mfma_f32_32x32x16_bf16 v[72:87], v[20:23], v[32:35], v[72:87]
    v_mfma_f32_32x32x16_bf16 v[88:103], v[20:23], v[36:39], v[88:103]
    s_barrier
    s_waitcnt lgkmcnt(2)
    v_mfma_f32_32x32x16_bf16 v[40:55], v[8:11], v[24:27], v[40:55]
    ds_read_b128 v[16:19], v108 offset:8192
    ds_read_b128 v[32:35], v6 offset:12288
    s_waitcnt lgkmcnt(2)
    v_mfma_f32_32x32x16_bf16 v[56:71], v[8:11], v[28:31], v[56:71]
    ds_read_b128 v[20:23], v108 offset:8704
    ds_read_b128 v[36:39], v6 offset:13312
    v_mfma_f32_32x32x16_bf16 v[72:87], v[12:15], v[24:27], v[72:87]
    v_mfma_f32_32x32x16_bf16 v[88:103], v[12:15], v[28:31], v[88:103]
    s_waitcnt lgkmcnt(2)
    v_mfma_f32_32x32x16_bf16 v[40:55], v[16:19], v[32:35], v[40:55]
    ds_read_b128 v[8:11], v107 offset:16384
    ds_read_b128 v[24:27], v6 offset:16384
    s_waitcnt lgkmcnt(2)
    v_mfma_f32_32x32x16_bf16 v[56:71], v[16:19], v[36:39], v[56:71]
    ds_read_b128 v[12:15], v107 offset:16896
    ds_read_b128 v[28:31], v6 offset:17408
    v_mfma_f32_32x32x16_bf16 v[72:87], v[20:23], v[32:35], v[72:87]
    v_mfma_f32_32x32x16_bf16 v[88:103], v[20:23], v[36:39], v[88:103]
    s_barrier
    s_waitcnt lgkmcnt(2)
    v_mfma_f32_32x32x16_bf16 v[40:55], v[8:11], v[24:27], v[40:55]
    ds_read_b128 v[16:19], v108 offset:16384
    ds_read_b128 v[32:35], v6 offset:20480
    s_waitcnt lgkmcnt(2)
    v_mfma_f32_32x32x16_bf16 v[56:71], v[8:11], v[28:31], v[56:71]
    ds_read_b128 v[20:23], v108 offset:16896
    ds_read_b128 v[36:39], v6 offset:21504
    v_mfma_f32_32x32x16_bf16 v[72:87], v[12:15], v[24:27], v[72:87]
    v_mfma_f32_32x32x16_bf16 v[88:103], v[12:15], v[28:31], v[88:103]
    s_waitcnt lgkmcnt(2)
    v_mfma_f32_32x32x16_bf16 v[40:55], v[16:19], v[32:35], v[40:55]
    ds_read_b128 v[8:11], v107 offset:24576
    ds_read_b128 v[24:27], v6 offset:24576
    s_waitcnt lgkmcnt(2)
    v_mfma_f32_32x32x16_bf16 v[56:71], v[16:19], v[36:39], v[56:71]
    ds_read_b128 v[12:15], v107 offset:25088
    ds_read_b128 v[28:31], v6 offset:25600
    v_mfma_f32_32x32x16_bf16 v[72:87], v[20:23], v[32:35], v[72:87]
    v_mfma_f32_32x32x16_bf16 v[88:103], v[20:23], v[36:39], v[88:103]
    s_barrier
    s_waitcnt lgkmcnt(2)
    v_mfma_f32_32x32x16_bf16 v[40:55], v[8:11], v[24:27], v[40:55]
    ds_read_b128 v[16:19], v108 offset:24576
    ds_read_b128 v[32:35], v6 offset:28672
    s_waitcnt lgkmcnt(2)
    v_mfma_f32_32x32x16_bf16 v[56:71], v[8:11], v[28:31], v[56:71]
    ds_read_b128 v[20:23], v108 offset:25088
    ds_read_b128 v[36:39], v6 offset:29696
    v_mfma_f32_32x32x16_bf16 v[72:87], v[12:15], v[24:27], v[72:87]
    v_mfma_f32_32x32x16_bf16 v[88:103], v[12:15], v[28:31], v[88:103]
    s_waitcnt lgkmcnt(2)
    v_mfma_f32_32x32x16_bf16 v[40:55], v[16:19], v[32:35], v[40:55]
    s_waitcnt lgkmcnt(0)
    v_mfma_f32_32x32x16_bf16 v[56:71], v[16:19], v[36:39], v[56:71]
    v_mfma_f32_32x32x16_bf16 v[72:87], v[20:23], v[32:35], v[72:87]
    v_mfma_f32_32x32x16_bf16 v[88:103], v[20:23], v[36:39], v[88:103]
    s_lshl_b32 s30, s29, 8
    v_lshlrev_b32 v109, 2, v105
    v_add_u32 v109, s30, v109
    ds_read_b32 v112, v109 offset:2048
    ds_read_b32 v114, v109 offset:2176
    s_lshl_b32 s30, s28, 8
    v_lshlrev_b32 v110, 4, v106
    v_add_u32 v110, s30, v110
    ds_read_b128 v[8:11], v110 offset:0
    ds_read_b128 v[24:27], v110 offset:512
    ds_read_b128 v[12:15], v110 offset:32
    ds_read_b128 v[28:31], v110 offset:544
    ds_read_b128 v[16:19], v110 offset:64
    ds_read_b128 v[32:35], v110 offset:576
    ds_read_b128 v[20:23], v110 offset:96
    ds_read_b128 v[36:39], v110 offset:608
    s_sub_u32 s34, s9, 8
    s_lshl_b32 s37, s34, 2
    s_lshl_b32 s38, s29, 1
    s_add_u32 s37, s37, s38
    s_lshl_b32 s37, s37, 5
    v_add_u32 v118, s37, v105
    v_add_u32 v118, 0, v118
    v_mul_u32_u24 v119, 3641, v118
    v_lshrrev_b32 v119, 16, v119
    v_mul_u32_u24 v120, 18, v119
    v_sub_u32 v120, v118, v120
    s_mov_b32 s40, 151552
    v_mul_lo_u32 v119, v119, s40
    v_lshl_add_u32 v119, v120, 4, v119
    v_mul_u32_u24 v121, 304, v106
    v_add_u32 v3, v119, v121
    v_cmp_gt_u32 vcc, 576, v118
    s_mov_b64 s[44:45], vcc
    v_cmp_eq_u32 vcc, 17, v120
    s_and_b64 s[46:47], vcc, s[44:45]
    v_add_u32 v118, s37, v105
    v_add_u32 v118, 32, v118
    v_mul_u32_u24 v119, 3641, v118
    v_lshrrev_b32 v119, 16, v119
    v_mul_u32_u24 v120, 18, v119
    v_sub_u32 v120, v118, v120
    s_mov_b32 s40, 151552
    v_mul_lo_u32 v119, v119, s40
    v_lshl_add_u32 v119, v120, 4, v119
    v_mul_u32_u24 v121, 304, v106
    v_add_u32 v4, v119, v121
    v_cmp_gt_u32 vcc, 576, v118
    s_mov_b64 s[48:49], vcc
    v_cmp_eq_u32 vcc, 17, v120
    s_and_b64 s[50:51], vcc, s[48:49]
    s_mul_i32 s38, s31, 1216
    s_add_u32 s38, s38, 73728
    v_mov_b32 v120, 0x3f803f80
    v_mov_b32 v121, 0x3f803f80
    v_mov_b32 v122, 0x3f803f80
    v_mov_b32 v123, 0x3f803f80
    s_waitcnt lgkmcnt(0)
    v_mov_b32 v113, v112
    v_mov_b32 v115, v114
    v_pk_mul_f32 v[116:117], v[24:25], v[112:113]
    v_pk_fma_f32 v[40:41], v[40:41], v[8:9], v[116:117] neg_lo:[0,0,1] neg_hi:[0,0,1]
    v_pk_mul_f32 v[116:117], v[26:27], v[112:113]
    v_pk_fma_f32 v[42:43], v[42:43], v[10:11], v[116:117] neg_lo:[0,0,1] neg_hi:[0,0,1]
    v_pk_mul_f32 v[116:117], v[28:29], v[112:113]
    v_pk_fma_f32 v[44:45], v[44:45], v[12:13], v[116:117] neg_lo:[0,0,1] neg_hi:[0,0,1]
    v_pk_mul_f32 v[116:117], v[30:31], v[112:113]
    v_pk_fma_f32 v[46:47], v[46:47], v[14:15], v[116:117] neg_lo:[0,0,1] neg_hi:[0,0,1]
    v_pk_mul_f32 v[116:117], v[32:33], v[112:113]
    v_pk_fma_f32 v[48:49], v[48:49], v[16:17], v[116:117] neg_lo:[0,0,1] neg_hi:[0,0,1]
    v_pk_mul_f32 v[116:117], v[34:35], v[112:113]
    v_pk_fma_f32 v[50:51], v[50:51], v[18:19], v[116:117] neg_lo:[0,0,1] neg_hi:[0,0,1]
    v_pk_mul_f32 v[116:117], v[36:37], v[112:113]
    v_pk_fma_f32 v[52:53], v[52:53], v[20:21], v[116:117] neg_lo:[0,0,1] neg_hi:[0,0,1]
    v_pk_mul_f32 v[116:117], v[38:39], v[112:113]
    v_pk_fma_f32 v[54:55], v[54:55], v[22:23], v[116:117] neg_lo:[0,0,1] neg_hi:[0,0,1]
    v_cvt_pk_bf16_f32 v40, v40, v41
    v_cvt_pk_bf16_f32 v41, v42, v43
    v_cvt_pk_bf16_f32 v42, v44, v45
    v_cvt_pk_bf16_f32 v43, v46, v47
    v_cvt_pk_bf16_f32 v44, v48, v49
    v_cvt_pk_bf16_f32 v45, v50, v51
    v_cvt_pk_bf16_f32 v46, v52, v53
    v_cvt_pk_bf16_f32 v47, v54, v55
    s_mov_b64 exec, s[44:45]
    buffer_store_dwordx4 v[40:43], v3, s[4:7], s38 offen offset:0 nt
    buffer_store_dwordx4 v[44:47], v3, s[4:7], s38 offen offset:608 nt
    s_mov_b64 exec, -1
    v_pk_mul_f32 v[116:117], v[24:25], v[114:115]
    v_pk_fma_f32 v[56:57], v[56:57], v[8:9], v[116:117] neg_lo:[0,0,1] neg_hi:[0,0,1]
    v_pk_mul_f32 v[116:117], v[26:27], v[114:115]
    v_pk_fma_f32 v[58:59], v[58:59], v[10:11], v[116:117] neg_lo:[0,0,1] neg_hi:[0,0,1]
    v_pk_mul_f32 v[116:117], v[28:29], v[114:115]
    v_pk_fma_f32 v[60:61], v[60:61], v[12:13], v[116:117] neg_lo:[0,0,1] neg_hi:[0,0,1]
    v_pk_mul_f32 v[116:117], v[30:31], v[114:115]
    v_pk_fma_f32 v[62:63], v[62:63], v[14:15], v[116:117] neg_lo:[0,0,1] neg_hi:[0,0,1]
    v_pk_mul_f32 v[116:117], v[32:33], v[114:115]
    v_pk_fma_f32 v[64:65], v[64:65], v[16:17], v[116:117] neg_lo:[0,0,1] neg_hi:[0,0,1]
    v_pk_mul_f32 v[116:117], v[34:35], v[114:115]
    v_pk_fma_f32 v[66:67], v[66:67], v[18:19], v[116:117] neg_lo:[0,0,1] neg_hi:[0,0,1]
    v_pk_mul_f32 v[116:117], v[36:37], v[114:115]
    v_pk_fma_f32 v[68:69], v[68:69], v[20:21], v[116:117] neg_lo:[0,0,1] neg_hi:[0,0,1]
    v_pk_mul_f32 v[116:117], v[38:39], v[114:115]
    v_pk_fma_f32 v[70:71], v[70:71], v[22:23], v[116:117] neg_lo:[0,0,1] neg_hi:[0,0,1]
    v_cvt_pk_bf16_f32 v56, v56, v57
    v_cvt_pk_bf16_f32 v57, v58, v59
    v_cvt_pk_bf16_f32 v58, v60, v61
    v_cvt_pk_bf16_f32 v59, v62, v63
    v_cvt_pk_bf16_f32 v60, v64, v65
    v_cvt_pk_bf16_f32 v61, v66, v67
    v_cvt_pk_bf16_f32 v62, v68, v69
    v_cvt_pk_bf16_f32 v63, v70, v71
    s_mov_b64 exec, s[48:49]
    buffer_store_dwordx4 v[56:59], v4, s[4:7], s38 offen offset:0 nt
    buffer_store_dwordx4 v[60:63], v4, s[4:7], s38 offen offset:608 nt
    s_mov_b64 exec, -1
    ds_read_b128 v[8:11], v110 offset:128
    ds_read_b128 v[24:27], v110 offset:640
    ds_read_b128 v[12:15], v110 offset:160
    ds_read_b128 v[28:31], v110 offset:672
    ds_read_b128 v[16:19], v110 offset:192
    ds_read_b128 v[32:35], v110 offset:704
    ds_read_b128 v[20:23], v110 offset:224
    ds_read_b128 v[36:39], v110 offset:736
    s_waitcnt lgkmcnt(0)
    v_pk_mul_f32 v[116:117], v[24:25], v[112:113]
    v_pk_fma_f32 v[72:73], v[72:73], v[8:9], v[116:117] neg_lo:[0,0,1] neg_hi:[0,0,1]
    v_pk_mul_f32 v[116:117], v[26:27], v[112:113]
    v_pk_fma_f32 v[74:75], v[74:75], v[10:11], v[116:117] neg_lo:[0,0,1] neg_hi:[0,0,1]
    v_pk_mul_f32 v[116:117], v[28:29], v[112:113]
    v_pk_fma_f32 v[76:77], v[76:77], v[12:13], v[116:117] neg_lo:[0,0,1] neg_hi:[0,0,1]
    v_pk_mul_f32 v[116:117], v[30:31], v[112:113]
    v_pk_fma_f32 v[78:79], v[78:79], v[14:15], v[116:117] neg_lo:[0,0,1] neg_hi:[0,0,1]
    v_pk_mul_f32 v[116:117], v[32:33], v[112:113]
    v_pk_fma_f32 v[80:81], v[80:81], v[16:17], v[116:117] neg_lo:[0,0,1] neg_hi:[0,0,1]
    v_pk_mul_f32 v[116:117], v[34:35], v[112:113]
    v_pk_fma_f32 v[82:83], v[82:83], v[18:19], v[116:117] neg_lo:[0,0,1] neg_hi:[0,0,1]
    v_pk_mul_f32 v[116:117], v[36:37], v[112:113]
    v_pk_fma_f32 v[84:85], v[84:85], v[20:21], v[116:117] neg_lo:[0,0,1] neg_hi:[0,0,1]
    v_pk_mul_f32 v[116:117], v[38:39], v[112:113]
    v_pk_fma_f32 v[86:87], v[86:87], v[22:23], v[116:117] neg_lo:[0,0,1] neg_hi:[0,0,1]
    v_cvt_pk_bf16_f32 v72, v72, v73
    v_cvt_pk_bf16_f32 v73, v74, v75
    v_cvt_pk_bf16_f32 v74, v76, v77
    v_cvt_pk_bf16_f32 v75, v78, v79
    v_cvt_pk_bf16_f32 v76, v80, v81
    v_cvt_pk_bf16_f32 v77, v82, v83
    v_cvt_pk_bf16_f32 v78, v84, v85
    v_cvt_pk_bf16_f32 v79, v86, v87
    s_mov_b64 exec, s[44:45]
    buffer_store_dwordx4 v[72:75], v3, s[4:7], s38 offen offset:1216 nt
    buffer_store_dwordx4 v[76:79], v3, s[4:7], s38 offen offset:1824 nt
    s_mov_b64 exec, -1
    v_pk_mul_f32 v[116:117], v[24:25], v[114:115]
    v_pk_fma_f32 v[88:89], v[88:89], v[8:9], v[116:117] neg_lo:[0,0,1] neg_hi:[0,0,1]
    v_pk_mul_f32 v[116:117], v[26:27], v[114:115]
    v_pk_fma_f32 v[90:91], v[90:91], v[10:11], v[116:117] neg_lo:[0,0,1] neg_hi:[0,0,1]
    v_pk_mul_f32 v[116:117], v[28:29], v[114:115]
    v_pk_fma_f32 v[92:93], v[92:93], v[12:13], v[116:117] neg_lo:[0,0,1] neg_hi:[0,0,1]
    v_pk_mul_f32 v[116:117], v[30:31], v[114:115]
    v_pk_fma_f32 v[94:95], v[94:95], v[14:15], v[116:117] neg_lo:[0,0,1] neg_hi:[0,0,1]
    v_pk_mul_f32 v[116:117], v[32:33], v[114:115]
    v_pk_fma_f32 v[96:97], v[96:97], v[16:17], v[116:117] neg_lo:[0,0,1] neg_hi:[0,0,1]
    v_pk_mul_f32 v[116:117], v[34:35], v[114:115]
    v_pk_fma_f32 v[98:99], v[98:99], v[18:19], v[116:117] neg_lo:[0,0,1] neg_hi:[0,0,1]
    v_pk_mul_f32 v[116:117], v[36:37], v[114:115]
    v_pk_fma_f32 v[100:101], v[100:101], v[20:21], v[116:117] neg_lo:[0,0,1] neg_hi:[0,0,1]
    v_pk_mul_f32 v[116:117], v[38:39], v[114:115]
    v_pk_fma_f32 v[102:103], v[102:103], v[22:23], v[116:117] neg_lo:[0,0,1] neg_hi:[0,0,1]
    v_cvt_pk_bf16_f32 v88, v88, v89
    v_cvt_pk_bf16_f32 v89, v90, v91
    v_cvt_pk_bf16_f32 v90, v92, v93
    v_cvt_pk_bf16_f32 v91, v94, v95
    v_cvt_pk_bf16_f32 v92, v96, v97
    v_cvt_pk_bf16_f32 v93, v98, v99
    v_cvt_pk_bf16_f32 v94, v100, v101
    v_cvt_pk_bf16_f32 v95, v102, v103
    s_mov_b64 exec, s[48:49]
    buffer_store_dwordx4 v[88:91], v4, s[4:7], s38 offen offset:1216 nt
    buffer_store_dwordx4 v[92:95], v4, s[4:7], s38 offen offset:1824 nt
    s_mov_b64 exec, -1
L_apq_end:
L_ap_fin:
L_ap_quit:
    s_endpgm
L_apa_slow:
    s_lshl_b32 s19, s28, 12
    v_subrev_u32 v109, s19, v109
    s_mul_i32 s19, s28, 38912
    v_subrev_u32 v110, s19, v110
    v_mov_b32 v116, 0xff800000
    v_mov_b32 v44, 0
    v_mov_b32 v45, 0
    v_mov_b32 v46, 0
    v_mov_b32 v47, 0
    v_mov_b32 v48, 0
    v_mov_b32 v49, 0
    v_mov_b32 v50, 0
    v_mov_b32 v51, 0
    v_mov_b32 v52, 0
    v_mov_b32 v53, 0
    v_mov_b32 v54, 0
    v_mov_b32 v55, 0
    v_mov_b32 v56, 0
    v_mov_b32 v57, 0
    v_mov_b32 v58, 0
    v_mov_b32 v59, 0
    s_mov_b32 s20, 0
    s_mov_b32 s29, s14
L_apa_sloop:
    ds_read_b128 v[24:27], v109
    buffer_load_dwordx4 v[20:23], v3, s[4:7], s29 offen offset:0
    ds_read_b128 v[28:31], v110 offset:0
    ds_read_b128 v[32:35], v110 offset:608
    s_waitcnt vmcnt(0) lgkmcnt(0)
    v_mfma_f32_32x32x16_bf16 v[76:91], v[20:23], v[4:7], 0
    v_mfma_f32_32x32x8bf16_1k v[76:91], v[24:25], v[12:13], v[76:91]
    s_nop 15
    s_nop 7
    v_max3_f32 v112, v76, v77, v78
    v_max3_f32 v112, v112, v79, v80
    v_max3_f32 v112, v112, v81, v82
    v_max3_f32 v112, v112, v83, v84
    v_max3_f32 v112, v112, v85, v86
    v_max3_f32 v112, v112, v87, v88
    v_max3_f32 v112, v112, v89, v90
    v_max_f32 v112, v112, v91
    s_nop 1
    v_mov_b32 v113, v112
    s_nop 1
    v_permlane32_swap_b32 v113, v112
    s_nop 1
    v_max3_f32 v112, v112, v113, v116
    v_sub_f32 v113, v116, v112
    v_exp_f32 v113, v113
    v_mov_b32 v116, v112
    v_sub_f32 v76, v76, v116
    v_sub_f32 v77, v77, v116
    v_sub_f32 v78, v78, v116
    v_sub_f32 v79, v79, v116
    v_sub_f32 v80, v80, v116
    v_sub_f32 v81, v81, v116
    v_sub_f32 v82, v82, v116
    v_sub_f32 v83, v83, v116
    v_sub_f32 v84, v84, v116
    v_sub_f32 v85, v85, v116
    v_sub_f32 v86, v86, v116
    v_sub_f32 v87, v87, v116
    v_sub_f32 v88, v88, v116
    v_sub_f32 v89, v89, v116
    v_sub_f32 v90, v90, v116
    v_sub_f32 v91, v91, v116
    v_exp_f32 v76, v76
    v_exp_f32 v77, v77
    v_exp_f32 v78, v78
    v_exp_f32 v79, v79
    v_exp_f32 v80, v80
    v_exp_f32 v81, v81
    v_exp_f32 v82, v82
    v_exp_f32 v83, v83
    v_exp_f32 v84, v84
    v_exp_f32 v85, v85
    v_exp_f32 v86, v86
    v_exp_f32 v87, v87
    v_exp_f32 v88, v88
    v_exp_f32 v89, v89
    v_exp_f32 v90, v90
    v_exp_f32 v91, v91
    v_mul_f32 v44, v44, v113
    v_mul_f32 v45, v45, v113
    v_mul_f32 v46, v46, v113
    v_mul_f32 v47, v47, v113
    v_mul_f32 v48, v48, v113
    v_mul_f32 v49, v49, v113
    v_mul_f32 v50, v50, v113
    v_mul_f32 v51, v51, v113
    v_mul_f32 v52, v52, v113
    v_mul_f32 v53, v53, v113
    v_mul_f32 v54, v54, v113
    v_mul_f32 v55, v55, v113
    v_mul_f32 v56, v56, v113
    v_mul_f32 v57, v57, v113
    v_mul_f32 v58, v58, v113
    v_mul_f32 v59, v59, v113
    v_cvt_pk_bf16_f32 v36, v76, v77
    v_cvt_pk_bf16_f32 v37, v78, v79
    v_cvt_pk_bf16_f32 v38, v80, v81
    v_cvt_pk_bf16_f32 v39, v82, v83
    v_cvt_pk_bf16_f32 v40, v84, v85
    v_cvt_pk_bf16_f32 v41, v86, v87
    v_cvt_pk_bf16_f32 v42, v88, v89
    v_cvt_pk_bf16_f32 v43, v90, v91
    s_nop 1
    v_mfma_f32_32x32x16_bf16 v[44:59], v[28:31], v[36:39], v[44:59]
    v_mfma_f32_32x32x16_bf16 v[44:59], v[32:35], v[40:43], v[44:59]
    s_nop 15
    s_nop 3
    buffer_load_dwordx4 v[20:23], v3, s[4:7], s29 offen offset:1024
    ds_read_b128 v[28:31], v110 offset:1216
    ds_read_b128 v[32:35], v110 offset:1824
    s_waitcnt vmcnt(0) lgkmcnt(0)
    v_mfma_f32_32x32x16_bf16 v[76:91], v[20:23], v[4:7], 0
    v_mfma_f32_32x32x8bf16_1k v[76:91], v[24:25], v[14:15], v[76:91]
    s_nop 15
    s_nop 7
    v_max3_f32 v112, v76, v77, v78
    v_max3_f32 v112, v112, v79, v80
    v_max3_f32 v112, v112, v81, v82
    v_max3_f32 v112, v112, v83, v84
    v_max3_f32 v112, v112, v85, v86
    v_max3_f32 v112, v112, v87, v88
    v_max3_f32 v112, v112, v89, v90
    v_max_f32 v112, v112, v91
    s_nop 1
    v_mov_b32 v113, v112
    s_nop 1
    v_permlane32_swap_b32 v113, v112
    s_nop 1
    v_max3_f32 v112, v112, v113, v116
    v_sub_f32 v113, v116, v112
    v_exp_f32 v113, v113
    v_mov_b32 v116, v112
    v_sub_f32 v76, v76, v116
    v_sub_f32 v77, v77, v116
    v_sub_f32 v78, v78, v116
    v_sub_f32 v79, v79, v116
    v_sub_f32 v80, v80, v116
    v_sub_f32 v81, v81, v116
    v_sub_f32 v82, v82, v116
    v_sub_f32 v83, v83, v116
    v_sub_f32 v84, v84, v116
    v_sub_f32 v85, v85, v116
    v_sub_f32 v86, v86, v116
    v_sub_f32 v87, v87, v116
    v_sub_f32 v88, v88, v116
    v_sub_f32 v89, v89, v116
    v_sub_f32 v90, v90, v116
    v_sub_f32 v91, v91, v116
    v_exp_f32 v76, v76
    v_exp_f32 v77, v77
    v_exp_f32 v78, v78
    v_exp_f32 v79, v79
    v_exp_f32 v80, v80
    v_exp_f32 v81, v81
    v_exp_f32 v82, v82
    v_exp_f32 v83, v83
    v_exp_f32 v84, v84
    v_exp_f32 v85, v85
    v_exp_f32 v86, v86
    v_exp_f32 v87, v87
    v_exp_f32 v88, v88
    v_exp_f32 v89, v89
    v_exp_f32 v90, v90
    v_exp_f32 v91, v91
    v_mul_f32 v44, v44, v113
    v_mul_f32 v45, v45, v113
    v_mul_f32 v46, v46, v113
    v_mul_f32 v47, v47, v113
    v_mul_f32 v48, v48, v113
    v_mul_f32 v49, v49, v113
    v_mul_f32 v50, v50, v113
    v_mul_f32 v51, v51, v113
    v_mul_f32 v52, v52, v113
    v_mul_f32 v53, v53, v113
    v_mul_f32 v54, v54, v113
    v_mul_f32 v55, v55, v113
    v_mul_f32 v56, v56, v113
    v_mul_f32 v57, v57, v113
    v_mul_f32 v58, v58, v113
    v_mul_f32 v59, v59, v113
    v_cvt_pk_bf16_f32 v36, v76, v77
    v_cvt_pk_bf16_f32 v37, v78, v79
    v_cvt_pk_bf16_f32 v38, v80, v81
    v_cvt_pk_bf16_f32 v39, v82, v83
    v_cvt_pk_bf16_f32 v40, v84, v85
    v_cvt_pk_bf16_f32 v41, v86, v87
    v_cvt_pk_bf16_f32 v42, v88, v89
    v_cvt_pk_bf16_f32 v43, v90, v91
    s_nop 1
    v_mfma_f32_32x32x16_bf16 v[44:59], v[28:31], v[36:39], v[44:59]
    v_mfma_f32_32x32x16_bf16 v[44:59], v[32:35], v[40:43], v[44:59]
    s_nop 15
    s_nop 3
    buffer_load_dwordx4 v[20:23], v3, s[4:7], s29 offen offset:2048
    ds_read_b128 v[28:31], v110 offset:2432
    ds_read_b128 v[32:35], v110 offset:3040
    s_waitcnt vmcnt(0) lgkmcnt(0)
    v_mfma_f32_32x32x16_bf16 v[76:91], v[20:23], v[4:7], 0
    v_mfma_f32_32x32x8bf16_1k v[76:91], v[26:27], v[12:13], v[76:91]
    s_nop 15
    s_nop 7
    v_max3_f32 v112, v76, v77, v78
    v_max3_f32 v112, v112, v79, v80
    v_max3_f32 v112, v112, v81, v82
    v_max3_f32 v112, v112, v83, v84
    v_max3_f32 v112, v112, v85, v86
    v_max3_f32 v112, v112, v87, v88
    v_max3_f32 v112, v112, v89, v90
    v_max_f32 v112, v112, v91
    s_nop 1
    v_mov_b32 v113, v112
    s_nop 1
    v_permlane32_swap_b32 v113, v112
    s_nop 1
    v_max3_f32 v112, v112, v113, v116
    v_sub_f32 v113, v116, v112
    v_exp_f32 v113, v113
    v_mov_b32 v116, v112
    v_sub_f32 v76, v76, v116
    v_sub_f32 v77, v77, v116
    v_sub_f32 v78, v78, v116
    v_sub_f32 v79, v79, v116
    v_sub_f32 v80, v80, v116
    v_sub_f32 v81, v81, v116
    v_sub_f32 v82, v82, v116
    v_sub_f32 v83, v83, v116
    v_sub_f32 v84, v84, v116
    v_sub_f32 v85, v85, v116
    v_sub_f32 v86, v86, v116
    v_sub_f32 v87, v87, v116
    v_sub_f32 v88, v88, v116
    v_sub_f32 v89, v89, v116
    v_sub_f32 v90, v90, v116
    v_sub_f32 v91, v91, v116
    v_exp_f32 v76, v76
    v_exp_f32 v77, v77
    v_exp_f32 v78, v78
    v_exp_f32 v79, v79
    v_exp_f32 v80, v80
    v_exp_f32 v81, v81
    v_exp_f32 v82, v82
    v_exp_f32 v83, v83
    v_exp_f32 v84, v84
    v_exp_f32 v85, v85
    v_exp_f32 v86, v86
    v_exp_f32 v87, v87
    v_exp_f32 v88, v88
    v_exp_f32 v89, v89
    v_exp_f32 v90, v90
    v_exp_f32 v91, v91
    v_mul_f32 v44, v44, v113
    v_mul_f32 v45, v45, v113
    v_mul_f32 v46, v46, v113
    v_mul_f32 v47, v47, v113
    v_mul_f32 v48, v48, v113
    v_mul_f32 v49, v49, v113
    v_mul_f32 v50, v50, v113
    v_mul_f32 v51, v51, v113
    v_mul_f32 v52, v52, v113
    v_mul_f32 v53, v53, v113
    v_mul_f32 v54, v54, v113
    v_mul_f32 v55, v55, v113
    v_mul_f32 v56, v56, v113
    v_mul_f32 v57, v57, v113
    v_mul_f32 v58, v58, v113
    v_mul_f32 v59, v59, v113
    v_cvt_pk_bf16_f32 v36, v76, v77
    v_cvt_pk_bf16_f32 v37, v78, v79
    v_cvt_pk_bf16_f32 v38, v80, v81
    v_cvt_pk_bf16_f32 v39, v82, v83
    v_cvt_pk_bf16_f32 v40, v84, v85
    v_cvt_pk_bf16_f32 v41, v86, v87
    v_cvt_pk_bf16_f32 v42, v88, v89
    v_cvt_pk_bf16_f32 v43, v90, v91
    s_nop 1
    v_mfma_f32_32x32x16_bf16 v[44:59], v[28:31], v[36:39], v[44:59]
    v_mfma_f32_32x32x16_bf16 v[44:59], v[32:35], v[40:43], v[44:59]
    s_nop 15
    s_nop 3
    buffer_load_dwordx4 v[20:23], v3, s[4:7], s29 offen offset:3072
    ds_read_b128 v[28:31], v110 offset:3648
    ds_read_b128 v[32:35], v110 offset:4256
    s_waitcnt vmcnt(0) lgkmcnt(0)
    v_mfma_f32_32x32x16_bf16 v[76:91], v[20:23], v[4:7], 0
    v_mfma_f32_32x32x8bf16_1k v[76:91], v[26:27], v[14:15], v[76:91]
    s_nop 15
    s_nop 7
    v_max3_f32 v112, v76, v77, v78
    v_max3_f32 v112, v112, v79, v80
    v_max3_f32 v112, v112, v81, v82
    v_max3_f32 v112, v112, v83, v84
    v_max3_f32 v112, v112, v85, v86
    v_max3_f32 v112, v112, v87, v88
    v_max3_f32 v112, v112, v89, v90
    v_max_f32 v112, v112, v91
    s_nop 1
    v_mov_b32 v113, v112
    s_nop 1
    v_permlane32_swap_b32 v113, v112
    s_nop 1
    v_max3_f32 v112, v112, v113, v116
    v_sub_f32 v113, v116, v112
    v_exp_f32 v113, v113
    v_mov_b32 v116, v112
    v_sub_f32 v76, v76, v116
    v_sub_f32 v77, v77, v116
    v_sub_f32 v78, v78, v116
    v_sub_f32 v79, v79, v116
    v_sub_f32 v80, v80, v116
    v_sub_f32 v81, v81, v116
    v_sub_f32 v82, v82, v116
    v_sub_f32 v83, v83, v116
    v_sub_f32 v84, v84, v116
    v_sub_f32 v85, v85, v116
    v_sub_f32 v86, v86, v116
    v_sub_f32 v87, v87, v116
    v_sub_f32 v88, v88, v116
    v_sub_f32 v89, v89, v116
    v_sub_f32 v90, v90, v116
    v_sub_f32 v91, v91, v116
    v_exp_f32 v76, v76
    v_exp_f32 v77, v77
    v_exp_f32 v78, v78
    v_exp_f32 v79, v79
    v_exp_f32 v80, v80
    v_exp_f32 v81, v81
    v_exp_f32 v82, v82
    v_exp_f32 v83, v83
    v_exp_f32 v84, v84
    v_exp_f32 v85, v85
    v_exp_f32 v86, v86
    v_exp_f32 v87, v87
    v_exp_f32 v88, v88
    v_exp_f32 v89, v89
    v_exp_f32 v90, v90
    v_exp_f32 v91, v91
    v_mul_f32 v44, v44, v113
    v_mul_f32 v45, v45, v113
    v_mul_f32 v46, v46, v113
    v_mul_f32 v47, v47, v113
    v_mul_f32 v48, v48, v113
    v_mul_f32 v49, v49, v113
    v_mul_f32 v50, v50, v113
    v_mul_f32 v51, v51, v113
    v_mul_f32 v52, v52, v113
    v_mul_f32 v53, v53, v113
    v_mul_f32 v54, v54, v113
    v_mul_f32 v55, v55, v113
    v_mul_f32 v56, v56, v113
    v_mul_f32 v57, v57, v113
    v_mul_f32 v58, v58, v113
    v_mul_f32 v59, v59, v113
    v_cvt_pk_bf16_f32 v36, v76, v77
    v_cvt_pk_bf16_f32 v37, v78, v79
    v_cvt_pk_bf16_f32 v38, v80, v81
    v_cvt_pk_bf16_f32 v39, v82, v83
    v_cvt_pk_bf16_f32 v40, v84, v85
    v_cvt_pk_bf16_f32 v41, v86, v87
    v_cvt_pk_bf16_f32 v42, v88, v89
    v_cvt_pk_bf16_f32 v43, v90, v91
    s_nop 1
    v_mfma_f32_32x32x16_bf16 v[44:59], v[28:31], v[36:39], v[44:59]
    v_mfma_f32_32x32x16_bf16 v[44:59], v[32:35], v[40:43], v[44:59]
    s_nop 15
    s_nop 3
    v_add_u32 v109, 512, v109
    v_add_u32 v110, 4864, v110
    s_add_u32 s29, s29, 4096
    s_add_u32 s20, s20, 1
    s_cmp_lt_u32 s20, 16
    s_cbranch_scc1 L_apa_sloop
    v_mov_b32 v112, v54
    s_nop 1
    v_permlane32_swap_b32 v112, v54
    s_nop 1
    s_branch L_apa_fin
.section .rodata,"a"
.p2align 6
.amdhsa_kernel attn_proj1_qkv2_kernel
.amdhsa_next_free_vgpr 244
.amdhsa_next_free_sgpr 102
.amdhsa_accum_offset 244
.amdhsa_group_segment_fixed_size 0
.amdhsa_kernarg_size 96
.amdhsa_user_sgpr_count 2
.amdhsa_user_sgpr_kernarg_segment_ptr 1
.amdhsa_system_sgpr_workgroup_id_x 1
.amdhsa_float_denorm_mode_32 3
.end_amdhsa_kernel
.text
```
